```python
import torch

def _softmax(x, axis=-1):
    return torch.softmax(x, dim=axis)
def _gelu(x):
    return torch.nn.functional.gelu(x, approximate="tanh")
def _silu(x):
    return torch.nn.functional.silu(x)
def _sigmoid(x):
    return torch.sigmoid(x)
def _layernorm(x, axis=-1, eps=1e-5):
    m = x.mean(dim=axis, keepdim=True)
    v = x.var(dim=axis, keepdim=True, unbiased=False)
    return (x - m) / torch.sqrt(v + eps)
def _scatter_add(tgt, idx, src, axis=0):
    return tgt.clone().index_add_(axis, idx, src)
def _segment_sum(src, seg, n):
    out = torch.zeros((n,) + src.shape[1:], dtype=src.dtype)
    return out.index_add_(0, seg, src)
def _pad(x, pw):
    flat = tuple(v for pair in reversed(pw) for v in pair)
    return torch.nn.functional.pad(x, flat)

kernel_name = 'interleave_layers__softmax_full_mha__dense_activation_gelu__prompt'

def setup_inputs():

    _w = (lambda a: (lambda t: t.to(torch.bfloat16) if t.is_floating_point() else t)(torch.as_tensor(a)))
    def _A_setup():
        B, S, D = 1, 2048, 512
        return {
            "x": _w((lambda *s: torch.randn(*s, dtype=torch.bfloat16) * 0.05)(B, S, D)),
            "wqkv": _w((lambda *s: torch.randn(*s, dtype=torch.bfloat16) * 0.05)(D, 3 * D)),
            "wo": _w((lambda *s: torch.randn(*s, dtype=torch.bfloat16) * 0.05)(D, D)),
        }
    _A_in = _A_setup()

    def _B_setup():
        B, S, D, F = 1, 2048, 512, 1792
        return {
            "x": _w((lambda *s: torch.randn(*s, dtype=torch.bfloat16) * 0.05)(B, S, D)),
            "w1": _w((lambda *s: torch.randn(*s, dtype=torch.bfloat16) * 0.8)(D, F) * (D ** -0.5)),
            "b1": _w((lambda *s: torch.randn(*s, dtype=torch.bfloat16) * 0.2)(F) * 0.01),
            "w2": _w((lambda *s: torch.randn(*s, dtype=torch.bfloat16) * 0.2)(F, D) * (F ** -0.5)),
            "b2": _w((lambda *s: torch.randn(*s, dtype=torch.bfloat16) * 0.2)(D) * 0.01),
        }
    _B_in = _B_setup()

    return {
        "A_x": _A_in["x"],
        "A_wqkv": _A_in["wqkv"],
        "A_wo": _A_in["wo"],
        "B_x": _B_in["x"],
        "B_w1": _B_in["w1"],
        "B_b1": _B_in["b1"],
        "B_w2": _B_in["w2"],
        "B_b2": _B_in["b2"],
    }

def reference(A_x, A_wqkv, A_wo, B_x, B_w1, B_b1, B_w2, B_b2):
    def _A_ref(x, wqkv, wo):
        B, S, D = x.shape
        H = 32; Dh = D // H
        qkv = (lambda x, *d: x.permute(*d))((x @ wqkv).reshape(B, S, 3, H, Dh), 2, 0, 3, 1, 4)
        q, k, v = qkv[0], qkv[1], qkv[2]
        scale = Dh ** -0.5
        scores = torch.einsum("bhqd,bhkd->bhqk", q, k) * scale
        p = _softmax(scores, axis=-1)
        o = torch.einsum("bhqk,bhkd->bhqd", p, v)
        return (lambda x, *d: x.permute(*d))(o, 0, 2, 1, 3).reshape(B, S, D) @ wo

    def _B_ref(x, w1, b1, w2, b2):
        h = torch.einsum("bsd,df->bsf", x, w1) + b1
        h = _gelu(h)
        return torch.einsum("bsf,fd->bsd", h, w2) + b2

    x = A_x
    x = x + _A_ref(_layernorm(x, axis=-1), A_wqkv, A_wo)
    x = x + _B_ref(_layernorm(x, axis=-1), B_w1, B_b1, B_w2, B_b2)
    x = x + _A_ref(_layernorm(x, axis=-1), A_wqkv, A_wo)
    x = x + _B_ref(_layernorm(x, axis=-1), B_w1, B_b1, B_w2, B_b2)
    return x
```

```asm
; @launch kernel=qkv1_kernel grid=(238,1,1) block=(512,1,1) lds=140800
; @launch kernel=attn_kernel grid=(256,1,1) block=(512,1,1) lds=139520
; @launch kernel=wo1_kernel grid=(256,1,1) block=(256,1,1) lds=65536
; @launch kernel=ffn1a_kernel grid=(224,1,1) block=(512,1,1) lds=69632
; @launch kernel=ffn2a_kernel grid=(256,1,1) block=(256,1,1) lds=65536
; @launch kernel=qkv2_kernel grid=(192,1,1) block=(512,1,1) lds=69632
; @launch kernel=attn_kernel grid=(256,1,1) block=(512,1,1) lds=139520
; @launch kernel=wo2_kernel grid=(256,1,1) block=(256,1,1) lds=65536
; @launch kernel=ffn1b_kernel grid=(224,1,1) block=(512,1,1) lds=69632
; @launch kernel=ffn2b_kernel grid=(256,1,1) block=(256,1,1) lds=65536
.amdgcn_target "amdgcn-amd-amdhsa--gfx950"
.text
.globl qkv1_kernel
.p2align 8
.type qkv1_kernel,@function
qkv1_kernel:
    s_cmp_ge_u32 s2, 238
    s_cbranch_scc1 L_qkv1_kernel_end
    s_load_dwordx16 s[4:19], s[0:1], 0
    s_load_dwordx4 s[20:23], s[0:1], 64
    s_load_dwordx2 s[24:25], s[0:1], 80
    s_and_b32 s51, s2, 7
    s_mul_i32 s51, s51, 24
    s_lshr_b32 s54, s2, 3
    s_add_u32 s54, s54, s51
    s_mov_b32 s51, 0x05555556
    s_mul_hi_u32 s48, s54, s51
    s_mul_i32 s51, s48, 48
    s_sub_u32 s54, s54, s51
    s_lshr_b32 s49, s54, 3
    s_and_b32 s54, s54, 7
    s_lshl_b32 s48, s48, 3
    s_add_u32 s48, s48, s54
    v_lshrrev_b32 v2, 6, v0
    v_and_b32 v1, 63, v0
    v_lshrrev_b32 v5, 5, v1
    v_readfirstlane_b32 s50, v2
    v_lshlrev_b32 v3, 4, v1
    v_and_b32 v4, 31, v1
    s_waitcnt lgkmcnt(0)
    s_cmp_lt_u32 s2, 192
    s_cbranch_scc1 L_qkv1_kernel_main_1
    s_and_b32 s89, s50, 3
    s_lshr_b32 s90, s50, 2
    s_cmp_ge_u32 s2, 204
    s_cbranch_scc1 L_qkv1_kernel_seg_2
    s_sub_u32 s80, s2, 192
    s_lshl_b32 s80, s80, 1
    s_add_u32 s80, s80, s90
    s_mov_b32 s28, s6
    s_and_b32 s29, s7, 0xffff
    s_mov_b32 s30, 0x00180000
    s_mov_b32 s31, 0x00020000
    s_add_u32 s32, s24, 0x01600000
    s_addc_u32 s33, s25, 0
    s_and_b32 s33, s33, 0xffff
    s_mov_b32 s34, 0x00180000
    s_mov_b32 s35, 0x00020000
    s_mov_b32 s84, s80
    s_mul_i32 s85, s89, 8
    v_lshrrev_b32 v3, 3, v1
    v_mul_u32_u24 v3, 3072, v3
    v_and_b32 v4, 7, v1
    v_lshl_add_u32 v3, v4, 4, v3
    s_mul_i32 s86, s85, 49152
    s_lshl_b32 s83, s84, 7
    s_add_u32 s86, s86, s83
    s_lshl_b32 s88, s50, 14
    s_add_u32 m0, s88, 0
    s_nop 0
    buffer_load_dwordx4 v3, s[28:31], s86 offen lds
    s_add_u32 s86, s86, 24576
    s_add_u32 m0, s88, 1024
    s_nop 0
    buffer_load_dwordx4 v3, s[28:31], s86 offen lds
    s_add_u32 s86, s86, 24576
    s_add_u32 m0, s88, 2048
    s_nop 0
    buffer_load_dwordx4 v3, s[28:31], s86 offen lds
    s_add_u32 s86, s86, 24576
    s_add_u32 m0, s88, 3072
    s_nop 0
    buffer_load_dwordx4 v3, s[28:31], s86 offen lds
    s_add_u32 s86, s86, 24576
    s_add_u32 m0, s88, 4096
    s_nop 0
    buffer_load_dwordx4 v3, s[28:31], s86 offen lds
    s_add_u32 s86, s86, 24576
    s_add_u32 m0, s88, 5120
    s_nop 0
    buffer_load_dwordx4 v3, s[28:31], s86 offen lds
    s_add_u32 s86, s86, 24576
    s_add_u32 m0, s88, 6144
    s_nop 0
    buffer_load_dwordx4 v3, s[28:31], s86 offen lds
    s_add_u32 s86, s86, 24576
    s_add_u32 m0, s88, 7168
    s_nop 0
    buffer_load_dwordx4 v3, s[28:31], s86 offen lds
    s_add_u32 s86, s86, 24576
    s_add_u32 m0, s88, 8192
    s_nop 0
    buffer_load_dwordx4 v3, s[28:31], s86 offen lds
    s_add_u32 s86, s86, 24576
    s_add_u32 m0, s88, 9216
    s_nop 0
    buffer_load_dwordx4 v3, s[28:31], s86 offen lds
    s_add_u32 s86, s86, 24576
    s_add_u32 m0, s88, 10240
    s_nop 0
    buffer_load_dwordx4 v3, s[28:31], s86 offen lds
    s_add_u32 s86, s86, 24576
    s_add_u32 m0, s88, 11264
    s_nop 0
    buffer_load_dwordx4 v3, s[28:31], s86 offen lds
    s_add_u32 s86, s86, 24576
    s_add_u32 m0, s88, 12288
    s_nop 0
    buffer_load_dwordx4 v3, s[28:31], s86 offen lds
    s_add_u32 s86, s86, 24576
    s_add_u32 m0, s88, 13312
    s_nop 0
    buffer_load_dwordx4 v3, s[28:31], s86 offen lds
    s_add_u32 s86, s86, 24576
    s_add_u32 m0, s88, 14336
    s_nop 0
    buffer_load_dwordx4 v3, s[28:31], s86 offen lds
    s_add_u32 s86, s86, 24576
    s_add_u32 m0, s88, 15360
    s_nop 0
    buffer_load_dwordx4 v3, s[28:31], s86 offen lds
    s_add_u32 s86, s86, 24576
    v_lshrrev_b32 v6, 4, v1
    v_and_b32 v7, 15, v1
    v_lshrrev_b32 v8, 2, v7
    v_and_b32 v9, 3, v7
    v_lshrrev_b32 v10, 1, v6
    v_lshl_add_u32 v10, v10, 3, v8
    v_lshlrev_b32 v10, 7, v10
    v_and_b32 v11, 1, v6
    v_lshlrev_b32 v11, 5, v11
    v_lshl_add_u32 v11, v9, 3, v11
    v_add3_u32 v10, v10, v11, s88
    v_lshlrev_b32 v5, 4, v1
    s_mul_i32 s83, s84, 64
    s_add_u32 s83, s83, s85
    s_lshl_b32 s83, s83, 10
    v_mov_b32 v12, 0
    v_mov_b32 v13, 0
    v_mov_b32 v14, 0x3f803f80
    s_waitcnt vmcnt(14)
    ds_read_b64_tr_b16 v[16:17], v10 offset:0
    ds_read_b64_tr_b16 v[18:19], v10 offset:512
    ds_read_b64_tr_b16 v[20:21], v10 offset:64
    ds_read_b64_tr_b16 v[22:23], v10 offset:576
    s_waitcnt lgkmcnt(0)
    s_add_u32 s86, s83, 0
    buffer_store_dwordx4 v[16:19], v5, s[32:35], s86 offen
    v_dot2_f32_bf16 v12, v16, v14, v12
    v_dot2_f32_bf16 v12, v17, v14, v12
    v_dot2_f32_bf16 v12, v18, v14, v12
    v_dot2_f32_bf16 v12, v19, v14, v12
    s_add_u32 s86, s83, 32768
    buffer_store_dwordx4 v[20:23], v5, s[32:35], s86 offen
    v_dot2_f32_bf16 v13, v20, v14, v13
    v_dot2_f32_bf16 v13, v21, v14, v13
    v_dot2_f32_bf16 v13, v22, v14, v13
    v_dot2_f32_bf16 v13, v23, v14, v13
    s_waitcnt vmcnt(14)
    ds_read_b64_tr_b16 v[24:25], v10 offset:2048
    ds_read_b64_tr_b16 v[26:27], v10 offset:2560
    ds_read_b64_tr_b16 v[28:29], v10 offset:2112
    ds_read_b64_tr_b16 v[30:31], v10 offset:2624
    s_waitcnt lgkmcnt(0)
    s_add_u32 s86, s83, 1024
    buffer_store_dwordx4 v[24:27], v5, s[32:35], s86 offen
    v_dot2_f32_bf16 v12, v24, v14, v12
    v_dot2_f32_bf16 v12, v25, v14, v12
    v_dot2_f32_bf16 v12, v26, v14, v12
    v_dot2_f32_bf16 v12, v27, v14, v12
    s_add_u32 s86, s83, 33792
    buffer_store_dwordx4 v[28:31], v5, s[32:35], s86 offen
    v_dot2_f32_bf16 v13, v28, v14, v13
    v_dot2_f32_bf16 v13, v29, v14, v13
    v_dot2_f32_bf16 v13, v30, v14, v13
    v_dot2_f32_bf16 v13, v31, v14, v13
    s_waitcnt vmcnt(14)
    ds_read_b64_tr_b16 v[16:17], v10 offset:4096
    ds_read_b64_tr_b16 v[18:19], v10 offset:4608
    ds_read_b64_tr_b16 v[20:21], v10 offset:4160
    ds_read_b64_tr_b16 v[22:23], v10 offset:4672
    s_waitcnt lgkmcnt(0)
    s_add_u32 s86, s83, 2048
    buffer_store_dwordx4 v[16:19], v5, s[32:35], s86 offen
    v_dot2_f32_bf16 v12, v16, v14, v12
    v_dot2_f32_bf16 v12, v17, v14, v12
    v_dot2_f32_bf16 v12, v18, v14, v12
    v_dot2_f32_bf16 v12, v19, v14, v12
    s_add_u32 s86, s83, 34816
    buffer_store_dwordx4 v[20:23], v5, s[32:35], s86 offen
    v_dot2_f32_bf16 v13, v20, v14, v13
    v_dot2_f32_bf16 v13, v21, v14, v13
    v_dot2_f32_bf16 v13, v22, v14, v13
    v_dot2_f32_bf16 v13, v23, v14, v13
    s_waitcnt vmcnt(14)
    ds_read_b64_tr_b16 v[24:25], v10 offset:6144
    ds_read_b64_tr_b16 v[26:27], v10 offset:6656
    ds_read_b64_tr_b16 v[28:29], v10 offset:6208
    ds_read_b64_tr_b16 v[30:31], v10 offset:6720
    s_waitcnt lgkmcnt(0)
    s_add_u32 s86, s83, 3072
    buffer_store_dwordx4 v[24:27], v5, s[32:35], s86 offen
    v_dot2_f32_bf16 v12, v24, v14, v12
    v_dot2_f32_bf16 v12, v25, v14, v12
    v_dot2_f32_bf16 v12, v26, v14, v12
    v_dot2_f32_bf16 v12, v27, v14, v12
    s_add_u32 s86, s83, 35840
    buffer_store_dwordx4 v[28:31], v5, s[32:35], s86 offen
    v_dot2_f32_bf16 v13, v28, v14, v13
    v_dot2_f32_bf16 v13, v29, v14, v13
    v_dot2_f32_bf16 v13, v30, v14, v13
    v_dot2_f32_bf16 v13, v31, v14, v13
    s_waitcnt vmcnt(14)
    ds_read_b64_tr_b16 v[16:17], v10 offset:8192
    ds_read_b64_tr_b16 v[18:19], v10 offset:8704
    ds_read_b64_tr_b16 v[20:21], v10 offset:8256
    ds_read_b64_tr_b16 v[22:23], v10 offset:8768
    s_waitcnt lgkmcnt(0)
    s_add_u32 s86, s83, 4096
    buffer_store_dwordx4 v[16:19], v5, s[32:35], s86 offen
    v_dot2_f32_bf16 v12, v16, v14, v12
    v_dot2_f32_bf16 v12, v17, v14, v12
    v_dot2_f32_bf16 v12, v18, v14, v12
    v_dot2_f32_bf16 v12, v19, v14, v12
    s_add_u32 s86, s83, 36864
    buffer_store_dwordx4 v[20:23], v5, s[32:35], s86 offen
    v_dot2_f32_bf16 v13, v20, v14, v13
    v_dot2_f32_bf16 v13, v21, v14, v13
    v_dot2_f32_bf16 v13, v22, v14, v13
    v_dot2_f32_bf16 v13, v23, v14, v13
    s_waitcnt vmcnt(14)
    ds_read_b64_tr_b16 v[24:25], v10 offset:10240
    ds_read_b64_tr_b16 v[26:27], v10 offset:10752
    ds_read_b64_tr_b16 v[28:29], v10 offset:10304
    ds_read_b64_tr_b16 v[30:31], v10 offset:10816
    s_waitcnt lgkmcnt(0)
    s_add_u32 s86, s83, 5120
    buffer_store_dwordx4 v[24:27], v5, s[32:35], s86 offen
    v_dot2_f32_bf16 v12, v24, v14, v12
    v_dot2_f32_bf16 v12, v25, v14, v12
    v_dot2_f32_bf16 v12, v26, v14, v12
    v_dot2_f32_bf16 v12, v27, v14, v12
    s_add_u32 s86, s83, 37888
    buffer_store_dwordx4 v[28:31], v5, s[32:35], s86 offen
    v_dot2_f32_bf16 v13, v28, v14, v13
    v_dot2_f32_bf16 v13, v29, v14, v13
    v_dot2_f32_bf16 v13, v30, v14, v13
    v_dot2_f32_bf16 v13, v31, v14, v13
    s_waitcnt vmcnt(14)
    ds_read_b64_tr_b16 v[16:17], v10 offset:12288
    ds_read_b64_tr_b16 v[18:19], v10 offset:12800
    ds_read_b64_tr_b16 v[20:21], v10 offset:12352
    ds_read_b64_tr_b16 v[22:23], v10 offset:12864
    s_waitcnt lgkmcnt(0)
    s_add_u32 s86, s83, 6144
    buffer_store_dwordx4 v[16:19], v5, s[32:35], s86 offen
    v_dot2_f32_bf16 v12, v16, v14, v12
    v_dot2_f32_bf16 v12, v17, v14, v12
    v_dot2_f32_bf16 v12, v18, v14, v12
    v_dot2_f32_bf16 v12, v19, v14, v12
    s_add_u32 s86, s83, 38912
    buffer_store_dwordx4 v[20:23], v5, s[32:35], s86 offen
    v_dot2_f32_bf16 v13, v20, v14, v13
    v_dot2_f32_bf16 v13, v21, v14, v13
    v_dot2_f32_bf16 v13, v22, v14, v13
    v_dot2_f32_bf16 v13, v23, v14, v13
    s_waitcnt vmcnt(14)
    ds_read_b64_tr_b16 v[24:25], v10 offset:14336
    ds_read_b64_tr_b16 v[26:27], v10 offset:14848
    ds_read_b64_tr_b16 v[28:29], v10 offset:14400
    ds_read_b64_tr_b16 v[30:31], v10 offset:14912
    s_waitcnt lgkmcnt(0)
    s_add_u32 s86, s83, 7168
    buffer_store_dwordx4 v[24:27], v5, s[32:35], s86 offen
    v_dot2_f32_bf16 v12, v24, v14, v12
    v_dot2_f32_bf16 v12, v25, v14, v12
    v_dot2_f32_bf16 v12, v26, v14, v12
    v_dot2_f32_bf16 v12, v27, v14, v12
    s_add_u32 s86, s83, 39936
    buffer_store_dwordx4 v[28:31], v5, s[32:35], s86 offen
    v_dot2_f32_bf16 v13, v28, v14, v13
    v_dot2_f32_bf16 v13, v29, v14, v13
    v_dot2_f32_bf16 v13, v30, v14, v13
    v_dot2_f32_bf16 v13, v31, v14, v13
    s_nop 3
    v_mov_b32 v32, v12
    v_mov_b32 v33, v13
    s_nop 1
    v_permlane32_swap_b32 v12, v32
    v_permlane32_swap_b32 v13, v33
    s_nop 1
    v_add_f32 v12, v12, v32
    v_add_f32 v13, v13, v33
    v_cmp_gt_u32 vcc, 32, v1
    s_nop 1
    v_cndmask_b32 v12, v13, v12, vcc
    v_lshlrev_b32 v7, 2, v1
    s_lshl_b32 s83, s50, 8
    v_add_u32 v8, s83, v7
    v_add_u32 v8, 131072, v8
    ds_write_b32 v8, v12
    s_waitcnt lgkmcnt(0)
    s_barrier
    s_lshl_b32 s83, s90, 10
    v_add_u32 v8, s83, v7
    v_add_u32 v8, 131072, v8
    ds_read_b32 v16, v8 offset:0
    ds_read_b32 v17, v8 offset:256
    ds_read_b32 v18, v8 offset:512
    ds_read_b32 v19, v8 offset:768
    s_waitcnt lgkmcnt(0)
    v_add_f32 v16, v16, v17
    v_add_f32 v18, v18, v19
    v_add_f32 v16, v16, v18
    s_add_u32 s36, s24, 0x02400000
    s_addc_u32 s37, s25, 0
    s_and_b32 s37, s37, 0xffff
    s_mov_b32 s38, 0x00001800
    s_mov_b32 s39, 0x00020000
    s_lshl_b32 s83, s84, 8
    buffer_store_dword v16, v7, s[36:39], s83 offen
    s_endpgm
L_qkv1_kernel_seg_2:
    s_cmp_ge_u32 s2, 218
    s_cbranch_scc1 L_qkv1_kernel_seg_3
    s_sub_u32 s80, s2, 204
    s_lshl_b32 s80, s80, 1
    s_add_u32 s80, s80, s90
    s_mov_b32 s28, s12
    s_and_b32 s29, s13, 0xffff
    s_mov_b32 s30, 0x001c0000
    s_mov_b32 s31, 0x00020000
    s_add_u32 s32, s24, 0x01900000
    s_addc_u32 s33, s25, 0
    s_and_b32 s33, s33, 0xffff
    s_mov_b32 s34, 0x001c0000
    s_mov_b32 s35, 0x00020000
    s_mov_b32 s84, s80
    s_mul_i32 s85, s89, 8
    v_lshrrev_b32 v3, 3, v1
    v_mul_u32_u24 v3, 3584, v3
    v_and_b32 v4, 7, v1
    v_lshl_add_u32 v3, v4, 4, v3
    s_mul_i32 s86, s85, 57344
    s_lshl_b32 s83, s84, 7
    s_add_u32 s86, s86, s83
    s_lshl_b32 s88, s50, 14
    s_add_u32 m0, s88, 0
    s_nop 0
    buffer_load_dwordx4 v3, s[28:31], s86 offen lds
    s_add_u32 s86, s86, 28672
    s_add_u32 m0, s88, 1024
    s_nop 0
    buffer_load_dwordx4 v3, s[28:31], s86 offen lds
    s_add_u32 s86, s86, 28672
    s_add_u32 m0, s88, 2048
    s_nop 0
    buffer_load_dwordx4 v3, s[28:31], s86 offen lds
    s_add_u32 s86, s86, 28672
    s_add_u32 m0, s88, 3072
    s_nop 0
    buffer_load_dwordx4 v3, s[28:31], s86 offen lds
    s_add_u32 s86, s86, 28672
    s_add_u32 m0, s88, 4096
    s_nop 0
    buffer_load_dwordx4 v3, s[28:31], s86 offen lds
    s_add_u32 s86, s86, 28672
    s_add_u32 m0, s88, 5120
    s_nop 0
    buffer_load_dwordx4 v3, s[28:31], s86 offen lds
    s_add_u32 s86, s86, 28672
    s_add_u32 m0, s88, 6144
    s_nop 0
    buffer_load_dwordx4 v3, s[28:31], s86 offen lds
    s_add_u32 s86, s86, 28672
    s_add_u32 m0, s88, 7168
    s_nop 0
    buffer_load_dwordx4 v3, s[28:31], s86 offen lds
    s_add_u32 s86, s86, 28672
    s_add_u32 m0, s88, 8192
    s_nop 0
    buffer_load_dwordx4 v3, s[28:31], s86 offen lds
    s_add_u32 s86, s86, 28672
    s_add_u32 m0, s88, 9216
    s_nop 0
    buffer_load_dwordx4 v3, s[28:31], s86 offen lds
    s_add_u32 s86, s86, 28672
    s_add_u32 m0, s88, 10240
    s_nop 0
    buffer_load_dwordx4 v3, s[28:31], s86 offen lds
    s_add_u32 s86, s86, 28672
    s_add_u32 m0, s88, 11264
    s_nop 0
    buffer_load_dwordx4 v3, s[28:31], s86 offen lds
    s_add_u32 s86, s86, 28672
    s_add_u32 m0, s88, 12288
    s_nop 0
    buffer_load_dwordx4 v3, s[28:31], s86 offen lds
    s_add_u32 s86, s86, 28672
    s_add_u32 m0, s88, 13312
    s_nop 0
    buffer_load_dwordx4 v3, s[28:31], s86 offen lds
    s_add_u32 s86, s86, 28672
    s_add_u32 m0, s88, 14336
    s_nop 0
    buffer_load_dwordx4 v3, s[28:31], s86 offen lds
    s_add_u32 s86, s86, 28672
    s_add_u32 m0, s88, 15360
    s_nop 0
    buffer_load_dwordx4 v3, s[28:31], s86 offen lds
    s_add_u32 s86, s86, 28672
    v_lshrrev_b32 v6, 4, v1
    v_and_b32 v7, 15, v1
    v_lshrrev_b32 v8, 2, v7
    v_and_b32 v9, 3, v7
    v_lshrrev_b32 v10, 1, v6
    v_lshl_add_u32 v10, v10, 3, v8
    v_lshlrev_b32 v10, 7, v10
    v_and_b32 v11, 1, v6
    v_lshlrev_b32 v11, 5, v11
    v_lshl_add_u32 v11, v9, 3, v11
    v_add3_u32 v10, v10, v11, s88
    v_lshlrev_b32 v5, 4, v1
    s_mul_i32 s83, s84, 64
    s_add_u32 s83, s83, s85
    s_lshl_b32 s83, s83, 10
    v_mov_b32 v12, 0
    v_mov_b32 v13, 0
    v_mov_b32 v14, 0x3f803f80
    s_waitcnt vmcnt(14)
    ds_read_b64_tr_b16 v[16:17], v10 offset:0
    ds_read_b64_tr_b16 v[18:19], v10 offset:512
    ds_read_b64_tr_b16 v[20:21], v10 offset:64
    ds_read_b64_tr_b16 v[22:23], v10 offset:576
    s_waitcnt lgkmcnt(0)
    s_add_u32 s86, s83, 0
    buffer_store_dwordx4 v[16:19], v5, s[32:35], s86 offen
    v_dot2_f32_bf16 v12, v16, v14, v12
    v_dot2_f32_bf16 v12, v17, v14, v12
    v_dot2_f32_bf16 v12, v18, v14, v12
    v_dot2_f32_bf16 v12, v19, v14, v12
    s_add_u32 s86, s83, 32768
    buffer_store_dwordx4 v[20:23], v5, s[32:35], s86 offen
    v_dot2_f32_bf16 v13, v20, v14, v13
    v_dot2_f32_bf16 v13, v21, v14, v13
    v_dot2_f32_bf16 v13, v22, v14, v13
    v_dot2_f32_bf16 v13, v23, v14, v13
    s_waitcnt vmcnt(14)
    ds_read_b64_tr_b16 v[24:25], v10 offset:2048
    ds_read_b64_tr_b16 v[26:27], v10 offset:2560
    ds_read_b64_tr_b16 v[28:29], v10 offset:2112
    ds_read_b64_tr_b16 v[30:31], v10 offset:2624
    s_waitcnt lgkmcnt(0)
    s_add_u32 s86, s83, 1024
    buffer_store_dwordx4 v[24:27], v5, s[32:35], s86 offen
    v_dot2_f32_bf16 v12, v24, v14, v12
    v_dot2_f32_bf16 v12, v25, v14, v12
    v_dot2_f32_bf16 v12, v26, v14, v12
    v_dot2_f32_bf16 v12, v27, v14, v12
    s_add_u32 s86, s83, 33792
    buffer_store_dwordx4 v[28:31], v5, s[32:35], s86 offen
    v_dot2_f32_bf16 v13, v28, v14, v13
    v_dot2_f32_bf16 v13, v29, v14, v13
    v_dot2_f32_bf16 v13, v30, v14, v13
    v_dot2_f32_bf16 v13, v31, v14, v13
    s_waitcnt vmcnt(14)
    ds_read_b64_tr_b16 v[16:17], v10 offset:4096
    ds_read_b64_tr_b16 v[18:19], v10 offset:4608
    ds_read_b64_tr_b16 v[20:21], v10 offset:4160
    ds_read_b64_tr_b16 v[22:23], v10 offset:4672
    s_waitcnt lgkmcnt(0)
    s_add_u32 s86, s83, 2048
    buffer_store_dwordx4 v[16:19], v5, s[32:35], s86 offen
    v_dot2_f32_bf16 v12, v16, v14, v12
    v_dot2_f32_bf16 v12, v17, v14, v12
    v_dot2_f32_bf16 v12, v18, v14, v12
    v_dot2_f32_bf16 v12, v19, v14, v12
    s_add_u32 s86, s83, 34816
    buffer_store_dwordx4 v[20:23], v5, s[32:35], s86 offen
    v_dot2_f32_bf16 v13, v20, v14, v13
    v_dot2_f32_bf16 v13, v21, v14, v13
    v_dot2_f32_bf16 v13, v22, v14, v13
    v_dot2_f32_bf16 v13, v23, v14, v13
    s_waitcnt vmcnt(14)
    ds_read_b64_tr_b16 v[24:25], v10 offset:6144
    ds_read_b64_tr_b16 v[26:27], v10 offset:6656
    ds_read_b64_tr_b16 v[28:29], v10 offset:6208
    ds_read_b64_tr_b16 v[30:31], v10 offset:6720
    s_waitcnt lgkmcnt(0)
    s_add_u32 s86, s83, 3072
    buffer_store_dwordx4 v[24:27], v5, s[32:35], s86 offen
    v_dot2_f32_bf16 v12, v24, v14, v12
    v_dot2_f32_bf16 v12, v25, v14, v12
    v_dot2_f32_bf16 v12, v26, v14, v12
    v_dot2_f32_bf16 v12, v27, v14, v12
    s_add_u32 s86, s83, 35840
    buffer_store_dwordx4 v[28:31], v5, s[32:35], s86 offen
    v_dot2_f32_bf16 v13, v28, v14, v13
    v_dot2_f32_bf16 v13, v29, v14, v13
    v_dot2_f32_bf16 v13, v30, v14, v13
    v_dot2_f32_bf16 v13, v31, v14, v13
    s_waitcnt vmcnt(14)
    ds_read_b64_tr_b16 v[16:17], v10 offset:8192
    ds_read_b64_tr_b16 v[18:19], v10 offset:8704
    ds_read_b64_tr_b16 v[20:21], v10 offset:8256
    ds_read_b64_tr_b16 v[22:23], v10 offset:8768
    s_waitcnt lgkmcnt(0)
    s_add_u32 s86, s83, 4096
    buffer_store_dwordx4 v[16:19], v5, s[32:35], s86 offen
    v_dot2_f32_bf16 v12, v16, v14, v12
    v_dot2_f32_bf16 v12, v17, v14, v12
    v_dot2_f32_bf16 v12, v18, v14, v12
    v_dot2_f32_bf16 v12, v19, v14, v12
    s_add_u32 s86, s83, 36864
    buffer_store_dwordx4 v[20:23], v5, s[32:35], s86 offen
    v_dot2_f32_bf16 v13, v20, v14, v13
    v_dot2_f32_bf16 v13, v21, v14, v13
    v_dot2_f32_bf16 v13, v22, v14, v13
    v_dot2_f32_bf16 v13, v23, v14, v13
    s_waitcnt vmcnt(14)
    ds_read_b64_tr_b16 v[24:25], v10 offset:10240
    ds_read_b64_tr_b16 v[26:27], v10 offset:10752
    ds_read_b64_tr_b16 v[28:29], v10 offset:10304
    ds_read_b64_tr_b16 v[30:31], v10 offset:10816
    s_waitcnt lgkmcnt(0)
    s_add_u32 s86, s83, 5120
    buffer_store_dwordx4 v[24:27], v5, s[32:35], s86 offen
    v_dot2_f32_bf16 v12, v24, v14, v12
    v_dot2_f32_bf16 v12, v25, v14, v12
    v_dot2_f32_bf16 v12, v26, v14, v12
    v_dot2_f32_bf16 v12, v27, v14, v12
    s_add_u32 s86, s83, 37888
    buffer_store_dwordx4 v[28:31], v5, s[32:35], s86 offen
    v_dot2_f32_bf16 v13, v28, v14, v13
    v_dot2_f32_bf16 v13, v29, v14, v13
    v_dot2_f32_bf16 v13, v30, v14, v13
    v_dot2_f32_bf16 v13, v31, v14, v13
    s_waitcnt vmcnt(14)
    ds_read_b64_tr_b16 v[16:17], v10 offset:12288
    ds_read_b64_tr_b16 v[18:19], v10 offset:12800
    ds_read_b64_tr_b16 v[20:21], v10 offset:12352
    ds_read_b64_tr_b16 v[22:23], v10 offset:12864
    s_waitcnt lgkmcnt(0)
    s_add_u32 s86, s83, 6144
    buffer_store_dwordx4 v[16:19], v5, s[32:35], s86 offen
    v_dot2_f32_bf16 v12, v16, v14, v12
    v_dot2_f32_bf16 v12, v17, v14, v12
    v_dot2_f32_bf16 v12, v18, v14, v12
    v_dot2_f32_bf16 v12, v19, v14, v12
    s_add_u32 s86, s83, 38912
    buffer_store_dwordx4 v[20:23], v5, s[32:35], s86 offen
    v_dot2_f32_bf16 v13, v20, v14, v13
    v_dot2_f32_bf16 v13, v21, v14, v13
    v_dot2_f32_bf16 v13, v22, v14, v13
    v_dot2_f32_bf16 v13, v23, v14, v13
    s_waitcnt vmcnt(14)
    ds_read_b64_tr_b16 v[24:25], v10 offset:14336
    ds_read_b64_tr_b16 v[26:27], v10 offset:14848
    ds_read_b64_tr_b16 v[28:29], v10 offset:14400
    ds_read_b64_tr_b16 v[30:31], v10 offset:14912
    s_waitcnt lgkmcnt(0)
    s_add_u32 s86, s83, 7168
    buffer_store_dwordx4 v[24:27], v5, s[32:35], s86 offen
    v_dot2_f32_bf16 v12, v24, v14, v12
    v_dot2_f32_bf16 v12, v25, v14, v12
    v_dot2_f32_bf16 v12, v26, v14, v12
    v_dot2_f32_bf16 v12, v27, v14, v12
    s_add_u32 s86, s83, 39936
    buffer_store_dwordx4 v[28:31], v5, s[32:35], s86 offen
    v_dot2_f32_bf16 v13, v28, v14, v13
    v_dot2_f32_bf16 v13, v29, v14, v13
    v_dot2_f32_bf16 v13, v30, v14, v13
    v_dot2_f32_bf16 v13, v31, v14, v13
    s_nop 3
    v_mov_b32 v32, v12
    v_mov_b32 v33, v13
    s_nop 1
    v_permlane32_swap_b32 v12, v32
    v_permlane32_swap_b32 v13, v33
    s_nop 1
    v_add_f32 v12, v12, v32
    v_add_f32 v13, v13, v33
    v_cmp_gt_u32 vcc, 32, v1
    s_nop 1
    v_cndmask_b32 v12, v13, v12, vcc
    v_lshlrev_b32 v7, 2, v1
    s_lshl_b32 s83, s50, 8
    v_add_u32 v8, s83, v7
    v_add_u32 v8, 131072, v8
    ds_write_b32 v8, v12
    s_waitcnt lgkmcnt(0)
    s_barrier
    s_lshl_b32 s83, s90, 10
    v_add_u32 v8, s83, v7
    v_add_u32 v8, 131072, v8
    ds_read_b32 v16, v8 offset:0
    ds_read_b32 v17, v8 offset:256
    ds_read_b32 v18, v8 offset:512
    ds_read_b32 v19, v8 offset:768
    s_waitcnt lgkmcnt(0)
    v_add_f32 v16, v16, v17
    v_add_f32 v18, v18, v19
    v_add_f32 v16, v16, v18
    s_add_u32 s36, s24, 0x02410000
    s_addc_u32 s37, s25, 0
    s_and_b32 s37, s37, 0xffff
    s_mov_b32 s38, 0x00001c00
    s_mov_b32 s39, 0x00020000
    s_lshl_b32 s83, s84, 8
    buffer_store_dword v16, v7, s[36:39], s83 offen
    s_endpgm
L_qkv1_kernel_seg_3:
    s_cmp_ge_u32 s2, 222
    s_cbranch_scc1 L_qkv1_kernel_seg_4
    s_sub_u32 s80, s2, 218
    s_lshl_b32 s80, s80, 1
    s_add_u32 s80, s80, s90
    s_mov_b32 s28, s8
    s_and_b32 s29, s9, 0xffff
    s_mov_b32 s30, 0x00080000
    s_mov_b32 s31, 0x00020000
    s_add_u32 s32, s24, 0x01800000
    s_addc_u32 s33, s25, 0
    s_and_b32 s33, s33, 0xffff
    s_mov_b32 s34, 0x00080000
    s_mov_b32 s35, 0x00020000
    s_mov_b32 s84, s80
    s_mul_i32 s85, s89, 8
    v_lshrrev_b32 v3, 3, v1
    v_mul_u32_u24 v3, 1024, v3
    v_and_b32 v4, 7, v1
    v_lshl_add_u32 v3, v4, 4, v3
    s_mul_i32 s86, s85, 16384
    s_lshl_b32 s83, s84, 7
    s_add_u32 s86, s86, s83
    s_lshl_b32 s88, s50, 14
    s_add_u32 m0, s88, 0
    s_nop 0
    buffer_load_dwordx4 v3, s[28:31], s86 offen lds
    s_add_u32 s86, s86, 8192
    s_add_u32 m0, s88, 1024
    s_nop 0
    buffer_load_dwordx4 v3, s[28:31], s86 offen lds
    s_add_u32 s86, s86, 8192
    s_add_u32 m0, s88, 2048
    s_nop 0
    buffer_load_dwordx4 v3, s[28:31], s86 offen lds
    s_add_u32 s86, s86, 8192
    s_add_u32 m0, s88, 3072
    s_nop 0
    buffer_load_dwordx4 v3, s[28:31], s86 offen lds
    s_add_u32 s86, s86, 8192
    s_add_u32 m0, s88, 4096
    s_nop 0
    buffer_load_dwordx4 v3, s[28:31], s86 offen lds
    s_add_u32 s86, s86, 8192
    s_add_u32 m0, s88, 5120
    s_nop 0
    buffer_load_dwordx4 v3, s[28:31], s86 offen lds
    s_add_u32 s86, s86, 8192
    s_add_u32 m0, s88, 6144
    s_nop 0
    buffer_load_dwordx4 v3, s[28:31], s86 offen lds
    s_add_u32 s86, s86, 8192
    s_add_u32 m0, s88, 7168
    s_nop 0
    buffer_load_dwordx4 v3, s[28:31], s86 offen lds
    s_add_u32 s86, s86, 8192
    s_add_u32 m0, s88, 8192
    s_nop 0
    buffer_load_dwordx4 v3, s[28:31], s86 offen lds
    s_add_u32 s86, s86, 8192
    s_add_u32 m0, s88, 9216
    s_nop 0
    buffer_load_dwordx4 v3, s[28:31], s86 offen lds
    s_add_u32 s86, s86, 8192
    s_add_u32 m0, s88, 10240
    s_nop 0
    buffer_load_dwordx4 v3, s[28:31], s86 offen lds
    s_add_u32 s86, s86, 8192
    s_add_u32 m0, s88, 11264
    s_nop 0
    buffer_load_dwordx4 v3, s[28:31], s86 offen lds
    s_add_u32 s86, s86, 8192
    s_add_u32 m0, s88, 12288
    s_nop 0
    buffer_load_dwordx4 v3, s[28:31], s86 offen lds
    s_add_u32 s86, s86, 8192
    s_add_u32 m0, s88, 13312
    s_nop 0
    buffer_load_dwordx4 v3, s[28:31], s86 offen lds
    s_add_u32 s86, s86, 8192
    s_add_u32 m0, s88, 14336
    s_nop 0
    buffer_load_dwordx4 v3, s[28:31], s86 offen lds
    s_add_u32 s86, s86, 8192
    s_add_u32 m0, s88, 15360
    s_nop 0
    buffer_load_dwordx4 v3, s[28:31], s86 offen lds
    s_add_u32 s86, s86, 8192
    v_lshrrev_b32 v6, 4, v1
    v_and_b32 v7, 15, v1
    v_lshrrev_b32 v8, 2, v7
    v_and_b32 v9, 3, v7
    v_lshrrev_b32 v10, 1, v6
    v_lshl_add_u32 v10, v10, 3, v8
    v_lshlrev_b32 v10, 7, v10
    v_and_b32 v11, 1, v6
    v_lshlrev_b32 v11, 5, v11
    v_lshl_add_u32 v11, v9, 3, v11
    v_add3_u32 v10, v10, v11, s88
    v_lshlrev_b32 v5, 4, v1
    s_mul_i32 s83, s84, 64
    s_add_u32 s83, s83, s85
    s_lshl_b32 s83, s83, 10
    v_mov_b32 v12, 0
    v_mov_b32 v13, 0
    v_mov_b32 v14, 0x3f803f80
    s_waitcnt vmcnt(14)
    ds_read_b64_tr_b16 v[16:17], v10 offset:0
    ds_read_b64_tr_b16 v[18:19], v10 offset:512
    ds_read_b64_tr_b16 v[20:21], v10 offset:64
    ds_read_b64_tr_b16 v[22:23], v10 offset:576
    s_waitcnt lgkmcnt(0)
    s_add_u32 s86, s83, 0
    buffer_store_dwordx4 v[16:19], v5, s[32:35], s86 offen
    s_add_u32 s86, s83, 32768
    buffer_store_dwordx4 v[20:23], v5, s[32:35], s86 offen
    s_waitcnt vmcnt(14)
    ds_read_b64_tr_b16 v[24:25], v10 offset:2048
    ds_read_b64_tr_b16 v[26:27], v10 offset:2560
    ds_read_b64_tr_b16 v[28:29], v10 offset:2112
    ds_read_b64_tr_b16 v[30:31], v10 offset:2624
    s_waitcnt lgkmcnt(0)
    s_add_u32 s86, s83, 1024
    buffer_store_dwordx4 v[24:27], v5, s[32:35], s86 offen
    s_add_u32 s86, s83, 33792
    buffer_store_dwordx4 v[28:31], v5, s[32:35], s86 offen
    s_waitcnt vmcnt(14)
    ds_read_b64_tr_b16 v[16:17], v10 offset:4096
    ds_read_b64_tr_b16 v[18:19], v10 offset:4608
    ds_read_b64_tr_b16 v[20:21], v10 offset:4160
    ds_read_b64_tr_b16 v[22:23], v10 offset:4672
    s_waitcnt lgkmcnt(0)
    s_add_u32 s86, s83, 2048
    buffer_store_dwordx4 v[16:19], v5, s[32:35], s86 offen
    s_add_u32 s86, s83, 34816
    buffer_store_dwordx4 v[20:23], v5, s[32:35], s86 offen
    s_waitcnt vmcnt(14)
    ds_read_b64_tr_b16 v[24:25], v10 offset:6144
    ds_read_b64_tr_b16 v[26:27], v10 offset:6656
    ds_read_b64_tr_b16 v[28:29], v10 offset:6208
    ds_read_b64_tr_b16 v[30:31], v10 offset:6720
    s_waitcnt lgkmcnt(0)
    s_add_u32 s86, s83, 3072
    buffer_store_dwordx4 v[24:27], v5, s[32:35], s86 offen
    s_add_u32 s86, s83, 35840
    buffer_store_dwordx4 v[28:31], v5, s[32:35], s86 offen
    s_waitcnt vmcnt(14)
    ds_read_b64_tr_b16 v[16:17], v10 offset:8192
    ds_read_b64_tr_b16 v[18:19], v10 offset:8704
    ds_read_b64_tr_b16 v[20:21], v10 offset:8256
    ds_read_b64_tr_b16 v[22:23], v10 offset:8768
    s_waitcnt lgkmcnt(0)
    s_add_u32 s86, s83, 4096
    buffer_store_dwordx4 v[16:19], v5, s[32:35], s86 offen
    s_add_u32 s86, s83, 36864
    buffer_store_dwordx4 v[20:23], v5, s[32:35], s86 offen
    s_waitcnt vmcnt(14)
    ds_read_b64_tr_b16 v[24:25], v10 offset:10240
    ds_read_b64_tr_b16 v[26:27], v10 offset:10752
    ds_read_b64_tr_b16 v[28:29], v10 offset:10304
    ds_read_b64_tr_b16 v[30:31], v10 offset:10816
    s_waitcnt lgkmcnt(0)
    s_add_u32 s86, s83, 5120
    buffer_store_dwordx4 v[24:27], v5, s[32:35], s86 offen
    s_add_u32 s86, s83, 37888
    buffer_store_dwordx4 v[28:31], v5, s[32:35], s86 offen
    s_waitcnt vmcnt(14)
    ds_read_b64_tr_b16 v[16:17], v10 offset:12288
    ds_read_b64_tr_b16 v[18:19], v10 offset:12800
    ds_read_b64_tr_b16 v[20:21], v10 offset:12352
    ds_read_b64_tr_b16 v[22:23], v10 offset:12864
    s_waitcnt lgkmcnt(0)
    s_add_u32 s86, s83, 6144
    buffer_store_dwordx4 v[16:19], v5, s[32:35], s86 offen
    s_add_u32 s86, s83, 38912
    buffer_store_dwordx4 v[20:23], v5, s[32:35], s86 offen
    s_waitcnt vmcnt(14)
    ds_read_b64_tr_b16 v[24:25], v10 offset:14336
    ds_read_b64_tr_b16 v[26:27], v10 offset:14848
    ds_read_b64_tr_b16 v[28:29], v10 offset:14400
    ds_read_b64_tr_b16 v[30:31], v10 offset:14912
    s_waitcnt lgkmcnt(0)
    s_add_u32 s86, s83, 7168
    buffer_store_dwordx4 v[24:27], v5, s[32:35], s86 offen
    s_add_u32 s86, s83, 39936
    buffer_store_dwordx4 v[28:31], v5, s[32:35], s86 offen
    s_endpgm
L_qkv1_kernel_seg_4:
    s_sub_u32 s80, s2, 222
    s_lshl_b32 s80, s80, 1
    s_add_u32 s80, s80, s90
    s_mov_b32 s28, s16
    s_and_b32 s29, s17, 0xffff
    s_mov_b32 s30, 0x001c0000
    s_mov_b32 s31, 0x00020000
    s_add_u32 s32, s24, 0x01b00000
    s_addc_u32 s33, s25, 0
    s_and_b32 s33, s33, 0xffff
    s_mov_b32 s34, 0x001c0000
    s_mov_b32 s35, 0x00020000
    s_lshr_b32 s84, s80, 2
    s_and_b32 s87, s80, 3
    s_lshl_b32 s87, s87, 2
    s_add_u32 s87, s87, s89
    s_mul_i32 s85, s87, 7
    v_lshrrev_b32 v3, 3, v1
    v_mul_u32_u24 v3, 1024, v3
    v_and_b32 v4, 7, v1
    v_lshl_add_u32 v3, v4, 4, v3
    s_mul_i32 s86, s85, 16384
    s_lshl_b32 s83, s84, 7
    s_add_u32 s86, s86, s83
    s_lshl_b32 s88, s50, 14
    s_add_u32 m0, s88, 0
    s_nop 0
    buffer_load_dwordx4 v3, s[28:31], s86 offen lds
    s_add_u32 s86, s86, 8192
    s_add_u32 m0, s88, 1024
    s_nop 0
    buffer_load_dwordx4 v3, s[28:31], s86 offen lds
    s_add_u32 s86, s86, 8192
    s_add_u32 m0, s88, 2048
    s_nop 0
    buffer_load_dwordx4 v3, s[28:31], s86 offen lds
    s_add_u32 s86, s86, 8192
    s_add_u32 m0, s88, 3072
    s_nop 0
    buffer_load_dwordx4 v3, s[28:31], s86 offen lds
    s_add_u32 s86, s86, 8192
    s_add_u32 m0, s88, 4096
    s_nop 0
    buffer_load_dwordx4 v3, s[28:31], s86 offen lds
    s_add_u32 s86, s86, 8192
    s_add_u32 m0, s88, 5120
    s_nop 0
    buffer_load_dwordx4 v3, s[28:31], s86 offen lds
    s_add_u32 s86, s86, 8192
    s_add_u32 m0, s88, 6144
    s_nop 0
    buffer_load_dwordx4 v3, s[28:31], s86 offen lds
    s_add_u32 s86, s86, 8192
    s_add_u32 m0, s88, 7168
    s_nop 0
    buffer_load_dwordx4 v3, s[28:31], s86 offen lds
    s_add_u32 s86, s86, 8192
    s_add_u32 m0, s88, 8192
    s_nop 0
    buffer_load_dwordx4 v3, s[28:31], s86 offen lds
    s_add_u32 s86, s86, 8192
    s_add_u32 m0, s88, 9216
    s_nop 0
    buffer_load_dwordx4 v3, s[28:31], s86 offen lds
    s_add_u32 s86, s86, 8192
    s_add_u32 m0, s88, 10240
    s_nop 0
    buffer_load_dwordx4 v3, s[28:31], s86 offen lds
    s_add_u32 s86, s86, 8192
    s_add_u32 m0, s88, 11264
    s_nop 0
    buffer_load_dwordx4 v3, s[28:31], s86 offen lds
    s_add_u32 s86, s86, 8192
    s_add_u32 m0, s88, 12288
    s_nop 0
    buffer_load_dwordx4 v3, s[28:31], s86 offen lds
    s_add_u32 s86, s86, 8192
    s_add_u32 m0, s88, 13312
    s_nop 0
    buffer_load_dwordx4 v3, s[28:31], s86 offen lds
    s_add_u32 s86, s86, 8192
    v_lshrrev_b32 v6, 4, v1
    v_and_b32 v7, 15, v1
    v_lshrrev_b32 v8, 2, v7
    v_and_b32 v9, 3, v7
    v_lshrrev_b32 v10, 1, v6
    v_lshl_add_u32 v10, v10, 3, v8
    v_lshlrev_b32 v10, 7, v10
    v_and_b32 v11, 1, v6
    v_lshlrev_b32 v11, 5, v11
    v_lshl_add_u32 v11, v9, 3, v11
    v_add3_u32 v10, v10, v11, s88
    v_lshlrev_b32 v5, 4, v1
    s_mul_i32 s83, s84, 224
    s_add_u32 s83, s83, s85
    s_lshl_b32 s83, s83, 10
    v_mov_b32 v12, 0
    v_mov_b32 v13, 0
    v_mov_b32 v14, 0x3f803f80
    s_waitcnt vmcnt(12)
    ds_read_b64_tr_b16 v[16:17], v10 offset:0
    ds_read_b64_tr_b16 v[18:19], v10 offset:512
    ds_read_b64_tr_b16 v[20:21], v10 offset:64
    ds_read_b64_tr_b16 v[22:23], v10 offset:576
    s_waitcnt lgkmcnt(0)
    s_add_u32 s86, s83, 0
    buffer_store_dwordx4 v[16:19], v5, s[32:35], s86 offen
    s_add_u32 s86, s83, 114688
    buffer_store_dwordx4 v[20:23], v5, s[32:35], s86 offen
    s_waitcnt vmcnt(12)
    ds_read_b64_tr_b16 v[24:25], v10 offset:2048
    ds_read_b64_tr_b16 v[26:27], v10 offset:2560
    ds_read_b64_tr_b16 v[28:29], v10 offset:2112
    ds_read_b64_tr_b16 v[30:31], v10 offset:2624
    s_waitcnt lgkmcnt(0)
    s_add_u32 s86, s83, 1024
    buffer_store_dwordx4 v[24:27], v5, s[32:35], s86 offen
    s_add_u32 s86, s83, 115712
    buffer_store_dwordx4 v[28:31], v5, s[32:35], s86 offen
    s_waitcnt vmcnt(12)
    ds_read_b64_tr_b16 v[16:17], v10 offset:4096
    ds_read_b64_tr_b16 v[18:19], v10 offset:4608
    ds_read_b64_tr_b16 v[20:21], v10 offset:4160
    ds_read_b64_tr_b16 v[22:23], v10 offset:4672
    s_waitcnt lgkmcnt(0)
    s_add_u32 s86, s83, 2048
    buffer_store_dwordx4 v[16:19], v5, s[32:35], s86 offen
    s_add_u32 s86, s83, 116736
    buffer_store_dwordx4 v[20:23], v5, s[32:35], s86 offen
    s_waitcnt vmcnt(12)
    ds_read_b64_tr_b16 v[24:25], v10 offset:6144
    ds_read_b64_tr_b16 v[26:27], v10 offset:6656
    ds_read_b64_tr_b16 v[28:29], v10 offset:6208
    ds_read_b64_tr_b16 v[30:31], v10 offset:6720
    s_waitcnt lgkmcnt(0)
    s_add_u32 s86, s83, 3072
    buffer_store_dwordx4 v[24:27], v5, s[32:35], s86 offen
    s_add_u32 s86, s83, 117760
    buffer_store_dwordx4 v[28:31], v5, s[32:35], s86 offen
    s_waitcnt vmcnt(12)
    ds_read_b64_tr_b16 v[16:17], v10 offset:8192
    ds_read_b64_tr_b16 v[18:19], v10 offset:8704
    ds_read_b64_tr_b16 v[20:21], v10 offset:8256
    ds_read_b64_tr_b16 v[22:23], v10 offset:8768
    s_waitcnt lgkmcnt(0)
    s_add_u32 s86, s83, 4096
    buffer_store_dwordx4 v[16:19], v5, s[32:35], s86 offen
    s_add_u32 s86, s83, 118784
    buffer_store_dwordx4 v[20:23], v5, s[32:35], s86 offen
    s_waitcnt vmcnt(12)
    ds_read_b64_tr_b16 v[24:25], v10 offset:10240
    ds_read_b64_tr_b16 v[26:27], v10 offset:10752
    ds_read_b64_tr_b16 v[28:29], v10 offset:10304
    ds_read_b64_tr_b16 v[30:31], v10 offset:10816
    s_waitcnt lgkmcnt(0)
    s_add_u32 s86, s83, 5120
    buffer_store_dwordx4 v[24:27], v5, s[32:35], s86 offen
    s_add_u32 s86, s83, 119808
    buffer_store_dwordx4 v[28:31], v5, s[32:35], s86 offen
    s_waitcnt vmcnt(12)
    ds_read_b64_tr_b16 v[16:17], v10 offset:12288
    ds_read_b64_tr_b16 v[18:19], v10 offset:12800
    ds_read_b64_tr_b16 v[20:21], v10 offset:12352
    ds_read_b64_tr_b16 v[22:23], v10 offset:12864
    s_waitcnt lgkmcnt(0)
    s_add_u32 s86, s83, 6144
    buffer_store_dwordx4 v[16:19], v5, s[32:35], s86 offen
    s_add_u32 s86, s83, 120832
    buffer_store_dwordx4 v[20:23], v5, s[32:35], s86 offen
    s_endpgm
L_qkv1_kernel_seg_5:
L_qkv1_kernel_main_1:
    s_mov_b32 s28, s4
    s_and_b32 s29, s5, 0xffff
    s_mov_b32 s30, 0x00200000
    s_mov_b32 s31, 0x00020000
    s_mov_b32 s32, s6
    s_and_b32 s33, s7, 0xffff
    s_mov_b32 s34, 0x00180000
    s_mov_b32 s35, 0x00020000
    s_lshl_b32 s51, s48, 16
    s_lshl_b32 s54, s50, 13
    s_add_u32 s51, s51, s54
    s_and_b32 s59, s50, 1
    s_lshl_b32 s59, s59, 3
    s_add_u32 s60, s59, 0
    v_xor_b32 v6, s60, v1
    v_lshlrev_b32 v64, 4, v6
    s_add_u32 s60, s59, 1
    v_xor_b32 v6, s60, v1
    v_lshlrev_b32 v65, 4, v6
    s_add_u32 s60, s59, 2
    v_xor_b32 v6, s60, v1
    v_lshlrev_b32 v66, 4, v6
    s_add_u32 s60, s59, 3
    v_xor_b32 v6, s60, v1
    v_lshlrev_b32 v67, 4, v6
    s_add_u32 s60, s59, 4
    v_xor_b32 v6, s60, v1
    v_lshlrev_b32 v68, 4, v6
    s_add_u32 s60, s59, 5
    v_xor_b32 v6, s60, v1
    v_lshlrev_b32 v69, 4, v6
    s_add_u32 s60, s59, 6
    v_xor_b32 v6, s60, v1
    v_lshlrev_b32 v70, 4, v6
    s_add_u32 s60, s59, 7
    v_xor_b32 v6, s60, v1
    v_lshlrev_b32 v71, 4, v6
    s_add_u32 m0, s54, 0
    s_add_u32 s60, s51, 0
    buffer_load_dwordx4 v64, s[28:31], s60 offen lds
    s_add_u32 m0, s54, 1024
    s_add_u32 s60, s51, 1024
    buffer_load_dwordx4 v65, s[28:31], s60 offen lds
    s_add_u32 m0, s54, 2048
    s_add_u32 s60, s51, 2048
    buffer_load_dwordx4 v66, s[28:31], s60 offen lds
    s_add_u32 m0, s54, 3072
    s_add_u32 s60, s51, 3072
    buffer_load_dwordx4 v67, s[28:31], s60 offen lds
    s_add_u32 m0, s54, 4096
    s_add_u32 s60, s51, 4096
    buffer_load_dwordx4 v68, s[28:31], s60 offen lds
    s_add_u32 m0, s54, 5120
    s_add_u32 s60, s51, 5120
    buffer_load_dwordx4 v69, s[28:31], s60 offen lds
    s_add_u32 m0, s54, 6144
    s_add_u32 s60, s51, 6144
    buffer_load_dwordx4 v70, s[28:31], s60 offen lds
    s_add_u32 m0, s54, 7168
    s_add_u32 s60, s51, 7168
    buffer_load_dwordx4 v71, s[28:31], s60 offen lds
    v_lshlrev_b32 v6, 10, v4
    v_and_b32 v9, 15, v1
    v_add_u32 v10, 0, v5
    v_xor_b32 v10, v10, v9
    v_lshl_add_u32 v88, v10, 4, v6
    v_add_u32 v10, 2, v5
    v_xor_b32 v10, v10, v9
    v_lshl_add_u32 v89, v10, 4, v6
    v_add_u32 v10, 4, v5
    v_xor_b32 v10, v10, v9
    v_lshl_add_u32 v90, v10, 4, v6
    v_add_u32 v10, 6, v5
    v_xor_b32 v10, v10, v9
    v_lshl_add_u32 v91, v10, 4, v6
    v_add_u32 v10, 8, v5
    v_xor_b32 v10, v10, v9
    v_lshl_add_u32 v92, v10, 4, v6
    v_add_u32 v10, 10, v5
    v_xor_b32 v10, v10, v9
    v_lshl_add_u32 v93, v10, 4, v6
    v_add_u32 v10, 12, v5
    v_xor_b32 v10, v10, v9
    v_lshl_add_u32 v94, v10, 4, v6
    v_add_u32 v10, 14, v5
    v_xor_b32 v10, v10, v9
    v_lshl_add_u32 v95, v10, 4, v6
    s_lshl_b32 s58, s49, 3
    s_add_u32 s58, s58, s50
    s_lshl_b32 s52, s58, 6
    s_lshl_b32 s59, s50, 13
    s_add_u32 s59, s59, 65536
    v_lshrrev_b32 v7, 2, v1
    v_mul_u32_u24 v7, 3072, v7
    v_and_b32 v8, 3, v1
    v_lshl_add_u32 v7, v8, 4, v7
    v_lshrrev_b32 v8, 4, v1
    v_and_b32 v9, 15, v1
    v_lshrrev_b32 v10, 2, v9
    v_and_b32 v9, 3, v9
    v_lshrrev_b32 v11, 1, v8
    v_lshl_add_u32 v11, v11, 3, v10
    v_lshlrev_b32 v11, 6, v11
    v_and_b32 v8, 1, v8
    v_lshlrev_b32 v8, 5, v8
    v_lshl_add_u32 v8, v9, 3, v8
    v_add3_u32 v8, v8, v11, s59
    s_add_u32 m0, s59, 0
    s_add_u32 s60, s52, 0
    buffer_load_dwordx4 v7, s[32:35], s60 offen lds
    s_add_u32 m0, s59, 1024
    s_add_u32 s60, s52, 49152
    buffer_load_dwordx4 v7, s[32:35], s60 offen lds
    s_add_u32 m0, s59, 2048
    s_add_u32 s60, s52, 98304
    buffer_load_dwordx4 v7, s[32:35], s60 offen lds
    s_add_u32 m0, s59, 3072
    s_add_u32 s60, s52, 147456
    buffer_load_dwordx4 v7, s[32:35], s60 offen lds
    s_add_u32 m0, s59, 4096
    s_add_u32 s60, s52, 196608
    buffer_load_dwordx4 v7, s[32:35], s60 offen lds
    s_add_u32 m0, s59, 5120
    s_add_u32 s60, s52, 245760
    buffer_load_dwordx4 v7, s[32:35], s60 offen lds
    v_mov_b32 v32, 0
    v_mov_b32 v33, 0
    v_mov_b32 v34, 0
    v_mov_b32 v35, 0
    v_mov_b32 v36, 0
    v_mov_b32 v37, 0
    v_mov_b32 v38, 0
    v_mov_b32 v39, 0
    v_mov_b32 v40, 0
    v_mov_b32 v41, 0
    v_mov_b32 v42, 0
    v_mov_b32 v43, 0
    v_mov_b32 v44, 0
    v_mov_b32 v45, 0
    v_mov_b32 v46, 0
    v_mov_b32 v47, 0
    v_mov_b32 v48, 0
    v_mov_b32 v49, 0
    v_mov_b32 v50, 0
    v_mov_b32 v51, 0
    v_mov_b32 v52, 0
    v_mov_b32 v53, 0
    v_mov_b32 v54, 0
    v_mov_b32 v55, 0
    v_mov_b32 v56, 0
    v_mov_b32 v57, 0
    v_mov_b32 v58, 0
    v_mov_b32 v59, 0
    v_mov_b32 v60, 0
    v_mov_b32 v61, 0
    v_mov_b32 v62, 0
    v_mov_b32 v63, 0
    v_mov_b32 v24, 0
    v_mov_b32 v25, 0
    v_mov_b32 v26, 0
    v_mov_b32 v27, 0
    v_mov_b32 v28, 0
    v_mov_b32 v29, 0x3f803f80
    s_cmp_ge_u32 s58, 32
    s_cbranch_scc1 L_qkv1_kernel_vpath_6
    s_cmp_lt_u32 s58, 16
    s_cselect_b32 s55, 0x3eb8aa3b, 1.0
    s_mov_b32 s36, s24
    s_and_b32 s37, s25, 0xffff
    s_mov_b32 s38, 0x00600000
    s_mov_b32 s39, 0x00020000
    s_lshl_b32 s56, s58, 17
    s_lshl_b32 s51, s48, 11
    s_add_u32 s56, s56, s51
    s_waitcnt vmcnt(6)
    s_barrier
    ds_read_b128 v[96:99], v88 offset:0
    ds_read_b128 v[100:103], v88 offset:32768
    ds_read_b128 v[104:107], v89 offset:0
    ds_read_b128 v[108:111], v89 offset:32768
    s_waitcnt vmcnt(5)
    ds_read_b64_tr_b16 v[16:17], v8 offset:0
    ds_read_b64_tr_b16 v[18:19], v8 offset:256
    s_add_u32 m0, s59, 6144
    s_add_u32 s60, s52, 294912
    buffer_load_dwordx4 v7, s[32:35], s60 offen lds
    ds_read_b128 v[112:115], v90 offset:0
    ds_read_b128 v[116:119], v90 offset:32768
    s_waitcnt vmcnt(5)
    ds_read_b64_tr_b16 v[20:21], v8 offset:1024
    ds_read_b64_tr_b16 v[22:23], v8 offset:1280
    s_waitcnt lgkmcnt(4)
    v_mfma_f32_32x32x16_bf16 v[32:47], v[16:19], v[96:99], v[32:47]
    v_mfma_f32_32x32x16_bf16 v[48:63], v[16:19], v[100:103], v[48:63]
    v_dot2_f32_bf16 v28, v16, v29, v28
    v_dot2_f32_bf16 v28, v17, v29, v28
    v_dot2_f32_bf16 v28, v18, v29, v28
    v_dot2_f32_bf16 v28, v19, v29, v28
    s_cmp_lg_u32 s50, 0
    s_cbranch_scc1 L_qkv1_kernel_st_7
    v_dot2_f32_bf16 v24, v96, v29, v24
    v_dot2_f32_bf16 v25, v96, v96, v25
    v_dot2_f32_bf16 v24, v97, v29, v24
    v_dot2_f32_bf16 v25, v97, v97, v25
    v_dot2_f32_bf16 v24, v98, v29, v24
    v_dot2_f32_bf16 v25, v98, v98, v25
    v_dot2_f32_bf16 v24, v99, v29, v24
    v_dot2_f32_bf16 v25, v99, v99, v25
    v_dot2_f32_bf16 v26, v100, v29, v26
    v_dot2_f32_bf16 v27, v100, v100, v27
    v_dot2_f32_bf16 v26, v101, v29, v26
    v_dot2_f32_bf16 v27, v101, v101, v27
    v_dot2_f32_bf16 v26, v102, v29, v26
    v_dot2_f32_bf16 v27, v102, v102, v27
    v_dot2_f32_bf16 v26, v103, v29, v26
    v_dot2_f32_bf16 v27, v103, v103, v27
L_qkv1_kernel_st_7:
    s_add_u32 m0, s59, 7168
    s_add_u32 s60, s52, 344064
    buffer_load_dwordx4 v7, s[32:35], s60 offen lds
    ds_read_b128 v[120:123], v91 offset:0
    ds_read_b128 v[124:127], v91 offset:32768
    s_waitcnt vmcnt(5)
    ds_read_b64_tr_b16 v[16:17], v8 offset:2048
    ds_read_b64_tr_b16 v[18:19], v8 offset:2304
    s_waitcnt lgkmcnt(4)
    v_mfma_f32_32x32x16_bf16 v[32:47], v[20:23], v[104:107], v[32:47]
    v_mfma_f32_32x32x16_bf16 v[48:63], v[20:23], v[108:111], v[48:63]
    v_dot2_f32_bf16 v28, v20, v29, v28
    v_dot2_f32_bf16 v28, v21, v29, v28
    v_dot2_f32_bf16 v28, v22, v29, v28
    v_dot2_f32_bf16 v28, v23, v29, v28
    s_cmp_lg_u32 s50, 1
    s_cbranch_scc1 L_qkv1_kernel_st_8
    v_dot2_f32_bf16 v24, v104, v29, v24
    v_dot2_f32_bf16 v25, v104, v104, v25
    v_dot2_f32_bf16 v24, v105, v29, v24
    v_dot2_f32_bf16 v25, v105, v105, v25
    v_dot2_f32_bf16 v24, v106, v29, v24
    v_dot2_f32_bf16 v25, v106, v106, v25
    v_dot2_f32_bf16 v24, v107, v29, v24
    v_dot2_f32_bf16 v25, v107, v107, v25
    v_dot2_f32_bf16 v26, v108, v29, v26
    v_dot2_f32_bf16 v27, v108, v108, v27
    v_dot2_f32_bf16 v26, v109, v29, v26
    v_dot2_f32_bf16 v27, v109, v109, v27
    v_dot2_f32_bf16 v26, v110, v29, v26
    v_dot2_f32_bf16 v27, v110, v110, v27
    v_dot2_f32_bf16 v26, v111, v29, v26
    v_dot2_f32_bf16 v27, v111, v111, v27
L_qkv1_kernel_st_8:
    s_add_u32 m0, s59, 0
    s_add_u32 s60, s52, 393216
    buffer_load_dwordx4 v7, s[32:35], s60 offen lds
    ds_read_b128 v[96:99], v92 offset:0
    ds_read_b128 v[100:103], v92 offset:32768
    s_waitcnt vmcnt(5)
    ds_read_b64_tr_b16 v[20:21], v8 offset:3072
    ds_read_b64_tr_b16 v[22:23], v8 offset:3328
    s_waitcnt lgkmcnt(4)
    v_mfma_f32_32x32x16_bf16 v[32:47], v[16:19], v[112:115], v[32:47]
    v_mfma_f32_32x32x16_bf16 v[48:63], v[16:19], v[116:119], v[48:63]
    v_dot2_f32_bf16 v28, v16, v29, v28
    v_dot2_f32_bf16 v28, v17, v29, v28
    v_dot2_f32_bf16 v28, v18, v29, v28
    v_dot2_f32_bf16 v28, v19, v29, v28
    s_cmp_lg_u32 s50, 2
    s_cbranch_scc1 L_qkv1_kernel_st_9
    v_dot2_f32_bf16 v24, v112, v29, v24
    v_dot2_f32_bf16 v25, v112, v112, v25
    v_dot2_f32_bf16 v24, v113, v29, v24
    v_dot2_f32_bf16 v25, v113, v113, v25
    v_dot2_f32_bf16 v24, v114, v29, v24
    v_dot2_f32_bf16 v25, v114, v114, v25
    v_dot2_f32_bf16 v24, v115, v29, v24
    v_dot2_f32_bf16 v25, v115, v115, v25
    v_dot2_f32_bf16 v26, v116, v29, v26
    v_dot2_f32_bf16 v27, v116, v116, v27
    v_dot2_f32_bf16 v26, v117, v29, v26
    v_dot2_f32_bf16 v27, v117, v117, v27
    v_dot2_f32_bf16 v26, v118, v29, v26
    v_dot2_f32_bf16 v27, v118, v118, v27
    v_dot2_f32_bf16 v26, v119, v29, v26
    v_dot2_f32_bf16 v27, v119, v119, v27
L_qkv1_kernel_st_9:
    s_add_u32 m0, s59, 1024
    s_add_u32 s60, s52, 442368
    buffer_load_dwordx4 v7, s[32:35], s60 offen lds
    ds_read_b128 v[104:107], v93 offset:0
    ds_read_b128 v[108:111], v93 offset:32768
    s_waitcnt vmcnt(5)
    ds_read_b64_tr_b16 v[16:17], v8 offset:4096
    ds_read_b64_tr_b16 v[18:19], v8 offset:4352
    s_waitcnt lgkmcnt(4)
    v_mfma_f32_32x32x16_bf16 v[32:47], v[20:23], v[120:123], v[32:47]
    v_mfma_f32_32x32x16_bf16 v[48:63], v[20:23], v[124:127], v[48:63]
    v_dot2_f32_bf16 v28, v20, v29, v28
    v_dot2_f32_bf16 v28, v21, v29, v28
    v_dot2_f32_bf16 v28, v22, v29, v28
    v_dot2_f32_bf16 v28, v23, v29, v28
    s_cmp_lg_u32 s50, 3
    s_cbranch_scc1 L_qkv1_kernel_st_10
    v_dot2_f32_bf16 v24, v120, v29, v24
    v_dot2_f32_bf16 v25, v120, v120, v25
    v_dot2_f32_bf16 v24, v121, v29, v24
    v_dot2_f32_bf16 v25, v121, v121, v25
    v_dot2_f32_bf16 v24, v122, v29, v24
    v_dot2_f32_bf16 v25, v122, v122, v25
    v_dot2_f32_bf16 v24, v123, v29, v24
    v_dot2_f32_bf16 v25, v123, v123, v25
    v_dot2_f32_bf16 v26, v124, v29, v26
    v_dot2_f32_bf16 v27, v124, v124, v27
    v_dot2_f32_bf16 v26, v125, v29, v26
    v_dot2_f32_bf16 v27, v125, v125, v27
    v_dot2_f32_bf16 v26, v126, v29, v26
    v_dot2_f32_bf16 v27, v126, v126, v27
    v_dot2_f32_bf16 v26, v127, v29, v26
    v_dot2_f32_bf16 v27, v127, v127, v27
L_qkv1_kernel_st_10:
    s_add_u32 m0, s59, 2048
    s_add_u32 s60, s52, 491520
    buffer_load_dwordx4 v7, s[32:35], s60 offen lds
    ds_read_b128 v[112:115], v94 offset:0
    ds_read_b128 v[116:119], v94 offset:32768
    s_waitcnt vmcnt(5)
    ds_read_b64_tr_b16 v[20:21], v8 offset:5120
    ds_read_b64_tr_b16 v[22:23], v8 offset:5376
    s_waitcnt lgkmcnt(4)
    v_mfma_f32_32x32x16_bf16 v[32:47], v[16:19], v[96:99], v[32:47]
    v_mfma_f32_32x32x16_bf16 v[48:63], v[16:19], v[100:103], v[48:63]
    v_dot2_f32_bf16 v28, v16, v29, v28
    v_dot2_f32_bf16 v28, v17, v29, v28
    v_dot2_f32_bf16 v28, v18, v29, v28
    v_dot2_f32_bf16 v28, v19, v29, v28
    s_cmp_lg_u32 s50, 4
    s_cbranch_scc1 L_qkv1_kernel_st_11
    v_dot2_f32_bf16 v24, v96, v29, v24
    v_dot2_f32_bf16 v25, v96, v96, v25
    v_dot2_f32_bf16 v24, v97, v29, v24
    v_dot2_f32_bf16 v25, v97, v97, v25
    v_dot2_f32_bf16 v24, v98, v29, v24
    v_dot2_f32_bf16 v25, v98, v98, v25
    v_dot2_f32_bf16 v24, v99, v29, v24
    v_dot2_f32_bf16 v25, v99, v99, v25
    v_dot2_f32_bf16 v26, v100, v29, v26
    v_dot2_f32_bf16 v27, v100, v100, v27
    v_dot2_f32_bf16 v26, v101, v29, v26
    v_dot2_f32_bf16 v27, v101, v101, v27
    v_dot2_f32_bf16 v26, v102, v29, v26
    v_dot2_f32_bf16 v27, v102, v102, v27
    v_dot2_f32_bf16 v26, v103, v29, v26
    v_dot2_f32_bf16 v27, v103, v103, v27
L_qkv1_kernel_st_11:
    s_add_u32 m0, s59, 3072
    s_add_u32 s60, s52, 540672
    buffer_load_dwordx4 v7, s[32:35], s60 offen lds
    ds_read_b128 v[120:123], v95 offset:0
    ds_read_b128 v[124:127], v95 offset:32768
    s_waitcnt vmcnt(5)
    ds_read_b64_tr_b16 v[16:17], v8 offset:6144
    ds_read_b64_tr_b16 v[18:19], v8 offset:6400
    s_waitcnt lgkmcnt(4)
    v_mfma_f32_32x32x16_bf16 v[32:47], v[20:23], v[104:107], v[32:47]
    v_mfma_f32_32x32x16_bf16 v[48:63], v[20:23], v[108:111], v[48:63]
    v_dot2_f32_bf16 v28, v20, v29, v28
    v_dot2_f32_bf16 v28, v21, v29, v28
    v_dot2_f32_bf16 v28, v22, v29, v28
    v_dot2_f32_bf16 v28, v23, v29, v28
    s_cmp_lg_u32 s50, 5
    s_cbranch_scc1 L_qkv1_kernel_st_12
    v_dot2_f32_bf16 v24, v104, v29, v24
    v_dot2_f32_bf16 v25, v104, v104, v25
    v_dot2_f32_bf16 v24, v105, v29, v24
    v_dot2_f32_bf16 v25, v105, v105, v25
    v_dot2_f32_bf16 v24, v106, v29, v24
    v_dot2_f32_bf16 v25, v106, v106, v25
    v_dot2_f32_bf16 v24, v107, v29, v24
    v_dot2_f32_bf16 v25, v107, v107, v25
    v_dot2_f32_bf16 v26, v108, v29, v26
    v_dot2_f32_bf16 v27, v108, v108, v27
    v_dot2_f32_bf16 v26, v109, v29, v26
    v_dot2_f32_bf16 v27, v109, v109, v27
    v_dot2_f32_bf16 v26, v110, v29, v26
    v_dot2_f32_bf16 v27, v110, v110, v27
    v_dot2_f32_bf16 v26, v111, v29, v26
    v_dot2_f32_bf16 v27, v111, v111, v27
L_qkv1_kernel_st_12:
    s_add_u32 m0, s59, 4096
    s_add_u32 s60, s52, 589824
    buffer_load_dwordx4 v7, s[32:35], s60 offen lds
    ds_read_b128 v[96:99], v88 offset:256
    ds_read_b128 v[100:103], v88 offset:33024
    s_waitcnt vmcnt(5)
    ds_read_b64_tr_b16 v[20:21], v8 offset:7168
    ds_read_b64_tr_b16 v[22:23], v8 offset:7424
    s_waitcnt lgkmcnt(4)
    v_mfma_f32_32x32x16_bf16 v[32:47], v[16:19], v[112:115], v[32:47]
    v_mfma_f32_32x32x16_bf16 v[48:63], v[16:19], v[116:119], v[48:63]
    v_dot2_f32_bf16 v28, v16, v29, v28
    v_dot2_f32_bf16 v28, v17, v29, v28
    v_dot2_f32_bf16 v28, v18, v29, v28
    v_dot2_f32_bf16 v28, v19, v29, v28
    s_cmp_lg_u32 s50, 6
    s_cbranch_scc1 L_qkv1_kernel_st_13
    v_dot2_f32_bf16 v24, v112, v29, v24
    v_dot2_f32_bf16 v25, v112, v112, v25
    v_dot2_f32_bf16 v24, v113, v29, v24
    v_dot2_f32_bf16 v25, v113, v113, v25
    v_dot2_f32_bf16 v24, v114, v29, v24
    v_dot2_f32_bf16 v25, v114, v114, v25
    v_dot2_f32_bf16 v24, v115, v29, v24
    v_dot2_f32_bf16 v25, v115, v115, v25
    v_dot2_f32_bf16 v26, v116, v29, v26
    v_dot2_f32_bf16 v27, v116, v116, v27
    v_dot2_f32_bf16 v26, v117, v29, v26
    v_dot2_f32_bf16 v27, v117, v117, v27
    v_dot2_f32_bf16 v26, v118, v29, v26
    v_dot2_f32_bf16 v27, v118, v118, v27
    v_dot2_f32_bf16 v26, v119, v29, v26
    v_dot2_f32_bf16 v27, v119, v119, v27
L_qkv1_kernel_st_13:
    s_add_u32 m0, s59, 5120
    s_add_u32 s60, s52, 638976
    buffer_load_dwordx4 v7, s[32:35], s60 offen lds
    ds_read_b128 v[104:107], v89 offset:256
    ds_read_b128 v[108:111], v89 offset:33024
    s_waitcnt vmcnt(5)
    ds_read_b64_tr_b16 v[16:17], v8 offset:0
    ds_read_b64_tr_b16 v[18:19], v8 offset:256
    s_waitcnt lgkmcnt(4)
    v_mfma_f32_32x32x16_bf16 v[32:47], v[20:23], v[120:123], v[32:47]
    v_mfma_f32_32x32x16_bf16 v[48:63], v[20:23], v[124:127], v[48:63]
    v_dot2_f32_bf16 v28, v20, v29, v28
    v_dot2_f32_bf16 v28, v21, v29, v28
    v_dot2_f32_bf16 v28, v22, v29, v28
    v_dot2_f32_bf16 v28, v23, v29, v28
    s_cmp_lg_u32 s50, 7
    s_cbranch_scc1 L_qkv1_kernel_st_14
    v_dot2_f32_bf16 v24, v120, v29, v24
    v_dot2_f32_bf16 v25, v120, v120, v25
    v_dot2_f32_bf16 v24, v121, v29, v24
    v_dot2_f32_bf16 v25, v121, v121, v25
    v_dot2_f32_bf16 v24, v122, v29, v24
    v_dot2_f32_bf16 v25, v122, v122, v25
    v_dot2_f32_bf16 v24, v123, v29, v24
    v_dot2_f32_bf16 v25, v123, v123, v25
    v_dot2_f32_bf16 v26, v124, v29, v26
    v_dot2_f32_bf16 v27, v124, v124, v27
    v_dot2_f32_bf16 v26, v125, v29, v26
    v_dot2_f32_bf16 v27, v125, v125, v27
    v_dot2_f32_bf16 v26, v126, v29, v26
    v_dot2_f32_bf16 v27, v126, v126, v27
    v_dot2_f32_bf16 v26, v127, v29, v26
    v_dot2_f32_bf16 v27, v127, v127, v27
L_qkv1_kernel_st_14:
    s_add_u32 m0, s59, 6144
    s_add_u32 s60, s52, 688128
    buffer_load_dwordx4 v7, s[32:35], s60 offen lds
    ds_read_b128 v[112:115], v90 offset:256
    ds_read_b128 v[116:119], v90 offset:33024
    s_waitcnt vmcnt(5)
    ds_read_b64_tr_b16 v[20:21], v8 offset:1024
    ds_read_b64_tr_b16 v[22:23], v8 offset:1280
    s_waitcnt lgkmcnt(4)
    v_mfma_f32_32x32x16_bf16 v[32:47], v[16:19], v[96:99], v[32:47]
    v_mfma_f32_32x32x16_bf16 v[48:63], v[16:19], v[100:103], v[48:63]
    v_dot2_f32_bf16 v28, v16, v29, v28
    v_dot2_f32_bf16 v28, v17, v29, v28
    v_dot2_f32_bf16 v28, v18, v29, v28
    v_dot2_f32_bf16 v28, v19, v29, v28
    s_cmp_lg_u32 s50, 0
    s_cbranch_scc1 L_qkv1_kernel_st_15
    v_dot2_f32_bf16 v24, v96, v29, v24
    v_dot2_f32_bf16 v25, v96, v96, v25
    v_dot2_f32_bf16 v24, v97, v29, v24
    v_dot2_f32_bf16 v25, v97, v97, v25
    v_dot2_f32_bf16 v24, v98, v29, v24
    v_dot2_f32_bf16 v25, v98, v98, v25
    v_dot2_f32_bf16 v24, v99, v29, v24
    v_dot2_f32_bf16 v25, v99, v99, v25
    v_dot2_f32_bf16 v26, v100, v29, v26
    v_dot2_f32_bf16 v27, v100, v100, v27
    v_dot2_f32_bf16 v26, v101, v29, v26
    v_dot2_f32_bf16 v27, v101, v101, v27
    v_dot2_f32_bf16 v26, v102, v29, v26
    v_dot2_f32_bf16 v27, v102, v102, v27
    v_dot2_f32_bf16 v26, v103, v29, v26
    v_dot2_f32_bf16 v27, v103, v103, v27
L_qkv1_kernel_st_15:
    s_add_u32 m0, s59, 7168
    s_add_u32 s60, s52, 737280
    buffer_load_dwordx4 v7, s[32:35], s60 offen lds
    ds_read_b128 v[120:123], v91 offset:256
    ds_read_b128 v[124:127], v91 offset:33024
    s_waitcnt vmcnt(5)
    ds_read_b64_tr_b16 v[16:17], v8 offset:2048
    ds_read_b64_tr_b16 v[18:19], v8 offset:2304
    s_waitcnt lgkmcnt(4)
    v_mfma_f32_32x32x16_bf16 v[32:47], v[20:23], v[104:107], v[32:47]
    v_mfma_f32_32x32x16_bf16 v[48:63], v[20:23], v[108:111], v[48:63]
    v_dot2_f32_bf16 v28, v20, v29, v28
    v_dot2_f32_bf16 v28, v21, v29, v28
    v_dot2_f32_bf16 v28, v22, v29, v28
    v_dot2_f32_bf16 v28, v23, v29, v28
    s_cmp_lg_u32 s50, 1
    s_cbranch_scc1 L_qkv1_kernel_st_16
    v_dot2_f32_bf16 v24, v104, v29, v24
    v_dot2_f32_bf16 v25, v104, v104, v25
    v_dot2_f32_bf16 v24, v105, v29, v24
    v_dot2_f32_bf16 v25, v105, v105, v25
    v_dot2_f32_bf16 v24, v106, v29, v24
    v_dot2_f32_bf16 v25, v106, v106, v25
    v_dot2_f32_bf16 v24, v107, v29, v24
    v_dot2_f32_bf16 v25, v107, v107, v25
    v_dot2_f32_bf16 v26, v108, v29, v26
    v_dot2_f32_bf16 v27, v108, v108, v27
    v_dot2_f32_bf16 v26, v109, v29, v26
    v_dot2_f32_bf16 v27, v109, v109, v27
    v_dot2_f32_bf16 v26, v110, v29, v26
    v_dot2_f32_bf16 v27, v110, v110, v27
    v_dot2_f32_bf16 v26, v111, v29, v26
    v_dot2_f32_bf16 v27, v111, v111, v27
L_qkv1_kernel_st_16:
    s_add_u32 m0, s59, 0
    s_add_u32 s60, s52, 786432
    buffer_load_dwordx4 v7, s[32:35], s60 offen lds
    ds_read_b128 v[96:99], v92 offset:256
    ds_read_b128 v[100:103], v92 offset:33024
    s_waitcnt vmcnt(5)
    ds_read_b64_tr_b16 v[20:21], v8 offset:3072
    ds_read_b64_tr_b16 v[22:23], v8 offset:3328
    s_waitcnt lgkmcnt(4)
    v_mfma_f32_32x32x16_bf16 v[32:47], v[16:19], v[112:115], v[32:47]
    v_mfma_f32_32x32x16_bf16 v[48:63], v[16:19], v[116:119], v[48:63]
    v_dot2_f32_bf16 v28, v16, v29, v28
    v_dot2_f32_bf16 v28, v17, v29, v28
    v_dot2_f32_bf16 v28, v18, v29, v28
    v_dot2_f32_bf16 v28, v19, v29, v28
    s_cmp_lg_u32 s50, 2
    s_cbranch_scc1 L_qkv1_kernel_st_17
    v_dot2_f32_bf16 v24, v112, v29, v24
    v_dot2_f32_bf16 v25, v112, v112, v25
    v_dot2_f32_bf16 v24, v113, v29, v24
    v_dot2_f32_bf16 v25, v113, v113, v25
    v_dot2_f32_bf16 v24, v114, v29, v24
    v_dot2_f32_bf16 v25, v114, v114, v25
    v_dot2_f32_bf16 v24, v115, v29, v24
    v_dot2_f32_bf16 v25, v115, v115, v25
    v_dot2_f32_bf16 v26, v116, v29, v26
    v_dot2_f32_bf16 v27, v116, v116, v27
    v_dot2_f32_bf16 v26, v117, v29, v26
    v_dot2_f32_bf16 v27, v117, v117, v27
    v_dot2_f32_bf16 v26, v118, v29, v26
    v_dot2_f32_bf16 v27, v118, v118, v27
    v_dot2_f32_bf16 v26, v119, v29, v26
    v_dot2_f32_bf16 v27, v119, v119, v27
L_qkv1_kernel_st_17:
    s_add_u32 m0, s59, 1024
    s_add_u32 s60, s52, 835584
    buffer_load_dwordx4 v7, s[32:35], s60 offen lds
    ds_read_b128 v[104:107], v93 offset:256
    ds_read_b128 v[108:111], v93 offset:33024
    s_waitcnt vmcnt(5)
    ds_read_b64_tr_b16 v[16:17], v8 offset:4096
    ds_read_b64_tr_b16 v[18:19], v8 offset:4352
    s_waitcnt lgkmcnt(4)
    v_mfma_f32_32x32x16_bf16 v[32:47], v[20:23], v[120:123], v[32:47]
    v_mfma_f32_32x32x16_bf16 v[48:63], v[20:23], v[124:127], v[48:63]
    v_dot2_f32_bf16 v28, v20, v29, v28
    v_dot2_f32_bf16 v28, v21, v29, v28
    v_dot2_f32_bf16 v28, v22, v29, v28
    v_dot2_f32_bf16 v28, v23, v29, v28
    s_cmp_lg_u32 s50, 3
    s_cbranch_scc1 L_qkv1_kernel_st_18
    v_dot2_f32_bf16 v24, v120, v29, v24
    v_dot2_f32_bf16 v25, v120, v120, v25
    v_dot2_f32_bf16 v24, v121, v29, v24
    v_dot2_f32_bf16 v25, v121, v121, v25
    v_dot2_f32_bf16 v24, v122, v29, v24
    v_dot2_f32_bf16 v25, v122, v122, v25
    v_dot2_f32_bf16 v24, v123, v29, v24
    v_dot2_f32_bf16 v25, v123, v123, v25
    v_dot2_f32_bf16 v26, v124, v29, v26
    v_dot2_f32_bf16 v27, v124, v124, v27
    v_dot2_f32_bf16 v26, v125, v29, v26
    v_dot2_f32_bf16 v27, v125, v125, v27
    v_dot2_f32_bf16 v26, v126, v29, v26
    v_dot2_f32_bf16 v27, v126, v126, v27
    v_dot2_f32_bf16 v26, v127, v29, v26
    v_dot2_f32_bf16 v27, v127, v127, v27
L_qkv1_kernel_st_18:
    s_add_u32 m0, s59, 2048
    s_add_u32 s60, s52, 884736
    buffer_load_dwordx4 v7, s[32:35], s60 offen lds
    ds_read_b128 v[112:115], v94 offset:256
    ds_read_b128 v[116:119], v94 offset:33024
    s_waitcnt vmcnt(5)
    ds_read_b64_tr_b16 v[20:21], v8 offset:5120
    ds_read_b64_tr_b16 v[22:23], v8 offset:5376
    s_waitcnt lgkmcnt(4)
    v_mfma_f32_32x32x16_bf16 v[32:47], v[16:19], v[96:99], v[32:47]
    v_mfma_f32_32x32x16_bf16 v[48:63], v[16:19], v[100:103], v[48:63]
    v_dot2_f32_bf16 v28, v16, v29, v28
    v_dot2_f32_bf16 v28, v17, v29, v28
    v_dot2_f32_bf16 v28, v18, v29, v28
    v_dot2_f32_bf16 v28, v19, v29, v28
    s_cmp_lg_u32 s50, 4
    s_cbranch_scc1 L_qkv1_kernel_st_19
    v_dot2_f32_bf16 v24, v96, v29, v24
    v_dot2_f32_bf16 v25, v96, v96, v25
    v_dot2_f32_bf16 v24, v97, v29, v24
    v_dot2_f32_bf16 v25, v97, v97, v25
    v_dot2_f32_bf16 v24, v98, v29, v24
    v_dot2_f32_bf16 v25, v98, v98, v25
    v_dot2_f32_bf16 v24, v99, v29, v24
    v_dot2_f32_bf16 v25, v99, v99, v25
    v_dot2_f32_bf16 v26, v100, v29, v26
    v_dot2_f32_bf16 v27, v100, v100, v27
    v_dot2_f32_bf16 v26, v101, v29, v26
    v_dot2_f32_bf16 v27, v101, v101, v27
    v_dot2_f32_bf16 v26, v102, v29, v26
    v_dot2_f32_bf16 v27, v102, v102, v27
    v_dot2_f32_bf16 v26, v103, v29, v26
    v_dot2_f32_bf16 v27, v103, v103, v27
L_qkv1_kernel_st_19:
    s_add_u32 m0, s59, 3072
    s_add_u32 s60, s52, 933888
    buffer_load_dwordx4 v7, s[32:35], s60 offen lds
    ds_read_b128 v[120:123], v95 offset:256
    ds_read_b128 v[124:127], v95 offset:33024
    s_waitcnt vmcnt(5)
    ds_read_b64_tr_b16 v[16:17], v8 offset:6144
    ds_read_b64_tr_b16 v[18:19], v8 offset:6400
    s_waitcnt lgkmcnt(4)
    v_mfma_f32_32x32x16_bf16 v[32:47], v[20:23], v[104:107], v[32:47]
    v_mfma_f32_32x32x16_bf16 v[48:63], v[20:23], v[108:111], v[48:63]
    v_dot2_f32_bf16 v28, v20, v29, v28
    v_dot2_f32_bf16 v28, v21, v29, v28
    v_dot2_f32_bf16 v28, v22, v29, v28
    v_dot2_f32_bf16 v28, v23, v29, v28
    s_cmp_lg_u32 s50, 5
    s_cbranch_scc1 L_qkv1_kernel_st_20
    v_dot2_f32_bf16 v24, v104, v29, v24
    v_dot2_f32_bf16 v25, v104, v104, v25
    v_dot2_f32_bf16 v24, v105, v29, v24
    v_dot2_f32_bf16 v25, v105, v105, v25
    v_dot2_f32_bf16 v24, v106, v29, v24
    v_dot2_f32_bf16 v25, v106, v106, v25
    v_dot2_f32_bf16 v24, v107, v29, v24
    v_dot2_f32_bf16 v25, v107, v107, v25
    v_dot2_f32_bf16 v26, v108, v29, v26
    v_dot2_f32_bf16 v27, v108, v108, v27
    v_dot2_f32_bf16 v26, v109, v29, v26
    v_dot2_f32_bf16 v27, v109, v109, v27
    v_dot2_f32_bf16 v26, v110, v29, v26
    v_dot2_f32_bf16 v27, v110, v110, v27
    v_dot2_f32_bf16 v26, v111, v29, v26
    v_dot2_f32_bf16 v27, v111, v111, v27
L_qkv1_kernel_st_20:
    s_add_u32 m0, s59, 4096
    s_add_u32 s60, s52, 983040
    buffer_load_dwordx4 v7, s[32:35], s60 offen lds
    ds_read_b128 v[96:99], v88 offset:512
    ds_read_b128 v[100:103], v88 offset:33280
    s_waitcnt vmcnt(5)
    ds_read_b64_tr_b16 v[20:21], v8 offset:7168
    ds_read_b64_tr_b16 v[22:23], v8 offset:7424
    s_waitcnt lgkmcnt(4)
    v_mfma_f32_32x32x16_bf16 v[32:47], v[16:19], v[112:115], v[32:47]
    v_mfma_f32_32x32x16_bf16 v[48:63], v[16:19], v[116:119], v[48:63]
    v_dot2_f32_bf16 v28, v16, v29, v28
    v_dot2_f32_bf16 v28, v17, v29, v28
    v_dot2_f32_bf16 v28, v18, v29, v28
    v_dot2_f32_bf16 v28, v19, v29, v28
    s_cmp_lg_u32 s50, 6
    s_cbranch_scc1 L_qkv1_kernel_st_21
    v_dot2_f32_bf16 v24, v112, v29, v24
    v_dot2_f32_bf16 v25, v112, v112, v25
    v_dot2_f32_bf16 v24, v113, v29, v24
    v_dot2_f32_bf16 v25, v113, v113, v25
    v_dot2_f32_bf16 v24, v114, v29, v24
    v_dot2_f32_bf16 v25, v114, v114, v25
    v_dot2_f32_bf16 v24, v115, v29, v24
    v_dot2_f32_bf16 v25, v115, v115, v25
    v_dot2_f32_bf16 v26, v116, v29, v26
    v_dot2_f32_bf16 v27, v116, v116, v27
    v_dot2_f32_bf16 v26, v117, v29, v26
    v_dot2_f32_bf16 v27, v117, v117, v27
    v_dot2_f32_bf16 v26, v118, v29, v26
    v_dot2_f32_bf16 v27, v118, v118, v27
    v_dot2_f32_bf16 v26, v119, v29, v26
    v_dot2_f32_bf16 v27, v119, v119, v27
L_qkv1_kernel_st_21:
    s_add_u32 m0, s59, 5120
    s_add_u32 s60, s52, 1032192
    buffer_load_dwordx4 v7, s[32:35], s60 offen lds
    ds_read_b128 v[104:107], v89 offset:512
    ds_read_b128 v[108:111], v89 offset:33280
    s_waitcnt vmcnt(5)
    ds_read_b64_tr_b16 v[16:17], v8 offset:0
    ds_read_b64_tr_b16 v[18:19], v8 offset:256
    s_waitcnt lgkmcnt(4)
    v_mfma_f32_32x32x16_bf16 v[32:47], v[20:23], v[120:123], v[32:47]
    v_mfma_f32_32x32x16_bf16 v[48:63], v[20:23], v[124:127], v[48:63]
    v_dot2_f32_bf16 v28, v20, v29, v28
    v_dot2_f32_bf16 v28, v21, v29, v28
    v_dot2_f32_bf16 v28, v22, v29, v28
    v_dot2_f32_bf16 v28, v23, v29, v28
    s_cmp_lg_u32 s50, 7
    s_cbranch_scc1 L_qkv1_kernel_st_22
    v_dot2_f32_bf16 v24, v120, v29, v24
    v_dot2_f32_bf16 v25, v120, v120, v25
    v_dot2_f32_bf16 v24, v121, v29, v24
    v_dot2_f32_bf16 v25, v121, v121, v25
    v_dot2_f32_bf16 v24, v122, v29, v24
    v_dot2_f32_bf16 v25, v122, v122, v25
    v_dot2_f32_bf16 v24, v123, v29, v24
    v_dot2_f32_bf16 v25, v123, v123, v25
    v_dot2_f32_bf16 v26, v124, v29, v26
    v_dot2_f32_bf16 v27, v124, v124, v27
    v_dot2_f32_bf16 v26, v125, v29, v26
    v_dot2_f32_bf16 v27, v125, v125, v27
    v_dot2_f32_bf16 v26, v126, v29, v26
    v_dot2_f32_bf16 v27, v126, v126, v27
    v_dot2_f32_bf16 v26, v127, v29, v26
    v_dot2_f32_bf16 v27, v127, v127, v27
L_qkv1_kernel_st_22:
    s_add_u32 m0, s59, 6144
    s_add_u32 s60, s52, 1081344
    buffer_load_dwordx4 v7, s[32:35], s60 offen lds
    ds_read_b128 v[112:115], v90 offset:512
    ds_read_b128 v[116:119], v90 offset:33280
    s_waitcnt vmcnt(5)
    ds_read_b64_tr_b16 v[20:21], v8 offset:1024
    ds_read_b64_tr_b16 v[22:23], v8 offset:1280
    s_waitcnt lgkmcnt(4)
    v_mfma_f32_32x32x16_bf16 v[32:47], v[16:19], v[96:99], v[32:47]
    v_mfma_f32_32x32x16_bf16 v[48:63], v[16:19], v[100:103], v[48:63]
    v_dot2_f32_bf16 v28, v16, v29, v28
    v_dot2_f32_bf16 v28, v17, v29, v28
    v_dot2_f32_bf16 v28, v18, v29, v28
    v_dot2_f32_bf16 v28, v19, v29, v28
    s_cmp_lg_u32 s50, 0
    s_cbranch_scc1 L_qkv1_kernel_st_23
    v_dot2_f32_bf16 v24, v96, v29, v24
    v_dot2_f32_bf16 v25, v96, v96, v25
    v_dot2_f32_bf16 v24, v97, v29, v24
    v_dot2_f32_bf16 v25, v97, v97, v25
    v_dot2_f32_bf16 v24, v98, v29, v24
    v_dot2_f32_bf16 v25, v98, v98, v25
    v_dot2_f32_bf16 v24, v99, v29, v24
    v_dot2_f32_bf16 v25, v99, v99, v25
    v_dot2_f32_bf16 v26, v100, v29, v26
    v_dot2_f32_bf16 v27, v100, v100, v27
    v_dot2_f32_bf16 v26, v101, v29, v26
    v_dot2_f32_bf16 v27, v101, v101, v27
    v_dot2_f32_bf16 v26, v102, v29, v26
    v_dot2_f32_bf16 v27, v102, v102, v27
    v_dot2_f32_bf16 v26, v103, v29, v26
    v_dot2_f32_bf16 v27, v103, v103, v27
L_qkv1_kernel_st_23:
    s_add_u32 m0, s59, 7168
    s_add_u32 s60, s52, 1130496
    buffer_load_dwordx4 v7, s[32:35], s60 offen lds
    ds_read_b128 v[120:123], v91 offset:512
    ds_read_b128 v[124:127], v91 offset:33280
    s_waitcnt vmcnt(5)
    ds_read_b64_tr_b16 v[16:17], v8 offset:2048
    ds_read_b64_tr_b16 v[18:19], v8 offset:2304
    s_waitcnt lgkmcnt(4)
    v_mfma_f32_32x32x16_bf16 v[32:47], v[20:23], v[104:107], v[32:47]
    v_mfma_f32_32x32x16_bf16 v[48:63], v[20:23], v[108:111], v[48:63]
    v_dot2_f32_bf16 v28, v20, v29, v28
    v_dot2_f32_bf16 v28, v21, v29, v28
    v_dot2_f32_bf16 v28, v22, v29, v28
    v_dot2_f32_bf16 v28, v23, v29, v28
    s_cmp_lg_u32 s50, 1
    s_cbranch_scc1 L_qkv1_kernel_st_24
    v_dot2_f32_bf16 v24, v104, v29, v24
    v_dot2_f32_bf16 v25, v104, v104, v25
    v_dot2_f32_bf16 v24, v105, v29, v24
    v_dot2_f32_bf16 v25, v105, v105, v25
    v_dot2_f32_bf16 v24, v106, v29, v24
    v_dot2_f32_bf16 v25, v106, v106, v25
    v_dot2_f32_bf16 v24, v107, v29, v24
    v_dot2_f32_bf16 v25, v107, v107, v25
    v_dot2_f32_bf16 v26, v108, v29, v26
    v_dot2_f32_bf16 v27, v108, v108, v27
    v_dot2_f32_bf16 v26, v109, v29, v26
    v_dot2_f32_bf16 v27, v109, v109, v27
    v_dot2_f32_bf16 v26, v110, v29, v26
    v_dot2_f32_bf16 v27, v110, v110, v27
    v_dot2_f32_bf16 v26, v111, v29, v26
    v_dot2_f32_bf16 v27, v111, v111, v27
L_qkv1_kernel_st_24:
    s_add_u32 m0, s59, 0
    s_add_u32 s60, s52, 1179648
    buffer_load_dwordx4 v7, s[32:35], s60 offen lds
    ds_read_b128 v[96:99], v92 offset:512
    ds_read_b128 v[100:103], v92 offset:33280
    s_waitcnt vmcnt(5)
    ds_read_b64_tr_b16 v[20:21], v8 offset:3072
    ds_read_b64_tr_b16 v[22:23], v8 offset:3328
    s_waitcnt lgkmcnt(4)
    v_mfma_f32_32x32x16_bf16 v[32:47], v[16:19], v[112:115], v[32:47]
    v_mfma_f32_32x32x16_bf16 v[48:63], v[16:19], v[116:119], v[48:63]
    v_dot2_f32_bf16 v28, v16, v29, v28
    v_dot2_f32_bf16 v28, v17, v29, v28
    v_dot2_f32_bf16 v28, v18, v29, v28
    v_dot2_f32_bf16 v28, v19, v29, v28
    s_cmp_lg_u32 s50, 2
    s_cbranch_scc1 L_qkv1_kernel_st_25
    v_dot2_f32_bf16 v24, v112, v29, v24
    v_dot2_f32_bf16 v25, v112, v112, v25
    v_dot2_f32_bf16 v24, v113, v29, v24
    v_dot2_f32_bf16 v25, v113, v113, v25
    v_dot2_f32_bf16 v24, v114, v29, v24
    v_dot2_f32_bf16 v25, v114, v114, v25
    v_dot2_f32_bf16 v24, v115, v29, v24
    v_dot2_f32_bf16 v25, v115, v115, v25
    v_dot2_f32_bf16 v26, v116, v29, v26
    v_dot2_f32_bf16 v27, v116, v116, v27
    v_dot2_f32_bf16 v26, v117, v29, v26
    v_dot2_f32_bf16 v27, v117, v117, v27
    v_dot2_f32_bf16 v26, v118, v29, v26
    v_dot2_f32_bf16 v27, v118, v118, v27
    v_dot2_f32_bf16 v26, v119, v29, v26
    v_dot2_f32_bf16 v27, v119, v119, v27
L_qkv1_kernel_st_25:
    s_add_u32 m0, s59, 1024
    s_add_u32 s60, s52, 1228800
    buffer_load_dwordx4 v7, s[32:35], s60 offen lds
    ds_read_b128 v[104:107], v93 offset:512
    ds_read_b128 v[108:111], v93 offset:33280
    s_waitcnt vmcnt(5)
    ds_read_b64_tr_b16 v[16:17], v8 offset:4096
    ds_read_b64_tr_b16 v[18:19], v8 offset:4352
    s_waitcnt lgkmcnt(4)
    v_mfma_f32_32x32x16_bf16 v[32:47], v[20:23], v[120:123], v[32:47]
    v_mfma_f32_32x32x16_bf16 v[48:63], v[20:23], v[124:127], v[48:63]
    v_dot2_f32_bf16 v28, v20, v29, v28
    v_dot2_f32_bf16 v28, v21, v29, v28
    v_dot2_f32_bf16 v28, v22, v29, v28
    v_dot2_f32_bf16 v28, v23, v29, v28
    s_cmp_lg_u32 s50, 3
    s_cbranch_scc1 L_qkv1_kernel_st_26
    v_dot2_f32_bf16 v24, v120, v29, v24
    v_dot2_f32_bf16 v25, v120, v120, v25
    v_dot2_f32_bf16 v24, v121, v29, v24
    v_dot2_f32_bf16 v25, v121, v121, v25
    v_dot2_f32_bf16 v24, v122, v29, v24
    v_dot2_f32_bf16 v25, v122, v122, v25
    v_dot2_f32_bf16 v24, v123, v29, v24
    v_dot2_f32_bf16 v25, v123, v123, v25
    v_dot2_f32_bf16 v26, v124, v29, v26
    v_dot2_f32_bf16 v27, v124, v124, v27
    v_dot2_f32_bf16 v26, v125, v29, v26
    v_dot2_f32_bf16 v27, v125, v125, v27
    v_dot2_f32_bf16 v26, v126, v29, v26
    v_dot2_f32_bf16 v27, v126, v126, v27
    v_dot2_f32_bf16 v26, v127, v29, v26
    v_dot2_f32_bf16 v27, v127, v127, v27
L_qkv1_kernel_st_26:
    s_add_u32 m0, s59, 2048
    s_add_u32 s60, s52, 1277952
    buffer_load_dwordx4 v7, s[32:35], s60 offen lds
    ds_read_b128 v[112:115], v94 offset:512
    ds_read_b128 v[116:119], v94 offset:33280
    s_waitcnt vmcnt(5)
    ds_read_b64_tr_b16 v[20:21], v8 offset:5120
    ds_read_b64_tr_b16 v[22:23], v8 offset:5376
    s_waitcnt lgkmcnt(4)
    v_mfma_f32_32x32x16_bf16 v[32:47], v[16:19], v[96:99], v[32:47]
    v_mfma_f32_32x32x16_bf16 v[48:63], v[16:19], v[100:103], v[48:63]
    v_dot2_f32_bf16 v28, v16, v29, v28
    v_dot2_f32_bf16 v28, v17, v29, v28
    v_dot2_f32_bf16 v28, v18, v29, v28
    v_dot2_f32_bf16 v28, v19, v29, v28
    s_cmp_lg_u32 s50, 4
    s_cbranch_scc1 L_qkv1_kernel_st_27
    v_dot2_f32_bf16 v24, v96, v29, v24
    v_dot2_f32_bf16 v25, v96, v96, v25
    v_dot2_f32_bf16 v24, v97, v29, v24
    v_dot2_f32_bf16 v25, v97, v97, v25
    v_dot2_f32_bf16 v24, v98, v29, v24
    v_dot2_f32_bf16 v25, v98, v98, v25
    v_dot2_f32_bf16 v24, v99, v29, v24
    v_dot2_f32_bf16 v25, v99, v99, v25
    v_dot2_f32_bf16 v26, v100, v29, v26
    v_dot2_f32_bf16 v27, v100, v100, v27
    v_dot2_f32_bf16 v26, v101, v29, v26
    v_dot2_f32_bf16 v27, v101, v101, v27
    v_dot2_f32_bf16 v26, v102, v29, v26
    v_dot2_f32_bf16 v27, v102, v102, v27
    v_dot2_f32_bf16 v26, v103, v29, v26
    v_dot2_f32_bf16 v27, v103, v103, v27
L_qkv1_kernel_st_27:
    s_add_u32 m0, s59, 3072
    s_add_u32 s60, s52, 1327104
    buffer_load_dwordx4 v7, s[32:35], s60 offen lds
    ds_read_b128 v[120:123], v95 offset:512
    ds_read_b128 v[124:127], v95 offset:33280
    s_waitcnt vmcnt(5)
    ds_read_b64_tr_b16 v[16:17], v8 offset:6144
    ds_read_b64_tr_b16 v[18:19], v8 offset:6400
    s_waitcnt lgkmcnt(4)
    v_mfma_f32_32x32x16_bf16 v[32:47], v[20:23], v[104:107], v[32:47]
    v_mfma_f32_32x32x16_bf16 v[48:63], v[20:23], v[108:111], v[48:63]
    v_dot2_f32_bf16 v28, v20, v29, v28
    v_dot2_f32_bf16 v28, v21, v29, v28
    v_dot2_f32_bf16 v28, v22, v29, v28
    v_dot2_f32_bf16 v28, v23, v29, v28
    s_cmp_lg_u32 s50, 5
    s_cbranch_scc1 L_qkv1_kernel_st_28
    v_dot2_f32_bf16 v24, v104, v29, v24
    v_dot2_f32_bf16 v25, v104, v104, v25
    v_dot2_f32_bf16 v24, v105, v29, v24
    v_dot2_f32_bf16 v25, v105, v105, v25
    v_dot2_f32_bf16 v24, v106, v29, v24
    v_dot2_f32_bf16 v25, v106, v106, v25
    v_dot2_f32_bf16 v24, v107, v29, v24
    v_dot2_f32_bf16 v25, v107, v107, v25
    v_dot2_f32_bf16 v26, v108, v29, v26
    v_dot2_f32_bf16 v27, v108, v108, v27
    v_dot2_f32_bf16 v26, v109, v29, v26
    v_dot2_f32_bf16 v27, v109, v109, v27
    v_dot2_f32_bf16 v26, v110, v29, v26
    v_dot2_f32_bf16 v27, v110, v110, v27
    v_dot2_f32_bf16 v26, v111, v29, v26
    v_dot2_f32_bf16 v27, v111, v111, v27
L_qkv1_kernel_st_28:
    s_add_u32 m0, s59, 4096
    s_add_u32 s60, s52, 1376256
    buffer_load_dwordx4 v7, s[32:35], s60 offen lds
    ds_read_b128 v[96:99], v88 offset:768
    ds_read_b128 v[100:103], v88 offset:33536
    s_waitcnt vmcnt(5)
    ds_read_b64_tr_b16 v[20:21], v8 offset:7168
    ds_read_b64_tr_b16 v[22:23], v8 offset:7424
    s_waitcnt lgkmcnt(4)
    v_mfma_f32_32x32x16_bf16 v[32:47], v[16:19], v[112:115], v[32:47]
    v_mfma_f32_32x32x16_bf16 v[48:63], v[16:19], v[116:119], v[48:63]
    v_dot2_f32_bf16 v28, v16, v29, v28
    v_dot2_f32_bf16 v28, v17, v29, v28
    v_dot2_f32_bf16 v28, v18, v29, v28
    v_dot2_f32_bf16 v28, v19, v29, v28
    s_cmp_lg_u32 s50, 6
    s_cbranch_scc1 L_qkv1_kernel_st_29
    v_dot2_f32_bf16 v24, v112, v29, v24
    v_dot2_f32_bf16 v25, v112, v112, v25
    v_dot2_f32_bf16 v24, v113, v29, v24
    v_dot2_f32_bf16 v25, v113, v113, v25
    v_dot2_f32_bf16 v24, v114, v29, v24
    v_dot2_f32_bf16 v25, v114, v114, v25
    v_dot2_f32_bf16 v24, v115, v29, v24
    v_dot2_f32_bf16 v25, v115, v115, v25
    v_dot2_f32_bf16 v26, v116, v29, v26
    v_dot2_f32_bf16 v27, v116, v116, v27
    v_dot2_f32_bf16 v26, v117, v29, v26
    v_dot2_f32_bf16 v27, v117, v117, v27
    v_dot2_f32_bf16 v26, v118, v29, v26
    v_dot2_f32_bf16 v27, v118, v118, v27
    v_dot2_f32_bf16 v26, v119, v29, v26
    v_dot2_f32_bf16 v27, v119, v119, v27
L_qkv1_kernel_st_29:
    s_add_u32 m0, s59, 5120
    s_add_u32 s60, s52, 1425408
    buffer_load_dwordx4 v7, s[32:35], s60 offen lds
    ds_read_b128 v[104:107], v89 offset:768
    ds_read_b128 v[108:111], v89 offset:33536
    s_waitcnt vmcnt(5)
    ds_read_b64_tr_b16 v[16:17], v8 offset:0
    ds_read_b64_tr_b16 v[18:19], v8 offset:256
    s_waitcnt lgkmcnt(4)
    v_mfma_f32_32x32x16_bf16 v[32:47], v[20:23], v[120:123], v[32:47]
    v_mfma_f32_32x32x16_bf16 v[48:63], v[20:23], v[124:127], v[48:63]
    v_dot2_f32_bf16 v28, v20, v29, v28
    v_dot2_f32_bf16 v28, v21, v29, v28
    v_dot2_f32_bf16 v28, v22, v29, v28
    v_dot2_f32_bf16 v28, v23, v29, v28
    s_cmp_lg_u32 s50, 7
    s_cbranch_scc1 L_qkv1_kernel_st_30
    v_dot2_f32_bf16 v24, v120, v29, v24
    v_dot2_f32_bf16 v25, v120, v120, v25
    v_dot2_f32_bf16 v24, v121, v29, v24
    v_dot2_f32_bf16 v25, v121, v121, v25
    v_dot2_f32_bf16 v24, v122, v29, v24
    v_dot2_f32_bf16 v25, v122, v122, v25
    v_dot2_f32_bf16 v24, v123, v29, v24
    v_dot2_f32_bf16 v25, v123, v123, v25
    v_dot2_f32_bf16 v26, v124, v29, v26
    v_dot2_f32_bf16 v27, v124, v124, v27
    v_dot2_f32_bf16 v26, v125, v29, v26
    v_dot2_f32_bf16 v27, v125, v125, v27
    v_dot2_f32_bf16 v26, v126, v29, v26
    v_dot2_f32_bf16 v27, v126, v126, v27
    v_dot2_f32_bf16 v26, v127, v29, v26
    v_dot2_f32_bf16 v27, v127, v127, v27
L_qkv1_kernel_st_30:
    s_add_u32 m0, s59, 6144
    s_add_u32 s60, s52, 1474560
    buffer_load_dwordx4 v7, s[32:35], s60 offen lds
    ds_read_b128 v[112:115], v90 offset:768
    ds_read_b128 v[116:119], v90 offset:33536
    s_waitcnt vmcnt(5)
    ds_read_b64_tr_b16 v[20:21], v8 offset:1024
    ds_read_b64_tr_b16 v[22:23], v8 offset:1280
    s_waitcnt lgkmcnt(4)
    v_mfma_f32_32x32x16_bf16 v[32:47], v[16:19], v[96:99], v[32:47]
    v_mfma_f32_32x32x16_bf16 v[48:63], v[16:19], v[100:103], v[48:63]
    v_dot2_f32_bf16 v28, v16, v29, v28
    v_dot2_f32_bf16 v28, v17, v29, v28
    v_dot2_f32_bf16 v28, v18, v29, v28
    v_dot2_f32_bf16 v28, v19, v29, v28
    s_cmp_lg_u32 s50, 0
    s_cbranch_scc1 L_qkv1_kernel_st_31
    v_dot2_f32_bf16 v24, v96, v29, v24
    v_dot2_f32_bf16 v25, v96, v96, v25
    v_dot2_f32_bf16 v24, v97, v29, v24
    v_dot2_f32_bf16 v25, v97, v97, v25
    v_dot2_f32_bf16 v24, v98, v29, v24
    v_dot2_f32_bf16 v25, v98, v98, v25
    v_dot2_f32_bf16 v24, v99, v29, v24
    v_dot2_f32_bf16 v25, v99, v99, v25
    v_dot2_f32_bf16 v26, v100, v29, v26
    v_dot2_f32_bf16 v27, v100, v100, v27
    v_dot2_f32_bf16 v26, v101, v29, v26
    v_dot2_f32_bf16 v27, v101, v101, v27
    v_dot2_f32_bf16 v26, v102, v29, v26
    v_dot2_f32_bf16 v27, v102, v102, v27
    v_dot2_f32_bf16 v26, v103, v29, v26
    v_dot2_f32_bf16 v27, v103, v103, v27
L_qkv1_kernel_st_31:
    s_add_u32 m0, s59, 7168
    s_add_u32 s60, s52, 1523712
    buffer_load_dwordx4 v7, s[32:35], s60 offen lds
    ds_read_b128 v[120:123], v91 offset:768
    ds_read_b128 v[124:127], v91 offset:33536
    s_waitcnt vmcnt(5)
    ds_read_b64_tr_b16 v[16:17], v8 offset:2048
    ds_read_b64_tr_b16 v[18:19], v8 offset:2304
    s_waitcnt lgkmcnt(4)
    v_mfma_f32_32x32x16_bf16 v[32:47], v[20:23], v[104:107], v[32:47]
    v_mfma_f32_32x32x16_bf16 v[48:63], v[20:23], v[108:111], v[48:63]
    v_dot2_f32_bf16 v28, v20, v29, v28
    v_dot2_f32_bf16 v28, v21, v29, v28
    v_dot2_f32_bf16 v28, v22, v29, v28
    v_dot2_f32_bf16 v28, v23, v29, v28
    s_cmp_lg_u32 s50, 1
    s_cbranch_scc1 L_qkv1_kernel_st_32
    v_dot2_f32_bf16 v24, v104, v29, v24
    v_dot2_f32_bf16 v25, v104, v104, v25
    v_dot2_f32_bf16 v24, v105, v29, v24
    v_dot2_f32_bf16 v25, v105, v105, v25
    v_dot2_f32_bf16 v24, v106, v29, v24
    v_dot2_f32_bf16 v25, v106, v106, v25
    v_dot2_f32_bf16 v24, v107, v29, v24
    v_dot2_f32_bf16 v25, v107, v107, v25
    v_dot2_f32_bf16 v26, v108, v29, v26
    v_dot2_f32_bf16 v27, v108, v108, v27
    v_dot2_f32_bf16 v26, v109, v29, v26
    v_dot2_f32_bf16 v27, v109, v109, v27
    v_dot2_f32_bf16 v26, v110, v29, v26
    v_dot2_f32_bf16 v27, v110, v110, v27
    v_dot2_f32_bf16 v26, v111, v29, v26
    v_dot2_f32_bf16 v27, v111, v111, v27
L_qkv1_kernel_st_32:
    ds_read_b128 v[96:99], v92 offset:768
    ds_read_b128 v[100:103], v92 offset:33536
    s_waitcnt vmcnt(4)
    ds_read_b64_tr_b16 v[20:21], v8 offset:3072
    ds_read_b64_tr_b16 v[22:23], v8 offset:3328
    s_waitcnt lgkmcnt(4)
    v_mfma_f32_32x32x16_bf16 v[32:47], v[16:19], v[112:115], v[32:47]
    v_mfma_f32_32x32x16_bf16 v[48:63], v[16:19], v[116:119], v[48:63]
    v_dot2_f32_bf16 v28, v16, v29, v28
    v_dot2_f32_bf16 v28, v17, v29, v28
    v_dot2_f32_bf16 v28, v18, v29, v28
    v_dot2_f32_bf16 v28, v19, v29, v28
    s_cmp_lg_u32 s50, 2
    s_cbranch_scc1 L_qkv1_kernel_st_33
    v_dot2_f32_bf16 v24, v112, v29, v24
    v_dot2_f32_bf16 v25, v112, v112, v25
    v_dot2_f32_bf16 v24, v113, v29, v24
    v_dot2_f32_bf16 v25, v113, v113, v25
    v_dot2_f32_bf16 v24, v114, v29, v24
    v_dot2_f32_bf16 v25, v114, v114, v25
    v_dot2_f32_bf16 v24, v115, v29, v24
    v_dot2_f32_bf16 v25, v115, v115, v25
    v_dot2_f32_bf16 v26, v116, v29, v26
    v_dot2_f32_bf16 v27, v116, v116, v27
    v_dot2_f32_bf16 v26, v117, v29, v26
    v_dot2_f32_bf16 v27, v117, v117, v27
    v_dot2_f32_bf16 v26, v118, v29, v26
    v_dot2_f32_bf16 v27, v118, v118, v27
    v_dot2_f32_bf16 v26, v119, v29, v26
    v_dot2_f32_bf16 v27, v119, v119, v27
L_qkv1_kernel_st_33:
    ds_read_b128 v[104:107], v93 offset:768
    ds_read_b128 v[108:111], v93 offset:33536
    s_waitcnt vmcnt(3)
    ds_read_b64_tr_b16 v[16:17], v8 offset:4096
    ds_read_b64_tr_b16 v[18:19], v8 offset:4352
    s_waitcnt lgkmcnt(4)
    v_mfma_f32_32x32x16_bf16 v[32:47], v[20:23], v[120:123], v[32:47]
    v_mfma_f32_32x32x16_bf16 v[48:63], v[20:23], v[124:127], v[48:63]
    v_dot2_f32_bf16 v28, v20, v29, v28
    v_dot2_f32_bf16 v28, v21, v29, v28
    v_dot2_f32_bf16 v28, v22, v29, v28
    v_dot2_f32_bf16 v28, v23, v29, v28
    s_cmp_lg_u32 s50, 3
    s_cbranch_scc1 L_qkv1_kernel_st_34
    v_dot2_f32_bf16 v24, v120, v29, v24
    v_dot2_f32_bf16 v25, v120, v120, v25
    v_dot2_f32_bf16 v24, v121, v29, v24
    v_dot2_f32_bf16 v25, v121, v121, v25
    v_dot2_f32_bf16 v24, v122, v29, v24
    v_dot2_f32_bf16 v25, v122, v122, v25
    v_dot2_f32_bf16 v24, v123, v29, v24
    v_dot2_f32_bf16 v25, v123, v123, v25
    v_dot2_f32_bf16 v26, v124, v29, v26
    v_dot2_f32_bf16 v27, v124, v124, v27
    v_dot2_f32_bf16 v26, v125, v29, v26
    v_dot2_f32_bf16 v27, v125, v125, v27
    v_dot2_f32_bf16 v26, v126, v29, v26
    v_dot2_f32_bf16 v27, v126, v126, v27
    v_dot2_f32_bf16 v26, v127, v29, v26
    v_dot2_f32_bf16 v27, v127, v127, v27
L_qkv1_kernel_st_34:
    ds_read_b128 v[112:115], v94 offset:768
    ds_read_b128 v[116:119], v94 offset:33536
    s_waitcnt vmcnt(2)
    ds_read_b64_tr_b16 v[20:21], v8 offset:5120
    ds_read_b64_tr_b16 v[22:23], v8 offset:5376
    s_waitcnt lgkmcnt(4)
    v_mfma_f32_32x32x16_bf16 v[32:47], v[16:19], v[96:99], v[32:47]
    v_mfma_f32_32x32x16_bf16 v[48:63], v[16:19], v[100:103], v[48:63]
    v_dot2_f32_bf16 v28, v16, v29, v28
    v_dot2_f32_bf16 v28, v17, v29, v28
    v_dot2_f32_bf16 v28, v18, v29, v28
    v_dot2_f32_bf16 v28, v19, v29, v28
    s_cmp_lg_u32 s50, 4
    s_cbranch_scc1 L_qkv1_kernel_st_35
    v_dot2_f32_bf16 v24, v96, v29, v24
    v_dot2_f32_bf16 v25, v96, v96, v25
    v_dot2_f32_bf16 v24, v97, v29, v24
    v_dot2_f32_bf16 v25, v97, v97, v25
    v_dot2_f32_bf16 v24, v98, v29, v24
    v_dot2_f32_bf16 v25, v98, v98, v25
    v_dot2_f32_bf16 v24, v99, v29, v24
    v_dot2_f32_bf16 v25, v99, v99, v25
    v_dot2_f32_bf16 v26, v100, v29, v26
    v_dot2_f32_bf16 v27, v100, v100, v27
    v_dot2_f32_bf16 v26, v101, v29, v26
    v_dot2_f32_bf16 v27, v101, v101, v27
    v_dot2_f32_bf16 v26, v102, v29, v26
    v_dot2_f32_bf16 v27, v102, v102, v27
    v_dot2_f32_bf16 v26, v103, v29, v26
    v_dot2_f32_bf16 v27, v103, v103, v27
L_qkv1_kernel_st_35:
    ds_read_b128 v[120:123], v95 offset:768
    ds_read_b128 v[124:127], v95 offset:33536
    s_waitcnt vmcnt(1)
    ds_read_b64_tr_b16 v[16:17], v8 offset:6144
    ds_read_b64_tr_b16 v[18:19], v8 offset:6400
    s_waitcnt lgkmcnt(4)
    v_mfma_f32_32x32x16_bf16 v[32:47], v[20:23], v[104:107], v[32:47]
    v_mfma_f32_32x32x16_bf16 v[48:63], v[20:23], v[108:111], v[48:63]
    v_dot2_f32_bf16 v28, v20, v29, v28
    v_dot2_f32_bf16 v28, v21, v29, v28
    v_dot2_f32_bf16 v28, v22, v29, v28
    v_dot2_f32_bf16 v28, v23, v29, v28
    s_cmp_lg_u32 s50, 5
    s_cbranch_scc1 L_qkv1_kernel_st_36
    v_dot2_f32_bf16 v24, v104, v29, v24
    v_dot2_f32_bf16 v25, v104, v104, v25
    v_dot2_f32_bf16 v24, v105, v29, v24
    v_dot2_f32_bf16 v25, v105, v105, v25
    v_dot2_f32_bf16 v24, v106, v29, v24
    v_dot2_f32_bf16 v25, v106, v106, v25
    v_dot2_f32_bf16 v24, v107, v29, v24
    v_dot2_f32_bf16 v25, v107, v107, v25
    v_dot2_f32_bf16 v26, v108, v29, v26
    v_dot2_f32_bf16 v27, v108, v108, v27
    v_dot2_f32_bf16 v26, v109, v29, v26
    v_dot2_f32_bf16 v27, v109, v109, v27
    v_dot2_f32_bf16 v26, v110, v29, v26
    v_dot2_f32_bf16 v27, v110, v110, v27
    v_dot2_f32_bf16 v26, v111, v29, v26
    v_dot2_f32_bf16 v27, v111, v111, v27
L_qkv1_kernel_st_36:
    s_waitcnt vmcnt(0)
    ds_read_b64_tr_b16 v[20:21], v8 offset:7168
    ds_read_b64_tr_b16 v[22:23], v8 offset:7424
    s_waitcnt lgkmcnt(2)
    v_mfma_f32_32x32x16_bf16 v[32:47], v[16:19], v[112:115], v[32:47]
    v_mfma_f32_32x32x16_bf16 v[48:63], v[16:19], v[116:119], v[48:63]
    v_dot2_f32_bf16 v28, v16, v29, v28
    v_dot2_f32_bf16 v28, v17, v29, v28
    v_dot2_f32_bf16 v28, v18, v29, v28
    v_dot2_f32_bf16 v28, v19, v29, v28
    s_cmp_lg_u32 s50, 6
    s_cbranch_scc1 L_qkv1_kernel_st_37
    v_dot2_f32_bf16 v24, v112, v29, v24
    v_dot2_f32_bf16 v25, v112, v112, v25
    v_dot2_f32_bf16 v24, v113, v29, v24
    v_dot2_f32_bf16 v25, v113, v113, v25
    v_dot2_f32_bf16 v24, v114, v29, v24
    v_dot2_f32_bf16 v25, v114, v114, v25
    v_dot2_f32_bf16 v24, v115, v29, v24
    v_dot2_f32_bf16 v25, v115, v115, v25
    v_dot2_f32_bf16 v26, v116, v29, v26
    v_dot2_f32_bf16 v27, v116, v116, v27
    v_dot2_f32_bf16 v26, v117, v29, v26
    v_dot2_f32_bf16 v27, v117, v117, v27
    v_dot2_f32_bf16 v26, v118, v29, v26
    v_dot2_f32_bf16 v27, v118, v118, v27
    v_dot2_f32_bf16 v26, v119, v29, v26
    v_dot2_f32_bf16 v27, v119, v119, v27
L_qkv1_kernel_st_37:
    s_waitcnt lgkmcnt(0)
    v_mfma_f32_32x32x16_bf16 v[32:47], v[20:23], v[120:123], v[32:47]
    v_mfma_f32_32x32x16_bf16 v[48:63], v[20:23], v[124:127], v[48:63]
    v_dot2_f32_bf16 v28, v20, v29, v28
    v_dot2_f32_bf16 v28, v21, v29, v28
    v_dot2_f32_bf16 v28, v22, v29, v28
    v_dot2_f32_bf16 v28, v23, v29, v28
    s_cmp_lg_u32 s50, 7
    s_cbranch_scc1 L_qkv1_kernel_st_38
    v_dot2_f32_bf16 v24, v120, v29, v24
    v_dot2_f32_bf16 v25, v120, v120, v25
    v_dot2_f32_bf16 v24, v121, v29, v24
    v_dot2_f32_bf16 v25, v121, v121, v25
    v_dot2_f32_bf16 v24, v122, v29, v24
    v_dot2_f32_bf16 v25, v122, v122, v25
    v_dot2_f32_bf16 v24, v123, v29, v24
    v_dot2_f32_bf16 v25, v123, v123, v25
    v_dot2_f32_bf16 v26, v124, v29, v26
    v_dot2_f32_bf16 v27, v124, v124, v27
    v_dot2_f32_bf16 v26, v125, v29, v26
    v_dot2_f32_bf16 v27, v125, v125, v27
    v_dot2_f32_bf16 v26, v126, v29, v26
    v_dot2_f32_bf16 v27, v126, v126, v27
    v_dot2_f32_bf16 v26, v127, v29, v26
    v_dot2_f32_bf16 v27, v127, v127, v27
L_qkv1_kernel_st_38:
    s_nop 3
    v_lshlrev_b32 v30, 4, v4
    v_lshl_add_u32 v30, v5, 3, v30
    s_lshl_b32 s51, s50, 10
    s_add_u32 s51, s51, 131072
    v_add_u32 v30, s51, v30
    ds_write_b64 v30, v[24:25]
    ds_write_b64 v30, v[26:27] offset:512
    v_mov_b32 v31, v28
    s_nop 1
    v_permlane32_swap_b32 v28, v31
    s_nop 1
    v_add_f32 v28, v28, v31
    v_lshlrev_b32 v31, 2, v4
    s_lshl_b32 s51, s50, 7
    s_add_u32 s51, s51, 139776
    v_add_u32 v31, s51, v31
    ds_write_b32 v31, v28
    s_waitcnt lgkmcnt(0)
    s_barrier
    v_lshrrev_b32 v30, 3, v1
    v_and_b32 v31, 7, v1
    v_lshlrev_b32 v31, 10, v31
    v_lshl_add_u32 v31, v30, 4, v31
    s_lshl_b32 s51, s50, 7
    s_add_u32 s51, s51, 131072
    v_add_u32 v31, s51, v31
    ds_read_b128 v[64:67], v31
    s_waitcnt lgkmcnt(0)
    v_pk_add_f32 v[24:25], v[64:65], v[66:67]
    s_nop 1
    v_add_f32_dpp v24, v24, v24 quad_perm:[1,0,3,2] row_mask:0xf bank_mask:0xf
    v_add_f32_dpp v25, v25, v25 quad_perm:[1,0,3,2] row_mask:0xf bank_mask:0xf
    s_nop 1
    v_add_f32_dpp v24, v24, v24 quad_perm:[2,3,0,1] row_mask:0xf bank_mask:0xf
    v_add_f32_dpp v25, v25, v25 quad_perm:[2,3,0,1] row_mask:0xf bank_mask:0xf
    s_nop 1
    v_add_f32_dpp v24, v24, v24 row_half_mirror row_mask:0xf bank_mask:0xf
    v_add_f32_dpp v25, v25, v25 row_half_mirror row_mask:0xf bank_mask:0xf
    v_mul_f32 v27, 0x3b000000, v24
    v_mul_f32 v26, 0x3b000000, v25
    v_fma_f32 v26, -v27, v27, v26
    v_max_f32 v26, 0, v26
    v_cvt_pk_bf16_f32 v24, v27, v26
    v_lshlrev_b32 v27, 16, v24
    v_and_b32 v26, 0xffff0000, v24
    v_add_f32 v26, 0x3727c5ac, v26
    v_cvt_pk_bf16_f32 v24, v26, v26
    v_and_b32 v26, 0xffff0000, v24
    v_sqrt_f32 v26, v26
    s_nop 0
    v_cvt_pk_bf16_f32 v24, v26, v26
    v_and_b32 v26, 0xffff0000, v24
    v_rcp_f32 v26, v26
    s_nop 0
    v_mul_f32 v27, v27, v26
    v_sub_f32 v27, 0, v27
    v_lshlrev_b32 v30, 3, v30
    s_lshl_b32 s51, s50, 6
    s_add_u32 s51, s51, 139264
    v_add_u32 v30, s51, v30
    ds_write_b64 v30, v[26:27]
    s_waitcnt lgkmcnt(0)
    s_barrier
    v_lshlrev_b32 v30, 3, v4
    v_add_u32 v30, 139264, v30
    ds_read_b64 v[24:25], v30
    ds_read_b64 v[26:27], v30 offset:256
    v_lshlrev_b32 v31, 4, v5
    s_lshl_b32 s51, s50, 7
    s_add_u32 s51, s51, 139776
    v_add_u32 v31, s51, v31
    ds_read_b128 v[96:99], v31 offset:0
    ds_read_b128 v[100:103], v31 offset:32
    ds_read_b128 v[104:107], v31 offset:64
    ds_read_b128 v[108:111], v31 offset:96
    v_lshlrev_b32 v7, 4, v4
    v_lshl_add_u32 v7, v5, 3, v7
    s_waitcnt lgkmcnt(0)
    v_mul_f32 v24, s55, v24
    v_mul_f32 v25, s55, v25
    v_mul_f32 v26, s55, v26
    v_mul_f32 v27, s55, v27
    v_mov_b32 v64, v24
    v_mov_b32 v65, v24
    v_mov_b32 v66, v25
    v_mov_b32 v67, v25
    v_mov_b32 v68, v26
    v_mov_b32 v69, v26
    v_mov_b32 v70, v27
    v_mov_b32 v71, v27
    v_pk_mul_f32 v[32:33], v[32:33], v[64:65]
    v_pk_mul_f32 v[34:35], v[34:35], v[64:65]
    v_pk_fma_f32 v[32:33], v[96:97], v[66:67], v[32:33]
    v_pk_fma_f32 v[34:35], v[98:99], v[66:67], v[34:35]
    v_cvt_pk_bf16_f32 v72, v32, v33
    v_cvt_pk_bf16_f32 v73, v34, v35
    s_add_u32 s51, s56, 0
    buffer_store_dwordx2 v[72:73], v7, s[36:39], s51 offen
    v_pk_mul_f32 v[36:37], v[36:37], v[64:65]
    v_pk_mul_f32 v[38:39], v[38:39], v[64:65]
    v_pk_fma_f32 v[36:37], v[100:101], v[66:67], v[36:37]
    v_pk_fma_f32 v[38:39], v[102:103], v[66:67], v[38:39]
    v_cvt_pk_bf16_f32 v74, v36, v37
    v_cvt_pk_bf16_f32 v75, v38, v39
    s_add_u32 s51, s56, 512
    buffer_store_dwordx2 v[74:75], v7, s[36:39], s51 offen
    v_pk_mul_f32 v[40:41], v[40:41], v[64:65]
    v_pk_mul_f32 v[42:43], v[42:43], v[64:65]
    v_pk_fma_f32 v[40:41], v[104:105], v[66:67], v[40:41]
    v_pk_fma_f32 v[42:43], v[106:107], v[66:67], v[42:43]
    v_cvt_pk_bf16_f32 v76, v40, v41
    v_cvt_pk_bf16_f32 v77, v42, v43
    s_add_u32 s51, s56, 65536
    buffer_store_dwordx2 v[76:77], v7, s[36:39], s51 offen
    v_pk_mul_f32 v[44:45], v[44:45], v[64:65]
    v_pk_mul_f32 v[46:47], v[46:47], v[64:65]
    v_pk_fma_f32 v[44:45], v[108:109], v[66:67], v[44:45]
    v_pk_fma_f32 v[46:47], v[110:111], v[66:67], v[46:47]
    v_cvt_pk_bf16_f32 v78, v44, v45
    v_cvt_pk_bf16_f32 v79, v46, v47
    s_add_u32 s51, s56, 66048
    buffer_store_dwordx2 v[78:79], v7, s[36:39], s51 offen
    v_pk_mul_f32 v[48:49], v[48:49], v[68:69]
    v_pk_mul_f32 v[50:51], v[50:51], v[68:69]
    v_pk_fma_f32 v[48:49], v[96:97], v[70:71], v[48:49]
    v_pk_fma_f32 v[50:51], v[98:99], v[70:71], v[50:51]
    v_cvt_pk_bf16_f32 v72, v48, v49
    v_cvt_pk_bf16_f32 v73, v50, v51
    s_add_u32 s51, s56, 1024
    buffer_store_dwordx2 v[72:73], v7, s[36:39], s51 offen
    v_pk_mul_f32 v[52:53], v[52:53], v[68:69]
    v_pk_mul_f32 v[54:55], v[54:55], v[68:69]
    v_pk_fma_f32 v[52:53], v[100:101], v[70:71], v[52:53]
    v_pk_fma_f32 v[54:55], v[102:103], v[70:71], v[54:55]
    v_cvt_pk_bf16_f32 v74, v52, v53
    v_cvt_pk_bf16_f32 v75, v54, v55
    s_add_u32 s51, s56, 1536
    buffer_store_dwordx2 v[74:75], v7, s[36:39], s51 offen
    v_pk_mul_f32 v[56:57], v[56:57], v[68:69]
    v_pk_mul_f32 v[58:59], v[58:59], v[68:69]
    v_pk_fma_f32 v[56:57], v[104:105], v[70:71], v[56:57]
    v_pk_fma_f32 v[58:59], v[106:107], v[70:71], v[58:59]
    v_cvt_pk_bf16_f32 v76, v56, v57
    v_cvt_pk_bf16_f32 v77, v58, v59
    s_add_u32 s51, s56, 66560
    buffer_store_dwordx2 v[76:77], v7, s[36:39], s51 offen
    v_pk_mul_f32 v[60:61], v[60:61], v[68:69]
    v_pk_mul_f32 v[62:63], v[62:63], v[68:69]
    v_pk_fma_f32 v[60:61], v[108:109], v[70:71], v[60:61]
    v_pk_fma_f32 v[62:63], v[110:111], v[70:71], v[62:63]
    v_cvt_pk_bf16_f32 v78, v60, v61
    v_cvt_pk_bf16_f32 v79, v62, v63
    s_add_u32 s51, s56, 67072
    buffer_store_dwordx2 v[78:79], v7, s[36:39], s51 offen
    s_endpgm
L_qkv1_kernel_vpath_6:
    s_add_u32 s36, s24, 0x00400000
    s_addc_u32 s37, s25, 0
    s_and_b32 s37, s37, 0xffff
    s_mov_b32 s38, 0x00200000
    s_mov_b32 s39, 0x00020000
    s_sub_u32 s51, s58, 32
    s_lshl_b32 s56, s51, 17
    s_lshl_b32 s51, s48, 11
    s_add_u32 s56, s56, s51
    s_waitcnt vmcnt(6)
    s_barrier
    ds_read_b128 v[96:99], v88 offset:0
    ds_read_b128 v[100:103], v88 offset:32768
    ds_read_b128 v[104:107], v89 offset:0
    ds_read_b128 v[108:111], v89 offset:32768
    s_waitcnt vmcnt(5)
    ds_read_b64_tr_b16 v[16:17], v8 offset:0
    ds_read_b64_tr_b16 v[18:19], v8 offset:256
    s_add_u32 m0, s59, 6144
    s_add_u32 s60, s52, 294912
    buffer_load_dwordx4 v7, s[32:35], s60 offen lds
    ds_read_b128 v[112:115], v90 offset:0
    ds_read_b128 v[116:119], v90 offset:32768
    s_waitcnt vmcnt(5)
    ds_read_b64_tr_b16 v[20:21], v8 offset:1024
    ds_read_b64_tr_b16 v[22:23], v8 offset:1280
    s_waitcnt lgkmcnt(4)
    v_mfma_f32_32x32x16_bf16 v[32:47], v[96:99], v[16:19], v[32:47]
    v_mfma_f32_32x32x16_bf16 v[48:63], v[100:103], v[16:19], v[48:63]
    v_dot2_f32_bf16 v28, v16, v29, v28
    v_dot2_f32_bf16 v28, v17, v29, v28
    v_dot2_f32_bf16 v28, v18, v29, v28
    v_dot2_f32_bf16 v28, v19, v29, v28
    s_cmp_lg_u32 s50, 0
    s_cbranch_scc1 L_qkv1_kernel_st_39
    v_dot2_f32_bf16 v24, v96, v29, v24
    v_dot2_f32_bf16 v25, v96, v96, v25
    v_dot2_f32_bf16 v24, v97, v29, v24
    v_dot2_f32_bf16 v25, v97, v97, v25
    v_dot2_f32_bf16 v24, v98, v29, v24
    v_dot2_f32_bf16 v25, v98, v98, v25
    v_dot2_f32_bf16 v24, v99, v29, v24
    v_dot2_f32_bf16 v25, v99, v99, v25
    v_dot2_f32_bf16 v26, v100, v29, v26
    v_dot2_f32_bf16 v27, v100, v100, v27
    v_dot2_f32_bf16 v26, v101, v29, v26
    v_dot2_f32_bf16 v27, v101, v101, v27
    v_dot2_f32_bf16 v26, v102, v29, v26
    v_dot2_f32_bf16 v27, v102, v102, v27
    v_dot2_f32_bf16 v26, v103, v29, v26
    v_dot2_f32_bf16 v27, v103, v103, v27
L_qkv1_kernel_st_39:
    s_add_u32 m0, s59, 7168
    s_add_u32 s60, s52, 344064
    buffer_load_dwordx4 v7, s[32:35], s60 offen lds
    ds_read_b128 v[120:123], v91 offset:0
    ds_read_b128 v[124:127], v91 offset:32768
    s_waitcnt vmcnt(5)
    ds_read_b64_tr_b16 v[16:17], v8 offset:2048
    ds_read_b64_tr_b16 v[18:19], v8 offset:2304
    s_waitcnt lgkmcnt(4)
    v_mfma_f32_32x32x16_bf16 v[32:47], v[104:107], v[20:23], v[32:47]
    v_mfma_f32_32x32x16_bf16 v[48:63], v[108:111], v[20:23], v[48:63]
    v_dot2_f32_bf16 v28, v20, v29, v28
    v_dot2_f32_bf16 v28, v21, v29, v28
    v_dot2_f32_bf16 v28, v22, v29, v28
    v_dot2_f32_bf16 v28, v23, v29, v28
    s_cmp_lg_u32 s50, 1
    s_cbranch_scc1 L_qkv1_kernel_st_40
    v_dot2_f32_bf16 v24, v104, v29, v24
    v_dot2_f32_bf16 v25, v104, v104, v25
    v_dot2_f32_bf16 v24, v105, v29, v24
    v_dot2_f32_bf16 v25, v105, v105, v25
    v_dot2_f32_bf16 v24, v106, v29, v24
    v_dot2_f32_bf16 v25, v106, v106, v25
    v_dot2_f32_bf16 v24, v107, v29, v24
    v_dot2_f32_bf16 v25, v107, v107, v25
    v_dot2_f32_bf16 v26, v108, v29, v26
    v_dot2_f32_bf16 v27, v108, v108, v27
    v_dot2_f32_bf16 v26, v109, v29, v26
    v_dot2_f32_bf16 v27, v109, v109, v27
    v_dot2_f32_bf16 v26, v110, v29, v26
    v_dot2_f32_bf16 v27, v110, v110, v27
    v_dot2_f32_bf16 v26, v111, v29, v26
    v_dot2_f32_bf16 v27, v111, v111, v27
L_qkv1_kernel_st_40:
    s_add_u32 m0, s59, 0
    s_add_u32 s60, s52, 393216
    buffer_load_dwordx4 v7, s[32:35], s60 offen lds
    ds_read_b128 v[96:99], v92 offset:0
    ds_read_b128 v[100:103], v92 offset:32768
    s_waitcnt vmcnt(5)
    ds_read_b64_tr_b16 v[20:21], v8 offset:3072
    ds_read_b64_tr_b16 v[22:23], v8 offset:3328
    s_waitcnt lgkmcnt(4)
    v_mfma_f32_32x32x16_bf16 v[32:47], v[112:115], v[16:19], v[32:47]
    v_mfma_f32_32x32x16_bf16 v[48:63], v[116:119], v[16:19], v[48:63]
    v_dot2_f32_bf16 v28, v16, v29, v28
    v_dot2_f32_bf16 v28, v17, v29, v28
    v_dot2_f32_bf16 v28, v18, v29, v28
    v_dot2_f32_bf16 v28, v19, v29, v28
    s_cmp_lg_u32 s50, 2
    s_cbranch_scc1 L_qkv1_kernel_st_41
    v_dot2_f32_bf16 v24, v112, v29, v24
    v_dot2_f32_bf16 v25, v112, v112, v25
    v_dot2_f32_bf16 v24, v113, v29, v24
    v_dot2_f32_bf16 v25, v113, v113, v25
    v_dot2_f32_bf16 v24, v114, v29, v24
    v_dot2_f32_bf16 v25, v114, v114, v25
    v_dot2_f32_bf16 v24, v115, v29, v24
    v_dot2_f32_bf16 v25, v115, v115, v25
    v_dot2_f32_bf16 v26, v116, v29, v26
    v_dot2_f32_bf16 v27, v116, v116, v27
    v_dot2_f32_bf16 v26, v117, v29, v26
    v_dot2_f32_bf16 v27, v117, v117, v27
    v_dot2_f32_bf16 v26, v118, v29, v26
    v_dot2_f32_bf16 v27, v118, v118, v27
    v_dot2_f32_bf16 v26, v119, v29, v26
    v_dot2_f32_bf16 v27, v119, v119, v27
L_qkv1_kernel_st_41:
    s_add_u32 m0, s59, 1024
    s_add_u32 s60, s52, 442368
    buffer_load_dwordx4 v7, s[32:35], s60 offen lds
    ds_read_b128 v[104:107], v93 offset:0
    ds_read_b128 v[108:111], v93 offset:32768
    s_waitcnt vmcnt(5)
    ds_read_b64_tr_b16 v[16:17], v8 offset:4096
    ds_read_b64_tr_b16 v[18:19], v8 offset:4352
    s_waitcnt lgkmcnt(4)
    v_mfma_f32_32x32x16_bf16 v[32:47], v[120:123], v[20:23], v[32:47]
    v_mfma_f32_32x32x16_bf16 v[48:63], v[124:127], v[20:23], v[48:63]
    v_dot2_f32_bf16 v28, v20, v29, v28
    v_dot2_f32_bf16 v28, v21, v29, v28
    v_dot2_f32_bf16 v28, v22, v29, v28
    v_dot2_f32_bf16 v28, v23, v29, v28
    s_cmp_lg_u32 s50, 3
    s_cbranch_scc1 L_qkv1_kernel_st_42
    v_dot2_f32_bf16 v24, v120, v29, v24
    v_dot2_f32_bf16 v25, v120, v120, v25
    v_dot2_f32_bf16 v24, v121, v29, v24
    v_dot2_f32_bf16 v25, v121, v121, v25
    v_dot2_f32_bf16 v24, v122, v29, v24
    v_dot2_f32_bf16 v25, v122, v122, v25
    v_dot2_f32_bf16 v24, v123, v29, v24
    v_dot2_f32_bf16 v25, v123, v123, v25
    v_dot2_f32_bf16 v26, v124, v29, v26
    v_dot2_f32_bf16 v27, v124, v124, v27
    v_dot2_f32_bf16 v26, v125, v29, v26
    v_dot2_f32_bf16 v27, v125, v125, v27
    v_dot2_f32_bf16 v26, v126, v29, v26
    v_dot2_f32_bf16 v27, v126, v126, v27
    v_dot2_f32_bf16 v26, v127, v29, v26
    v_dot2_f32_bf16 v27, v127, v127, v27
L_qkv1_kernel_st_42:
    s_add_u32 m0, s59, 2048
    s_add_u32 s60, s52, 491520
    buffer_load_dwordx4 v7, s[32:35], s60 offen lds
    ds_read_b128 v[112:115], v94 offset:0
    ds_read_b128 v[116:119], v94 offset:32768
    s_waitcnt vmcnt(5)
    ds_read_b64_tr_b16 v[20:21], v8 offset:5120
    ds_read_b64_tr_b16 v[22:23], v8 offset:5376
    s_waitcnt lgkmcnt(4)
    v_mfma_f32_32x32x16_bf16 v[32:47], v[96:99], v[16:19], v[32:47]
    v_mfma_f32_32x32x16_bf16 v[48:63], v[100:103], v[16:19], v[48:63]
    v_dot2_f32_bf16 v28, v16, v29, v28
    v_dot2_f32_bf16 v28, v17, v29, v28
    v_dot2_f32_bf16 v28, v18, v29, v28
    v_dot2_f32_bf16 v28, v19, v29, v28
    s_cmp_lg_u32 s50, 4
    s_cbranch_scc1 L_qkv1_kernel_st_43
    v_dot2_f32_bf16 v24, v96, v29, v24
    v_dot2_f32_bf16 v25, v96, v96, v25
    v_dot2_f32_bf16 v24, v97, v29, v24
    v_dot2_f32_bf16 v25, v97, v97, v25
    v_dot2_f32_bf16 v24, v98, v29, v24
    v_dot2_f32_bf16 v25, v98, v98, v25
    v_dot2_f32_bf16 v24, v99, v29, v24
    v_dot2_f32_bf16 v25, v99, v99, v25
    v_dot2_f32_bf16 v26, v100, v29, v26
    v_dot2_f32_bf16 v27, v100, v100, v27
    v_dot2_f32_bf16 v26, v101, v29, v26
    v_dot2_f32_bf16 v27, v101, v101, v27
    v_dot2_f32_bf16 v26, v102, v29, v26
    v_dot2_f32_bf16 v27, v102, v102, v27
    v_dot2_f32_bf16 v26, v103, v29, v26
    v_dot2_f32_bf16 v27, v103, v103, v27
L_qkv1_kernel_st_43:
    s_add_u32 m0, s59, 3072
    s_add_u32 s60, s52, 540672
    buffer_load_dwordx4 v7, s[32:35], s60 offen lds
    ds_read_b128 v[120:123], v95 offset:0
    ds_read_b128 v[124:127], v95 offset:32768
    s_waitcnt vmcnt(5)
    ds_read_b64_tr_b16 v[16:17], v8 offset:6144
    ds_read_b64_tr_b16 v[18:19], v8 offset:6400
    s_waitcnt lgkmcnt(4)
    v_mfma_f32_32x32x16_bf16 v[32:47], v[104:107], v[20:23], v[32:47]
    v_mfma_f32_32x32x16_bf16 v[48:63], v[108:111], v[20:23], v[48:63]
    v_dot2_f32_bf16 v28, v20, v29, v28
    v_dot2_f32_bf16 v28, v21, v29, v28
    v_dot2_f32_bf16 v28, v22, v29, v28
    v_dot2_f32_bf16 v28, v23, v29, v28
    s_cmp_lg_u32 s50, 5
    s_cbranch_scc1 L_qkv1_kernel_st_44
    v_dot2_f32_bf16 v24, v104, v29, v24
    v_dot2_f32_bf16 v25, v104, v104, v25
    v_dot2_f32_bf16 v24, v105, v29, v24
    v_dot2_f32_bf16 v25, v105, v105, v25
    v_dot2_f32_bf16 v24, v106, v29, v24
    v_dot2_f32_bf16 v25, v106, v106, v25
    v_dot2_f32_bf16 v24, v107, v29, v24
    v_dot2_f32_bf16 v25, v107, v107, v25
    v_dot2_f32_bf16 v26, v108, v29, v26
    v_dot2_f32_bf16 v27, v108, v108, v27
    v_dot2_f32_bf16 v26, v109, v29, v26
    v_dot2_f32_bf16 v27, v109, v109, v27
    v_dot2_f32_bf16 v26, v110, v29, v26
    v_dot2_f32_bf16 v27, v110, v110, v27
    v_dot2_f32_bf16 v26, v111, v29, v26
    v_dot2_f32_bf16 v27, v111, v111, v27
L_qkv1_kernel_st_44:
    s_add_u32 m0, s59, 4096
    s_add_u32 s60, s52, 589824
    buffer_load_dwordx4 v7, s[32:35], s60 offen lds
    ds_read_b128 v[96:99], v88 offset:256
    ds_read_b128 v[100:103], v88 offset:33024
    s_waitcnt vmcnt(5)
    ds_read_b64_tr_b16 v[20:21], v8 offset:7168
    ds_read_b64_tr_b16 v[22:23], v8 offset:7424
    s_waitcnt lgkmcnt(4)
    v_mfma_f32_32x32x16_bf16 v[32:47], v[112:115], v[16:19], v[32:47]
    v_mfma_f32_32x32x16_bf16 v[48:63], v[116:119], v[16:19], v[48:63]
    v_dot2_f32_bf16 v28, v16, v29, v28
    v_dot2_f32_bf16 v28, v17, v29, v28
    v_dot2_f32_bf16 v28, v18, v29, v28
    v_dot2_f32_bf16 v28, v19, v29, v28
    s_cmp_lg_u32 s50, 6
    s_cbranch_scc1 L_qkv1_kernel_st_45
    v_dot2_f32_bf16 v24, v112, v29, v24
    v_dot2_f32_bf16 v25, v112, v112, v25
    v_dot2_f32_bf16 v24, v113, v29, v24
    v_dot2_f32_bf16 v25, v113, v113, v25
    v_dot2_f32_bf16 v24, v114, v29, v24
    v_dot2_f32_bf16 v25, v114, v114, v25
    v_dot2_f32_bf16 v24, v115, v29, v24
    v_dot2_f32_bf16 v25, v115, v115, v25
    v_dot2_f32_bf16 v26, v116, v29, v26
    v_dot2_f32_bf16 v27, v116, v116, v27
    v_dot2_f32_bf16 v26, v117, v29, v26
    v_dot2_f32_bf16 v27, v117, v117, v27
    v_dot2_f32_bf16 v26, v118, v29, v26
    v_dot2_f32_bf16 v27, v118, v118, v27
    v_dot2_f32_bf16 v26, v119, v29, v26
    v_dot2_f32_bf16 v27, v119, v119, v27
L_qkv1_kernel_st_45:
    s_add_u32 m0, s59, 5120
    s_add_u32 s60, s52, 638976
    buffer_load_dwordx4 v7, s[32:35], s60 offen lds
    ds_read_b128 v[104:107], v89 offset:256
    ds_read_b128 v[108:111], v89 offset:33024
    s_waitcnt vmcnt(5)
    ds_read_b64_tr_b16 v[16:17], v8 offset:0
    ds_read_b64_tr_b16 v[18:19], v8 offset:256
    s_waitcnt lgkmcnt(4)
    v_mfma_f32_32x32x16_bf16 v[32:47], v[120:123], v[20:23], v[32:47]
    v_mfma_f32_32x32x16_bf16 v[48:63], v[124:127], v[20:23], v[48:63]
    v_dot2_f32_bf16 v28, v20, v29, v28
    v_dot2_f32_bf16 v28, v21, v29, v28
    v_dot2_f32_bf16 v28, v22, v29, v28
    v_dot2_f32_bf16 v28, v23, v29, v28
    s_cmp_lg_u32 s50, 7
    s_cbranch_scc1 L_qkv1_kernel_st_46
    v_dot2_f32_bf16 v24, v120, v29, v24
    v_dot2_f32_bf16 v25, v120, v120, v25
    v_dot2_f32_bf16 v24, v121, v29, v24
    v_dot2_f32_bf16 v25, v121, v121, v25
    v_dot2_f32_bf16 v24, v122, v29, v24
    v_dot2_f32_bf16 v25, v122, v122, v25
    v_dot2_f32_bf16 v24, v123, v29, v24
    v_dot2_f32_bf16 v25, v123, v123, v25
    v_dot2_f32_bf16 v26, v124, v29, v26
    v_dot2_f32_bf16 v27, v124, v124, v27
    v_dot2_f32_bf16 v26, v125, v29, v26
    v_dot2_f32_bf16 v27, v125, v125, v27
    v_dot2_f32_bf16 v26, v126, v29, v26
    v_dot2_f32_bf16 v27, v126, v126, v27
    v_dot2_f32_bf16 v26, v127, v29, v26
    v_dot2_f32_bf16 v27, v127, v127, v27
L_qkv1_kernel_st_46:
    s_add_u32 m0, s59, 6144
    s_add_u32 s60, s52, 688128
    buffer_load_dwordx4 v7, s[32:35], s60 offen lds
    ds_read_b128 v[112:115], v90 offset:256
    ds_read_b128 v[116:119], v90 offset:33024
    s_waitcnt vmcnt(5)
    ds_read_b64_tr_b16 v[20:21], v8 offset:1024
    ds_read_b64_tr_b16 v[22:23], v8 offset:1280
    s_waitcnt lgkmcnt(4)
    v_mfma_f32_32x32x16_bf16 v[32:47], v[96:99], v[16:19], v[32:47]
    v_mfma_f32_32x32x16_bf16 v[48:63], v[100:103], v[16:19], v[48:63]
    v_dot2_f32_bf16 v28, v16, v29, v28
    v_dot2_f32_bf16 v28, v17, v29, v28
    v_dot2_f32_bf16 v28, v18, v29, v28
    v_dot2_f32_bf16 v28, v19, v29, v28
    s_cmp_lg_u32 s50, 0
    s_cbranch_scc1 L_qkv1_kernel_st_47
    v_dot2_f32_bf16 v24, v96, v29, v24
    v_dot2_f32_bf16 v25, v96, v96, v25
    v_dot2_f32_bf16 v24, v97, v29, v24
    v_dot2_f32_bf16 v25, v97, v97, v25
    v_dot2_f32_bf16 v24, v98, v29, v24
    v_dot2_f32_bf16 v25, v98, v98, v25
    v_dot2_f32_bf16 v24, v99, v29, v24
    v_dot2_f32_bf16 v25, v99, v99, v25
    v_dot2_f32_bf16 v26, v100, v29, v26
    v_dot2_f32_bf16 v27, v100, v100, v27
    v_dot2_f32_bf16 v26, v101, v29, v26
    v_dot2_f32_bf16 v27, v101, v101, v27
    v_dot2_f32_bf16 v26, v102, v29, v26
    v_dot2_f32_bf16 v27, v102, v102, v27
    v_dot2_f32_bf16 v26, v103, v29, v26
    v_dot2_f32_bf16 v27, v103, v103, v27
L_qkv1_kernel_st_47:
    s_add_u32 m0, s59, 7168
    s_add_u32 s60, s52, 737280
    buffer_load_dwordx4 v7, s[32:35], s60 offen lds
    ds_read_b128 v[120:123], v91 offset:256
    ds_read_b128 v[124:127], v91 offset:33024
    s_waitcnt vmcnt(5)
    ds_read_b64_tr_b16 v[16:17], v8 offset:2048
    ds_read_b64_tr_b16 v[18:19], v8 offset:2304
    s_waitcnt lgkmcnt(4)
    v_mfma_f32_32x32x16_bf16 v[32:47], v[104:107], v[20:23], v[32:47]
    v_mfma_f32_32x32x16_bf16 v[48:63], v[108:111], v[20:23], v[48:63]
    v_dot2_f32_bf16 v28, v20, v29, v28
    v_dot2_f32_bf16 v28, v21, v29, v28
    v_dot2_f32_bf16 v28, v22, v29, v28
    v_dot2_f32_bf16 v28, v23, v29, v28
    s_cmp_lg_u32 s50, 1
    s_cbranch_scc1 L_qkv1_kernel_st_48
    v_dot2_f32_bf16 v24, v104, v29, v24
    v_dot2_f32_bf16 v25, v104, v104, v25
    v_dot2_f32_bf16 v24, v105, v29, v24
    v_dot2_f32_bf16 v25, v105, v105, v25
    v_dot2_f32_bf16 v24, v106, v29, v24
    v_dot2_f32_bf16 v25, v106, v106, v25
    v_dot2_f32_bf16 v24, v107, v29, v24
    v_dot2_f32_bf16 v25, v107, v107, v25
    v_dot2_f32_bf16 v26, v108, v29, v26
    v_dot2_f32_bf16 v27, v108, v108, v27
    v_dot2_f32_bf16 v26, v109, v29, v26
    v_dot2_f32_bf16 v27, v109, v109, v27
    v_dot2_f32_bf16 v26, v110, v29, v26
    v_dot2_f32_bf16 v27, v110, v110, v27
    v_dot2_f32_bf16 v26, v111, v29, v26
    v_dot2_f32_bf16 v27, v111, v111, v27
L_qkv1_kernel_st_48:
    s_add_u32 m0, s59, 0
    s_add_u32 s60, s52, 786432
    buffer_load_dwordx4 v7, s[32:35], s60 offen lds
    ds_read_b128 v[96:99], v92 offset:256
    ds_read_b128 v[100:103], v92 offset:33024
    s_waitcnt vmcnt(5)
    ds_read_b64_tr_b16 v[20:21], v8 offset:3072
    ds_read_b64_tr_b16 v[22:23], v8 offset:3328
    s_waitcnt lgkmcnt(4)
    v_mfma_f32_32x32x16_bf16 v[32:47], v[112:115], v[16:19], v[32:47]
    v_mfma_f32_32x32x16_bf16 v[48:63], v[116:119], v[16:19], v[48:63]
    v_dot2_f32_bf16 v28, v16, v29, v28
    v_dot2_f32_bf16 v28, v17, v29, v28
    v_dot2_f32_bf16 v28, v18, v29, v28
    v_dot2_f32_bf16 v28, v19, v29, v28
    s_cmp_lg_u32 s50, 2
    s_cbranch_scc1 L_qkv1_kernel_st_49
    v_dot2_f32_bf16 v24, v112, v29, v24
    v_dot2_f32_bf16 v25, v112, v112, v25
    v_dot2_f32_bf16 v24, v113, v29, v24
    v_dot2_f32_bf16 v25, v113, v113, v25
    v_dot2_f32_bf16 v24, v114, v29, v24
    v_dot2_f32_bf16 v25, v114, v114, v25
    v_dot2_f32_bf16 v24, v115, v29, v24
    v_dot2_f32_bf16 v25, v115, v115, v25
    v_dot2_f32_bf16 v26, v116, v29, v26
    v_dot2_f32_bf16 v27, v116, v116, v27
    v_dot2_f32_bf16 v26, v117, v29, v26
    v_dot2_f32_bf16 v27, v117, v117, v27
    v_dot2_f32_bf16 v26, v118, v29, v26
    v_dot2_f32_bf16 v27, v118, v118, v27
    v_dot2_f32_bf16 v26, v119, v29, v26
    v_dot2_f32_bf16 v27, v119, v119, v27
L_qkv1_kernel_st_49:
    s_add_u32 m0, s59, 1024
    s_add_u32 s60, s52, 835584
    buffer_load_dwordx4 v7, s[32:35], s60 offen lds
    ds_read_b128 v[104:107], v93 offset:256
    ds_read_b128 v[108:111], v93 offset:33024
    s_waitcnt vmcnt(5)
    ds_read_b64_tr_b16 v[16:17], v8 offset:4096
    ds_read_b64_tr_b16 v[18:19], v8 offset:4352
    s_waitcnt lgkmcnt(4)
    v_mfma_f32_32x32x16_bf16 v[32:47], v[120:123], v[20:23], v[32:47]
    v_mfma_f32_32x32x16_bf16 v[48:63], v[124:127], v[20:23], v[48:63]
    v_dot2_f32_bf16 v28, v20, v29, v28
    v_dot2_f32_bf16 v28, v21, v29, v28
    v_dot2_f32_bf16 v28, v22, v29, v28
    v_dot2_f32_bf16 v28, v23, v29, v28
    s_cmp_lg_u32 s50, 3
    s_cbranch_scc1 L_qkv1_kernel_st_50
    v_dot2_f32_bf16 v24, v120, v29, v24
    v_dot2_f32_bf16 v25, v120, v120, v25
    v_dot2_f32_bf16 v24, v121, v29, v24
    v_dot2_f32_bf16 v25, v121, v121, v25
    v_dot2_f32_bf16 v24, v122, v29, v24
    v_dot2_f32_bf16 v25, v122, v122, v25
    v_dot2_f32_bf16 v24, v123, v29, v24
    v_dot2_f32_bf16 v25, v123, v123, v25
    v_dot2_f32_bf16 v26, v124, v29, v26
    v_dot2_f32_bf16 v27, v124, v124, v27
    v_dot2_f32_bf16 v26, v125, v29, v26
    v_dot2_f32_bf16 v27, v125, v125, v27
    v_dot2_f32_bf16 v26, v126, v29, v26
    v_dot2_f32_bf16 v27, v126, v126, v27
    v_dot2_f32_bf16 v26, v127, v29, v26
    v_dot2_f32_bf16 v27, v127, v127, v27
L_qkv1_kernel_st_50:
    s_add_u32 m0, s59, 2048
    s_add_u32 s60, s52, 884736
    buffer_load_dwordx4 v7, s[32:35], s60 offen lds
    ds_read_b128 v[112:115], v94 offset:256
    ds_read_b128 v[116:119], v94 offset:33024
    s_waitcnt vmcnt(5)
    ds_read_b64_tr_b16 v[20:21], v8 offset:5120
    ds_read_b64_tr_b16 v[22:23], v8 offset:5376
    s_waitcnt lgkmcnt(4)
    v_mfma_f32_32x32x16_bf16 v[32:47], v[96:99], v[16:19], v[32:47]
    v_mfma_f32_32x32x16_bf16 v[48:63], v[100:103], v[16:19], v[48:63]
    v_dot2_f32_bf16 v28, v16, v29, v28
    v_dot2_f32_bf16 v28, v17, v29, v28
    v_dot2_f32_bf16 v28, v18, v29, v28
    v_dot2_f32_bf16 v28, v19, v29, v28
    s_cmp_lg_u32 s50, 4
    s_cbranch_scc1 L_qkv1_kernel_st_51
    v_dot2_f32_bf16 v24, v96, v29, v24
    v_dot2_f32_bf16 v25, v96, v96, v25
    v_dot2_f32_bf16 v24, v97, v29, v24
    v_dot2_f32_bf16 v25, v97, v97, v25
    v_dot2_f32_bf16 v24, v98, v29, v24
    v_dot2_f32_bf16 v25, v98, v98, v25
    v_dot2_f32_bf16 v24, v99, v29, v24
    v_dot2_f32_bf16 v25, v99, v99, v25
    v_dot2_f32_bf16 v26, v100, v29, v26
    v_dot2_f32_bf16 v27, v100, v100, v27
    v_dot2_f32_bf16 v26, v101, v29, v26
    v_dot2_f32_bf16 v27, v101, v101, v27
    v_dot2_f32_bf16 v26, v102, v29, v26
    v_dot2_f32_bf16 v27, v102, v102, v27
    v_dot2_f32_bf16 v26, v103, v29, v26
    v_dot2_f32_bf16 v27, v103, v103, v27
L_qkv1_kernel_st_51:
    s_add_u32 m0, s59, 3072
    s_add_u32 s60, s52, 933888
    buffer_load_dwordx4 v7, s[32:35], s60 offen lds
    ds_read_b128 v[120:123], v95 offset:256
    ds_read_b128 v[124:127], v95 offset:33024
    s_waitcnt vmcnt(5)
    ds_read_b64_tr_b16 v[16:17], v8 offset:6144
    ds_read_b64_tr_b16 v[18:19], v8 offset:6400
    s_waitcnt lgkmcnt(4)
    v_mfma_f32_32x32x16_bf16 v[32:47], v[104:107], v[20:23], v[32:47]
    v_mfma_f32_32x32x16_bf16 v[48:63], v[108:111], v[20:23], v[48:63]
    v_dot2_f32_bf16 v28, v20, v29, v28
    v_dot2_f32_bf16 v28, v21, v29, v28
    v_dot2_f32_bf16 v28, v22, v29, v28
    v_dot2_f32_bf16 v28, v23, v29, v28
    s_cmp_lg_u32 s50, 5
    s_cbranch_scc1 L_qkv1_kernel_st_52
    v_dot2_f32_bf16 v24, v104, v29, v24
    v_dot2_f32_bf16 v25, v104, v104, v25
    v_dot2_f32_bf16 v24, v105, v29, v24
    v_dot2_f32_bf16 v25, v105, v105, v25
    v_dot2_f32_bf16 v24, v106, v29, v24
    v_dot2_f32_bf16 v25, v106, v106, v25
    v_dot2_f32_bf16 v24, v107, v29, v24
    v_dot2_f32_bf16 v25, v107, v107, v25
    v_dot2_f32_bf16 v26, v108, v29, v26
    v_dot2_f32_bf16 v27, v108, v108, v27
    v_dot2_f32_bf16 v26, v109, v29, v26
    v_dot2_f32_bf16 v27, v109, v109, v27
    v_dot2_f32_bf16 v26, v110, v29, v26
    v_dot2_f32_bf16 v27, v110, v110, v27
    v_dot2_f32_bf16 v26, v111, v29, v26
    v_dot2_f32_bf16 v27, v111, v111, v27
L_qkv1_kernel_st_52:
    s_add_u32 m0, s59, 4096
    s_add_u32 s60, s52, 983040
    buffer_load_dwordx4 v7, s[32:35], s60 offen lds
    ds_read_b128 v[96:99], v88 offset:512
    ds_read_b128 v[100:103], v88 offset:33280
    s_waitcnt vmcnt(5)
    ds_read_b64_tr_b16 v[20:21], v8 offset:7168
    ds_read_b64_tr_b16 v[22:23], v8 offset:7424
    s_waitcnt lgkmcnt(4)
    v_mfma_f32_32x32x16_bf16 v[32:47], v[112:115], v[16:19], v[32:47]
    v_mfma_f32_32x32x16_bf16 v[48:63], v[116:119], v[16:19], v[48:63]
    v_dot2_f32_bf16 v28, v16, v29, v28
    v_dot2_f32_bf16 v28, v17, v29, v28
    v_dot2_f32_bf16 v28, v18, v29, v28
    v_dot2_f32_bf16 v28, v19, v29, v28
    s_cmp_lg_u32 s50, 6
    s_cbranch_scc1 L_qkv1_kernel_st_53
    v_dot2_f32_bf16 v24, v112, v29, v24
    v_dot2_f32_bf16 v25, v112, v112, v25
    v_dot2_f32_bf16 v24, v113, v29, v24
    v_dot2_f32_bf16 v25, v113, v113, v25
    v_dot2_f32_bf16 v24, v114, v29, v24
    v_dot2_f32_bf16 v25, v114, v114, v25
    v_dot2_f32_bf16 v24, v115, v29, v24
    v_dot2_f32_bf16 v25, v115, v115, v25
    v_dot2_f32_bf16 v26, v116, v29, v26
    v_dot2_f32_bf16 v27, v116, v116, v27
    v_dot2_f32_bf16 v26, v117, v29, v26
    v_dot2_f32_bf16 v27, v117, v117, v27
    v_dot2_f32_bf16 v26, v118, v29, v26
    v_dot2_f32_bf16 v27, v118, v118, v27
    v_dot2_f32_bf16 v26, v119, v29, v26
    v_dot2_f32_bf16 v27, v119, v119, v27
L_qkv1_kernel_st_53:
    s_add_u32 m0, s59, 5120
    s_add_u32 s60, s52, 1032192
    buffer_load_dwordx4 v7, s[32:35], s60 offen lds
    ds_read_b128 v[104:107], v89 offset:512
    ds_read_b128 v[108:111], v89 offset:33280
    s_waitcnt vmcnt(5)
    ds_read_b64_tr_b16 v[16:17], v8 offset:0
    ds_read_b64_tr_b16 v[18:19], v8 offset:256
    s_waitcnt lgkmcnt(4)
    v_mfma_f32_32x32x16_bf16 v[32:47], v[120:123], v[20:23], v[32:47]
    v_mfma_f32_32x32x16_bf16 v[48:63], v[124:127], v[20:23], v[48:63]
    v_dot2_f32_bf16 v28, v20, v29, v28
    v_dot2_f32_bf16 v28, v21, v29, v28
    v_dot2_f32_bf16 v28, v22, v29, v28
    v_dot2_f32_bf16 v28, v23, v29, v28
    s_cmp_lg_u32 s50, 7
    s_cbranch_scc1 L_qkv1_kernel_st_54
    v_dot2_f32_bf16 v24, v120, v29, v24
    v_dot2_f32_bf16 v25, v120, v120, v25
    v_dot2_f32_bf16 v24, v121, v29, v24
    v_dot2_f32_bf16 v25, v121, v121, v25
    v_dot2_f32_bf16 v24, v122, v29, v24
    v_dot2_f32_bf16 v25, v122, v122, v25
    v_dot2_f32_bf16 v24, v123, v29, v24
    v_dot2_f32_bf16 v25, v123, v123, v25
    v_dot2_f32_bf16 v26, v124, v29, v26
    v_dot2_f32_bf16 v27, v124, v124, v27
    v_dot2_f32_bf16 v26, v125, v29, v26
    v_dot2_f32_bf16 v27, v125, v125, v27
    v_dot2_f32_bf16 v26, v126, v29, v26
    v_dot2_f32_bf16 v27, v126, v126, v27
    v_dot2_f32_bf16 v26, v127, v29, v26
    v_dot2_f32_bf16 v27, v127, v127, v27
L_qkv1_kernel_st_54:
    s_add_u32 m0, s59, 6144
    s_add_u32 s60, s52, 1081344
    buffer_load_dwordx4 v7, s[32:35], s60 offen lds
    ds_read_b128 v[112:115], v90 offset:512
    ds_read_b128 v[116:119], v90 offset:33280
    s_waitcnt vmcnt(5)
    ds_read_b64_tr_b16 v[20:21], v8 offset:1024
    ds_read_b64_tr_b16 v[22:23], v8 offset:1280
    s_waitcnt lgkmcnt(4)
    v_mfma_f32_32x32x16_bf16 v[32:47], v[96:99], v[16:19], v[32:47]
    v_mfma_f32_32x32x16_bf16 v[48:63], v[100:103], v[16:19], v[48:63]
    v_dot2_f32_bf16 v28, v16, v29, v28
    v_dot2_f32_bf16 v28, v17, v29, v28
    v_dot2_f32_bf16 v28, v18, v29, v28
    v_dot2_f32_bf16 v28, v19, v29, v28
    s_cmp_lg_u32 s50, 0
    s_cbranch_scc1 L_qkv1_kernel_st_55
    v_dot2_f32_bf16 v24, v96, v29, v24
    v_dot2_f32_bf16 v25, v96, v96, v25
    v_dot2_f32_bf16 v24, v97, v29, v24
    v_dot2_f32_bf16 v25, v97, v97, v25
    v_dot2_f32_bf16 v24, v98, v29, v24
    v_dot2_f32_bf16 v25, v98, v98, v25
    v_dot2_f32_bf16 v24, v99, v29, v24
    v_dot2_f32_bf16 v25, v99, v99, v25
    v_dot2_f32_bf16 v26, v100, v29, v26
    v_dot2_f32_bf16 v27, v100, v100, v27
    v_dot2_f32_bf16 v26, v101, v29, v26
    v_dot2_f32_bf16 v27, v101, v101, v27
    v_dot2_f32_bf16 v26, v102, v29, v26
    v_dot2_f32_bf16 v27, v102, v102, v27
    v_dot2_f32_bf16 v26, v103, v29, v26
    v_dot2_f32_bf16 v27, v103, v103, v27
L_qkv1_kernel_st_55:
    s_add_u32 m0, s59, 7168
    s_add_u32 s60, s52, 1130496
    buffer_load_dwordx4 v7, s[32:35], s60 offen lds
    ds_read_b128 v[120:123], v91 offset:512
    ds_read_b128 v[124:127], v91 offset:33280
    s_waitcnt vmcnt(5)
    ds_read_b64_tr_b16 v[16:17], v8 offset:2048
    ds_read_b64_tr_b16 v[18:19], v8 offset:2304
    s_waitcnt lgkmcnt(4)
    v_mfma_f32_32x32x16_bf16 v[32:47], v[104:107], v[20:23], v[32:47]
    v_mfma_f32_32x32x16_bf16 v[48:63], v[108:111], v[20:23], v[48:63]
    v_dot2_f32_bf16 v28, v20, v29, v28
    v_dot2_f32_bf16 v28, v21, v29, v28
    v_dot2_f32_bf16 v28, v22, v29, v28
    v_dot2_f32_bf16 v28, v23, v29, v28
    s_cmp_lg_u32 s50, 1
    s_cbranch_scc1 L_qkv1_kernel_st_56
    v_dot2_f32_bf16 v24, v104, v29, v24
    v_dot2_f32_bf16 v25, v104, v104, v25
    v_dot2_f32_bf16 v24, v105, v29, v24
    v_dot2_f32_bf16 v25, v105, v105, v25
    v_dot2_f32_bf16 v24, v106, v29, v24
    v_dot2_f32_bf16 v25, v106, v106, v25
    v_dot2_f32_bf16 v24, v107, v29, v24
    v_dot2_f32_bf16 v25, v107, v107, v25
    v_dot2_f32_bf16 v26, v108, v29, v26
    v_dot2_f32_bf16 v27, v108, v108, v27
    v_dot2_f32_bf16 v26, v109, v29, v26
    v_dot2_f32_bf16 v27, v109, v109, v27
    v_dot2_f32_bf16 v26, v110, v29, v26
    v_dot2_f32_bf16 v27, v110, v110, v27
    v_dot2_f32_bf16 v26, v111, v29, v26
    v_dot2_f32_bf16 v27, v111, v111, v27
L_qkv1_kernel_st_56:
    s_add_u32 m0, s59, 0
    s_add_u32 s60, s52, 1179648
    buffer_load_dwordx4 v7, s[32:35], s60 offen lds
    ds_read_b128 v[96:99], v92 offset:512
    ds_read_b128 v[100:103], v92 offset:33280
    s_waitcnt vmcnt(5)
    ds_read_b64_tr_b16 v[20:21], v8 offset:3072
    ds_read_b64_tr_b16 v[22:23], v8 offset:3328
    s_waitcnt lgkmcnt(4)
    v_mfma_f32_32x32x16_bf16 v[32:47], v[112:115], v[16:19], v[32:47]
    v_mfma_f32_32x32x16_bf16 v[48:63], v[116:119], v[16:19], v[48:63]
    v_dot2_f32_bf16 v28, v16, v29, v28
    v_dot2_f32_bf16 v28, v17, v29, v28
    v_dot2_f32_bf16 v28, v18, v29, v28
    v_dot2_f32_bf16 v28, v19, v29, v28
    s_cmp_lg_u32 s50, 2
    s_cbranch_scc1 L_qkv1_kernel_st_57
    v_dot2_f32_bf16 v24, v112, v29, v24
    v_dot2_f32_bf16 v25, v112, v112, v25
    v_dot2_f32_bf16 v24, v113, v29, v24
    v_dot2_f32_bf16 v25, v113, v113, v25
    v_dot2_f32_bf16 v24, v114, v29, v24
    v_dot2_f32_bf16 v25, v114, v114, v25
    v_dot2_f32_bf16 v24, v115, v29, v24
    v_dot2_f32_bf16 v25, v115, v115, v25
    v_dot2_f32_bf16 v26, v116, v29, v26
    v_dot2_f32_bf16 v27, v116, v116, v27
    v_dot2_f32_bf16 v26, v117, v29, v26
    v_dot2_f32_bf16 v27, v117, v117, v27
    v_dot2_f32_bf16 v26, v118, v29, v26
    v_dot2_f32_bf16 v27, v118, v118, v27
    v_dot2_f32_bf16 v26, v119, v29, v26
    v_dot2_f32_bf16 v27, v119, v119, v27
L_qkv1_kernel_st_57:
    s_add_u32 m0, s59, 1024
    s_add_u32 s60, s52, 1228800
    buffer_load_dwordx4 v7, s[32:35], s60 offen lds
    ds_read_b128 v[104:107], v93 offset:512
    ds_read_b128 v[108:111], v93 offset:33280
    s_waitcnt vmcnt(5)
    ds_read_b64_tr_b16 v[16:17], v8 offset:4096
    ds_read_b64_tr_b16 v[18:19], v8 offset:4352
    s_waitcnt lgkmcnt(4)
    v_mfma_f32_32x32x16_bf16 v[32:47], v[120:123], v[20:23], v[32:47]
    v_mfma_f32_32x32x16_bf16 v[48:63], v[124:127], v[20:23], v[48:63]
    v_dot2_f32_bf16 v28, v20, v29, v28
    v_dot2_f32_bf16 v28, v21, v29, v28
    v_dot2_f32_bf16 v28, v22, v29, v28
    v_dot2_f32_bf16 v28, v23, v29, v28
    s_cmp_lg_u32 s50, 3
    s_cbranch_scc1 L_qkv1_kernel_st_58
    v_dot2_f32_bf16 v24, v120, v29, v24
    v_dot2_f32_bf16 v25, v120, v120, v25
    v_dot2_f32_bf16 v24, v121, v29, v24
    v_dot2_f32_bf16 v25, v121, v121, v25
    v_dot2_f32_bf16 v24, v122, v29, v24
    v_dot2_f32_bf16 v25, v122, v122, v25
    v_dot2_f32_bf16 v24, v123, v29, v24
    v_dot2_f32_bf16 v25, v123, v123, v25
    v_dot2_f32_bf16 v26, v124, v29, v26
    v_dot2_f32_bf16 v27, v124, v124, v27
    v_dot2_f32_bf16 v26, v125, v29, v26
    v_dot2_f32_bf16 v27, v125, v125, v27
    v_dot2_f32_bf16 v26, v126, v29, v26
    v_dot2_f32_bf16 v27, v126, v126, v27
    v_dot2_f32_bf16 v26, v127, v29, v26
    v_dot2_f32_bf16 v27, v127, v127, v27
L_qkv1_kernel_st_58:
    s_add_u32 m0, s59, 2048
    s_add_u32 s60, s52, 1277952
    buffer_load_dwordx4 v7, s[32:35], s60 offen lds
    ds_read_b128 v[112:115], v94 offset:512
    ds_read_b128 v[116:119], v94 offset:33280
    s_waitcnt vmcnt(5)
    ds_read_b64_tr_b16 v[20:21], v8 offset:5120
    ds_read_b64_tr_b16 v[22:23], v8 offset:5376
    s_waitcnt lgkmcnt(4)
    v_mfma_f32_32x32x16_bf16 v[32:47], v[96:99], v[16:19], v[32:47]
    v_mfma_f32_32x32x16_bf16 v[48:63], v[100:103], v[16:19], v[48:63]
    v_dot2_f32_bf16 v28, v16, v29, v28
    v_dot2_f32_bf16 v28, v17, v29, v28
    v_dot2_f32_bf16 v28, v18, v29, v28
    v_dot2_f32_bf16 v28, v19, v29, v28
    s_cmp_lg_u32 s50, 4
    s_cbranch_scc1 L_qkv1_kernel_st_59
    v_dot2_f32_bf16 v24, v96, v29, v24
    v_dot2_f32_bf16 v25, v96, v96, v25
    v_dot2_f32_bf16 v24, v97, v29, v24
    v_dot2_f32_bf16 v25, v97, v97, v25
    v_dot2_f32_bf16 v24, v98, v29, v24
    v_dot2_f32_bf16 v25, v98, v98, v25
    v_dot2_f32_bf16 v24, v99, v29, v24
    v_dot2_f32_bf16 v25, v99, v99, v25
    v_dot2_f32_bf16 v26, v100, v29, v26
    v_dot2_f32_bf16 v27, v100, v100, v27
    v_dot2_f32_bf16 v26, v101, v29, v26
    v_dot2_f32_bf16 v27, v101, v101, v27
    v_dot2_f32_bf16 v26, v102, v29, v26
    v_dot2_f32_bf16 v27, v102, v102, v27
    v_dot2_f32_bf16 v26, v103, v29, v26
    v_dot2_f32_bf16 v27, v103, v103, v27
L_qkv1_kernel_st_59:
    s_add_u32 m0, s59, 3072
    s_add_u32 s60, s52, 1327104
    buffer_load_dwordx4 v7, s[32:35], s60 offen lds
    ds_read_b128 v[120:123], v95 offset:512
    ds_read_b128 v[124:127], v95 offset:33280
    s_waitcnt vmcnt(5)
    ds_read_b64_tr_b16 v[16:17], v8 offset:6144
    ds_read_b64_tr_b16 v[18:19], v8 offset:6400
    s_waitcnt lgkmcnt(4)
    v_mfma_f32_32x32x16_bf16 v[32:47], v[104:107], v[20:23], v[32:47]
    v_mfma_f32_32x32x16_bf16 v[48:63], v[108:111], v[20:23], v[48:63]
    v_dot2_f32_bf16 v28, v20, v29, v28
    v_dot2_f32_bf16 v28, v21, v29, v28
    v_dot2_f32_bf16 v28, v22, v29, v28
    v_dot2_f32_bf16 v28, v23, v29, v28
    s_cmp_lg_u32 s50, 5
    s_cbranch_scc1 L_qkv1_kernel_st_60
    v_dot2_f32_bf16 v24, v104, v29, v24
    v_dot2_f32_bf16 v25, v104, v104, v25
    v_dot2_f32_bf16 v24, v105, v29, v24
    v_dot2_f32_bf16 v25, v105, v105, v25
    v_dot2_f32_bf16 v24, v106, v29, v24
    v_dot2_f32_bf16 v25, v106, v106, v25
    v_dot2_f32_bf16 v24, v107, v29, v24
    v_dot2_f32_bf16 v25, v107, v107, v25
    v_dot2_f32_bf16 v26, v108, v29, v26
    v_dot2_f32_bf16 v27, v108, v108, v27
    v_dot2_f32_bf16 v26, v109, v29, v26
    v_dot2_f32_bf16 v27, v109, v109, v27
    v_dot2_f32_bf16 v26, v110, v29, v26
    v_dot2_f32_bf16 v27, v110, v110, v27
    v_dot2_f32_bf16 v26, v111, v29, v26
    v_dot2_f32_bf16 v27, v111, v111, v27
L_qkv1_kernel_st_60:
    s_add_u32 m0, s59, 4096
    s_add_u32 s60, s52, 1376256
    buffer_load_dwordx4 v7, s[32:35], s60 offen lds
    ds_read_b128 v[96:99], v88 offset:768
    ds_read_b128 v[100:103], v88 offset:33536
    s_waitcnt vmcnt(5)
    ds_read_b64_tr_b16 v[20:21], v8 offset:7168
    ds_read_b64_tr_b16 v[22:23], v8 offset:7424
    s_waitcnt lgkmcnt(4)
    v_mfma_f32_32x32x16_bf16 v[32:47], v[112:115], v[16:19], v[32:47]
    v_mfma_f32_32x32x16_bf16 v[48:63], v[116:119], v[16:19], v[48:63]
    v_dot2_f32_bf16 v28, v16, v29, v28
    v_dot2_f32_bf16 v28, v17, v29, v28
    v_dot2_f32_bf16 v28, v18, v29, v28
    v_dot2_f32_bf16 v28, v19, v29, v28
    s_cmp_lg_u32 s50, 6
    s_cbranch_scc1 L_qkv1_kernel_st_61
    v_dot2_f32_bf16 v24, v112, v29, v24
    v_dot2_f32_bf16 v25, v112, v112, v25
    v_dot2_f32_bf16 v24, v113, v29, v24
    v_dot2_f32_bf16 v25, v113, v113, v25
    v_dot2_f32_bf16 v24, v114, v29, v24
    v_dot2_f32_bf16 v25, v114, v114, v25
    v_dot2_f32_bf16 v24, v115, v29, v24
    v_dot2_f32_bf16 v25, v115, v115, v25
    v_dot2_f32_bf16 v26, v116, v29, v26
    v_dot2_f32_bf16 v27, v116, v116, v27
    v_dot2_f32_bf16 v26, v117, v29, v26
    v_dot2_f32_bf16 v27, v117, v117, v27
    v_dot2_f32_bf16 v26, v118, v29, v26
    v_dot2_f32_bf16 v27, v118, v118, v27
    v_dot2_f32_bf16 v26, v119, v29, v26
    v_dot2_f32_bf16 v27, v119, v119, v27
L_qkv1_kernel_st_61:
    s_add_u32 m0, s59, 5120
    s_add_u32 s60, s52, 1425408
    buffer_load_dwordx4 v7, s[32:35], s60 offen lds
    ds_read_b128 v[104:107], v89 offset:768
    ds_read_b128 v[108:111], v89 offset:33536
    s_waitcnt vmcnt(5)
    ds_read_b64_tr_b16 v[16:17], v8 offset:0
    ds_read_b64_tr_b16 v[18:19], v8 offset:256
    s_waitcnt lgkmcnt(4)
    v_mfma_f32_32x32x16_bf16 v[32:47], v[120:123], v[20:23], v[32:47]
    v_mfma_f32_32x32x16_bf16 v[48:63], v[124:127], v[20:23], v[48:63]
    v_dot2_f32_bf16 v28, v20, v29, v28
    v_dot2_f32_bf16 v28, v21, v29, v28
    v_dot2_f32_bf16 v28, v22, v29, v28
    v_dot2_f32_bf16 v28, v23, v29, v28
    s_cmp_lg_u32 s50, 7
    s_cbranch_scc1 L_qkv1_kernel_st_62
    v_dot2_f32_bf16 v24, v120, v29, v24
    v_dot2_f32_bf16 v25, v120, v120, v25
    v_dot2_f32_bf16 v24, v121, v29, v24
    v_dot2_f32_bf16 v25, v121, v121, v25
    v_dot2_f32_bf16 v24, v122, v29, v24
    v_dot2_f32_bf16 v25, v122, v122, v25
    v_dot2_f32_bf16 v24, v123, v29, v24
    v_dot2_f32_bf16 v25, v123, v123, v25
    v_dot2_f32_bf16 v26, v124, v29, v26
    v_dot2_f32_bf16 v27, v124, v124, v27
    v_dot2_f32_bf16 v26, v125, v29, v26
    v_dot2_f32_bf16 v27, v125, v125, v27
    v_dot2_f32_bf16 v26, v126, v29, v26
    v_dot2_f32_bf16 v27, v126, v126, v27
    v_dot2_f32_bf16 v26, v127, v29, v26
    v_dot2_f32_bf16 v27, v127, v127, v27
L_qkv1_kernel_st_62:
    s_add_u32 m0, s59, 6144
    s_add_u32 s60, s52, 1474560
    buffer_load_dwordx4 v7, s[32:35], s60 offen lds
    ds_read_b128 v[112:115], v90 offset:768
    ds_read_b128 v[116:119], v90 offset:33536
    s_waitcnt vmcnt(5)
    ds_read_b64_tr_b16 v[20:21], v8 offset:1024
    ds_read_b64_tr_b16 v[22:23], v8 offset:1280
    s_waitcnt lgkmcnt(4)
    v_mfma_f32_32x32x16_bf16 v[32:47], v[96:99], v[16:19], v[32:47]
    v_mfma_f32_32x32x16_bf16 v[48:63], v[100:103], v[16:19], v[48:63]
    v_dot2_f32_bf16 v28, v16, v29, v28
    v_dot2_f32_bf16 v28, v17, v29, v28
    v_dot2_f32_bf16 v28, v18, v29, v28
    v_dot2_f32_bf16 v28, v19, v29, v28
    s_cmp_lg_u32 s50, 0
    s_cbranch_scc1 L_qkv1_kernel_st_63
    v_dot2_f32_bf16 v24, v96, v29, v24
    v_dot2_f32_bf16 v25, v96, v96, v25
    v_dot2_f32_bf16 v24, v97, v29, v24
    v_dot2_f32_bf16 v25, v97, v97, v25
    v_dot2_f32_bf16 v24, v98, v29, v24
    v_dot2_f32_bf16 v25, v98, v98, v25
    v_dot2_f32_bf16 v24, v99, v29, v24
    v_dot2_f32_bf16 v25, v99, v99, v25
    v_dot2_f32_bf16 v26, v100, v29, v26
    v_dot2_f32_bf16 v27, v100, v100, v27
    v_dot2_f32_bf16 v26, v101, v29, v26
    v_dot2_f32_bf16 v27, v101, v101, v27
    v_dot2_f32_bf16 v26, v102, v29, v26
    v_dot2_f32_bf16 v27, v102, v102, v27
    v_dot2_f32_bf16 v26, v103, v29, v26
    v_dot2_f32_bf16 v27, v103, v103, v27
L_qkv1_kernel_st_63:
    s_add_u32 m0, s59, 7168
    s_add_u32 s60, s52, 1523712
    buffer_load_dwordx4 v7, s[32:35], s60 offen lds
    ds_read_b128 v[120:123], v91 offset:768
    ds_read_b128 v[124:127], v91 offset:33536
    s_waitcnt vmcnt(5)
    ds_read_b64_tr_b16 v[16:17], v8 offset:2048
    ds_read_b64_tr_b16 v[18:19], v8 offset:2304
    s_waitcnt lgkmcnt(4)
    v_mfma_f32_32x32x16_bf16 v[32:47], v[104:107], v[20:23], v[32:47]
    v_mfma_f32_32x32x16_bf16 v[48:63], v[108:111], v[20:23], v[48:63]
    v_dot2_f32_bf16 v28, v20, v29, v28
    v_dot2_f32_bf16 v28, v21, v29, v28
    v_dot2_f32_bf16 v28, v22, v29, v28
    v_dot2_f32_bf16 v28, v23, v29, v28
    s_cmp_lg_u32 s50, 1
    s_cbranch_scc1 L_qkv1_kernel_st_64
    v_dot2_f32_bf16 v24, v104, v29, v24
    v_dot2_f32_bf16 v25, v104, v104, v25
    v_dot2_f32_bf16 v24, v105, v29, v24
    v_dot2_f32_bf16 v25, v105, v105, v25
    v_dot2_f32_bf16 v24, v106, v29, v24
    v_dot2_f32_bf16 v25, v106, v106, v25
    v_dot2_f32_bf16 v24, v107, v29, v24
    v_dot2_f32_bf16 v25, v107, v107, v25
    v_dot2_f32_bf16 v26, v108, v29, v26
    v_dot2_f32_bf16 v27, v108, v108, v27
    v_dot2_f32_bf16 v26, v109, v29, v26
    v_dot2_f32_bf16 v27, v109, v109, v27
    v_dot2_f32_bf16 v26, v110, v29, v26
    v_dot2_f32_bf16 v27, v110, v110, v27
    v_dot2_f32_bf16 v26, v111, v29, v26
    v_dot2_f32_bf16 v27, v111, v111, v27
L_qkv1_kernel_st_64:
    ds_read_b128 v[96:99], v92 offset:768
    ds_read_b128 v[100:103], v92 offset:33536
    s_waitcnt vmcnt(4)
    ds_read_b64_tr_b16 v[20:21], v8 offset:3072
    ds_read_b64_tr_b16 v[22:23], v8 offset:3328
    s_waitcnt lgkmcnt(4)
    v_mfma_f32_32x32x16_bf16 v[32:47], v[112:115], v[16:19], v[32:47]
    v_mfma_f32_32x32x16_bf16 v[48:63], v[116:119], v[16:19], v[48:63]
    v_dot2_f32_bf16 v28, v16, v29, v28
    v_dot2_f32_bf16 v28, v17, v29, v28
    v_dot2_f32_bf16 v28, v18, v29, v28
    v_dot2_f32_bf16 v28, v19, v29, v28
    s_cmp_lg_u32 s50, 2
    s_cbranch_scc1 L_qkv1_kernel_st_65
    v_dot2_f32_bf16 v24, v112, v29, v24
    v_dot2_f32_bf16 v25, v112, v112, v25
    v_dot2_f32_bf16 v24, v113, v29, v24
    v_dot2_f32_bf16 v25, v113, v113, v25
    v_dot2_f32_bf16 v24, v114, v29, v24
    v_dot2_f32_bf16 v25, v114, v114, v25
    v_dot2_f32_bf16 v24, v115, v29, v24
    v_dot2_f32_bf16 v25, v115, v115, v25
    v_dot2_f32_bf16 v26, v116, v29, v26
    v_dot2_f32_bf16 v27, v116, v116, v27
    v_dot2_f32_bf16 v26, v117, v29, v26
    v_dot2_f32_bf16 v27, v117, v117, v27
    v_dot2_f32_bf16 v26, v118, v29, v26
    v_dot2_f32_bf16 v27, v118, v118, v27
    v_dot2_f32_bf16 v26, v119, v29, v26
    v_dot2_f32_bf16 v27, v119, v119, v27
L_qkv1_kernel_st_65:
    ds_read_b128 v[104:107], v93 offset:768
    ds_read_b128 v[108:111], v93 offset:33536
    s_waitcnt vmcnt(3)
    ds_read_b64_tr_b16 v[16:17], v8 offset:4096
    ds_read_b64_tr_b16 v[18:19], v8 offset:4352
    s_waitcnt lgkmcnt(4)
    v_mfma_f32_32x32x16_bf16 v[32:47], v[120:123], v[20:23], v[32:47]
    v_mfma_f32_32x32x16_bf16 v[48:63], v[124:127], v[20:23], v[48:63]
    v_dot2_f32_bf16 v28, v20, v29, v28
    v_dot2_f32_bf16 v28, v21, v29, v28
    v_dot2_f32_bf16 v28, v22, v29, v28
    v_dot2_f32_bf16 v28, v23, v29, v28
    s_cmp_lg_u32 s50, 3
    s_cbranch_scc1 L_qkv1_kernel_st_66
    v_dot2_f32_bf16 v24, v120, v29, v24
    v_dot2_f32_bf16 v25, v120, v120, v25
    v_dot2_f32_bf16 v24, v121, v29, v24
    v_dot2_f32_bf16 v25, v121, v121, v25
    v_dot2_f32_bf16 v24, v122, v29, v24
    v_dot2_f32_bf16 v25, v122, v122, v25
    v_dot2_f32_bf16 v24, v123, v29, v24
    v_dot2_f32_bf16 v25, v123, v123, v25
    v_dot2_f32_bf16 v26, v124, v29, v26
    v_dot2_f32_bf16 v27, v124, v124, v27
    v_dot2_f32_bf16 v26, v125, v29, v26
    v_dot2_f32_bf16 v27, v125, v125, v27
    v_dot2_f32_bf16 v26, v126, v29, v26
    v_dot2_f32_bf16 v27, v126, v126, v27
    v_dot2_f32_bf16 v26, v127, v29, v26
    v_dot2_f32_bf16 v27, v127, v127, v27
L_qkv1_kernel_st_66:
    ds_read_b128 v[112:115], v94 offset:768
    ds_read_b128 v[116:119], v94 offset:33536
    s_waitcnt vmcnt(2)
    ds_read_b64_tr_b16 v[20:21], v8 offset:5120
    ds_read_b64_tr_b16 v[22:23], v8 offset:5376
    s_waitcnt lgkmcnt(4)
    v_mfma_f32_32x32x16_bf16 v[32:47], v[96:99], v[16:19], v[32:47]
    v_mfma_f32_32x32x16_bf16 v[48:63], v[100:103], v[16:19], v[48:63]
    v_dot2_f32_bf16 v28, v16, v29, v28
    v_dot2_f32_bf16 v28, v17, v29, v28
    v_dot2_f32_bf16 v28, v18, v29, v28
    v_dot2_f32_bf16 v28, v19, v29, v28
    s_cmp_lg_u32 s50, 4
    s_cbranch_scc1 L_qkv1_kernel_st_67
    v_dot2_f32_bf16 v24, v96, v29, v24
    v_dot2_f32_bf16 v25, v96, v96, v25
    v_dot2_f32_bf16 v24, v97, v29, v24
    v_dot2_f32_bf16 v25, v97, v97, v25
    v_dot2_f32_bf16 v24, v98, v29, v24
    v_dot2_f32_bf16 v25, v98, v98, v25
    v_dot2_f32_bf16 v24, v99, v29, v24
    v_dot2_f32_bf16 v25, v99, v99, v25
    v_dot2_f32_bf16 v26, v100, v29, v26
    v_dot2_f32_bf16 v27, v100, v100, v27
    v_dot2_f32_bf16 v26, v101, v29, v26
    v_dot2_f32_bf16 v27, v101, v101, v27
    v_dot2_f32_bf16 v26, v102, v29, v26
    v_dot2_f32_bf16 v27, v102, v102, v27
    v_dot2_f32_bf16 v26, v103, v29, v26
    v_dot2_f32_bf16 v27, v103, v103, v27
L_qkv1_kernel_st_67:
    ds_read_b128 v[120:123], v95 offset:768
    ds_read_b128 v[124:127], v95 offset:33536
    s_waitcnt vmcnt(1)
    ds_read_b64_tr_b16 v[16:17], v8 offset:6144
    ds_read_b64_tr_b16 v[18:19], v8 offset:6400
    s_waitcnt lgkmcnt(4)
    v_mfma_f32_32x32x16_bf16 v[32:47], v[104:107], v[20:23], v[32:47]
    v_mfma_f32_32x32x16_bf16 v[48:63], v[108:111], v[20:23], v[48:63]
    v_dot2_f32_bf16 v28, v20, v29, v28
    v_dot2_f32_bf16 v28, v21, v29, v28
    v_dot2_f32_bf16 v28, v22, v29, v28
    v_dot2_f32_bf16 v28, v23, v29, v28
    s_cmp_lg_u32 s50, 5
    s_cbranch_scc1 L_qkv1_kernel_st_68
    v_dot2_f32_bf16 v24, v104, v29, v24
    v_dot2_f32_bf16 v25, v104, v104, v25
    v_dot2_f32_bf16 v24, v105, v29, v24
    v_dot2_f32_bf16 v25, v105, v105, v25
    v_dot2_f32_bf16 v24, v106, v29, v24
    v_dot2_f32_bf16 v25, v106, v106, v25
    v_dot2_f32_bf16 v24, v107, v29, v24
    v_dot2_f32_bf16 v25, v107, v107, v25
    v_dot2_f32_bf16 v26, v108, v29, v26
    v_dot2_f32_bf16 v27, v108, v108, v27
    v_dot2_f32_bf16 v26, v109, v29, v26
    v_dot2_f32_bf16 v27, v109, v109, v27
    v_dot2_f32_bf16 v26, v110, v29, v26
    v_dot2_f32_bf16 v27, v110, v110, v27
    v_dot2_f32_bf16 v26, v111, v29, v26
    v_dot2_f32_bf16 v27, v111, v111, v27
L_qkv1_kernel_st_68:
    s_waitcnt vmcnt(0)
    ds_read_b64_tr_b16 v[20:21], v8 offset:7168
    ds_read_b64_tr_b16 v[22:23], v8 offset:7424
    s_waitcnt lgkmcnt(2)
    v_mfma_f32_32x32x16_bf16 v[32:47], v[112:115], v[16:19], v[32:47]
    v_mfma_f32_32x32x16_bf16 v[48:63], v[116:119], v[16:19], v[48:63]
    v_dot2_f32_bf16 v28, v16, v29, v28
    v_dot2_f32_bf16 v28, v17, v29, v28
    v_dot2_f32_bf16 v28, v18, v29, v28
    v_dot2_f32_bf16 v28, v19, v29, v28
    s_cmp_lg_u32 s50, 6
    s_cbranch_scc1 L_qkv1_kernel_st_69
    v_dot2_f32_bf16 v24, v112, v29, v24
    v_dot2_f32_bf16 v25, v112, v112, v25
    v_dot2_f32_bf16 v24, v113, v29, v24
    v_dot2_f32_bf16 v25, v113, v113, v25
    v_dot2_f32_bf16 v24, v114, v29, v24
    v_dot2_f32_bf16 v25, v114, v114, v25
    v_dot2_f32_bf16 v24, v115, v29, v24
    v_dot2_f32_bf16 v25, v115, v115, v25
    v_dot2_f32_bf16 v26, v116, v29, v26
    v_dot2_f32_bf16 v27, v116, v116, v27
    v_dot2_f32_bf16 v26, v117, v29, v26
    v_dot2_f32_bf16 v27, v117, v117, v27
    v_dot2_f32_bf16 v26, v118, v29, v26
    v_dot2_f32_bf16 v27, v118, v118, v27
    v_dot2_f32_bf16 v26, v119, v29, v26
    v_dot2_f32_bf16 v27, v119, v119, v27
L_qkv1_kernel_st_69:
    s_waitcnt lgkmcnt(0)
    v_mfma_f32_32x32x16_bf16 v[32:47], v[120:123], v[20:23], v[32:47]
    v_mfma_f32_32x32x16_bf16 v[48:63], v[124:127], v[20:23], v[48:63]
    v_dot2_f32_bf16 v28, v20, v29, v28
    v_dot2_f32_bf16 v28, v21, v29, v28
    v_dot2_f32_bf16 v28, v22, v29, v28
    v_dot2_f32_bf16 v28, v23, v29, v28
    s_cmp_lg_u32 s50, 7
    s_cbranch_scc1 L_qkv1_kernel_st_70
    v_dot2_f32_bf16 v24, v120, v29, v24
    v_dot2_f32_bf16 v25, v120, v120, v25
    v_dot2_f32_bf16 v24, v121, v29, v24
    v_dot2_f32_bf16 v25, v121, v121, v25
    v_dot2_f32_bf16 v24, v122, v29, v24
    v_dot2_f32_bf16 v25, v122, v122, v25
    v_dot2_f32_bf16 v24, v123, v29, v24
    v_dot2_f32_bf16 v25, v123, v123, v25
    v_dot2_f32_bf16 v26, v124, v29, v26
    v_dot2_f32_bf16 v27, v124, v124, v27
    v_dot2_f32_bf16 v26, v125, v29, v26
    v_dot2_f32_bf16 v27, v125, v125, v27
    v_dot2_f32_bf16 v26, v126, v29, v26
    v_dot2_f32_bf16 v27, v126, v126, v27
    v_dot2_f32_bf16 v26, v127, v29, v26
    v_dot2_f32_bf16 v27, v127, v127, v27
L_qkv1_kernel_st_70:
    s_nop 3
    v_lshlrev_b32 v30, 4, v4
    v_lshl_add_u32 v30, v5, 3, v30
    s_lshl_b32 s51, s50, 10
    s_add_u32 s51, s51, 131072
    v_add_u32 v30, s51, v30
    ds_write_b64 v30, v[24:25]
    ds_write_b64 v30, v[26:27] offset:512
    v_mov_b32 v31, v28
    s_nop 1
    v_permlane32_swap_b32 v28, v31
    s_nop 1
    v_add_f32 v28, v28, v31
    v_lshlrev_b32 v31, 2, v4
    s_lshl_b32 s51, s50, 7
    s_add_u32 s51, s51, 139776
    v_add_u32 v31, s51, v31
    ds_write_b32 v31, v28
    s_waitcnt lgkmcnt(0)
    s_barrier
    v_lshrrev_b32 v30, 3, v1
    v_and_b32 v31, 7, v1
    v_lshlrev_b32 v31, 10, v31
    v_lshl_add_u32 v31, v30, 4, v31
    s_lshl_b32 s51, s50, 7
    s_add_u32 s51, s51, 131072
    v_add_u32 v31, s51, v31
    ds_read_b128 v[64:67], v31
    s_waitcnt lgkmcnt(0)
    v_pk_add_f32 v[24:25], v[64:65], v[66:67]
    s_nop 1
    v_add_f32_dpp v24, v24, v24 quad_perm:[1,0,3,2] row_mask:0xf bank_mask:0xf
    v_add_f32_dpp v25, v25, v25 quad_perm:[1,0,3,2] row_mask:0xf bank_mask:0xf
    s_nop 1
    v_add_f32_dpp v24, v24, v24 quad_perm:[2,3,0,1] row_mask:0xf bank_mask:0xf
    v_add_f32_dpp v25, v25, v25 quad_perm:[2,3,0,1] row_mask:0xf bank_mask:0xf
    s_nop 1
    v_add_f32_dpp v24, v24, v24 row_half_mirror row_mask:0xf bank_mask:0xf
    v_add_f32_dpp v25, v25, v25 row_half_mirror row_mask:0xf bank_mask:0xf
    v_mul_f32 v27, 0x3b000000, v24
    v_mul_f32 v26, 0x3b000000, v25
    v_fma_f32 v26, -v27, v27, v26
    v_max_f32 v26, 0, v26
    v_cvt_pk_bf16_f32 v24, v27, v26
    v_lshlrev_b32 v27, 16, v24
    v_and_b32 v26, 0xffff0000, v24
    v_add_f32 v26, 0x3727c5ac, v26
    v_cvt_pk_bf16_f32 v24, v26, v26
    v_and_b32 v26, 0xffff0000, v24
    v_sqrt_f32 v26, v26
    s_nop 0
    v_cvt_pk_bf16_f32 v24, v26, v26
    v_and_b32 v26, 0xffff0000, v24
    v_rcp_f32 v26, v26
    s_nop 0
    v_mul_f32 v27, v27, v26
    v_sub_f32 v27, 0, v27
    v_lshlrev_b32 v30, 3, v30
    s_lshl_b32 s51, s50, 6
    s_add_u32 s51, s51, 139264
    v_add_u32 v30, s51, v30
    ds_write_b64 v30, v[26:27]
    s_waitcnt lgkmcnt(0)
    s_barrier
    v_bfe_u32 v7, v1, 4, 1
    v_lshlrev_b32 v7, 16, v7
    v_lshl_add_u32 v7, v5, 8, v7
    v_and_b32 v6, 15, v1
    v_lshl_add_u32 v7, v6, 4, v7
    v_lshlrev_b32 v30, 5, v5
    v_add_u32 v30, 139264, v30
    ds_read_b128 v[64:67], v30 offset:0
    ds_read_b128 v[68:71], v30 offset:16
    ds_read_b128 v[72:75], v30 offset:64
    ds_read_b128 v[76:79], v30 offset:80
    ds_read_b128 v[80:83], v30 offset:128
    ds_read_b128 v[84:87], v30 offset:144
    ds_read_b128 v[88:91], v30 offset:192
    ds_read_b128 v[92:95], v30 offset:208
    ds_read_b128 v[96:99], v30 offset:256
    ds_read_b128 v[100:103], v30 offset:272
    ds_read_b128 v[104:107], v30 offset:320
    ds_read_b128 v[108:111], v30 offset:336
    ds_read_b128 v[112:115], v30 offset:384
    ds_read_b128 v[116:119], v30 offset:400
    ds_read_b128 v[120:123], v30 offset:448
    ds_read_b128 v[124:127], v30 offset:464
    s_waitcnt lgkmcnt(0)
    v_mul_f32 v32, v32, v64
    v_fma_f32 v32, v65, v28, v32
    v_mul_f32 v33, v33, v66
    v_fma_f32 v33, v67, v28, v33
    v_mul_f32 v34, v34, v68
    v_fma_f32 v34, v69, v28, v34
    v_mul_f32 v35, v35, v70
    v_fma_f32 v35, v71, v28, v35
    v_mul_f32 v36, v36, v72
    v_fma_f32 v36, v73, v28, v36
    v_mul_f32 v37, v37, v74
    v_fma_f32 v37, v75, v28, v37
    v_mul_f32 v38, v38, v76
    v_fma_f32 v38, v77, v28, v38
    v_mul_f32 v39, v39, v78
    v_fma_f32 v39, v79, v28, v39
    v_mul_f32 v40, v40, v80
    v_fma_f32 v40, v81, v28, v40
    v_mul_f32 v41, v41, v82
    v_fma_f32 v41, v83, v28, v41
    v_mul_f32 v42, v42, v84
    v_fma_f32 v42, v85, v28, v42
    v_mul_f32 v43, v43, v86
    v_fma_f32 v43, v87, v28, v43
    v_mul_f32 v44, v44, v88
    v_fma_f32 v44, v89, v28, v44
    v_mul_f32 v45, v45, v90
    v_fma_f32 v45, v91, v28, v45
    v_mul_f32 v46, v46, v92
    v_fma_f32 v46, v93, v28, v46
    v_mul_f32 v47, v47, v94
    v_fma_f32 v47, v95, v28, v47
    v_cvt_pk_bf16_f32 v12, v32, v33
    v_cvt_pk_bf16_f32 v13, v34, v35
    v_cvt_pk_bf16_f32 v14, v36, v37
    v_cvt_pk_bf16_f32 v15, v38, v39
    s_add_u32 s51, s56, 0
    buffer_store_dwordx4 v[12:15], v7, s[36:39], s51 offen
    s_nop 1
    v_cvt_pk_bf16_f32 v16, v40, v41
    v_cvt_pk_bf16_f32 v17, v42, v43
    v_cvt_pk_bf16_f32 v18, v44, v45
    v_cvt_pk_bf16_f32 v19, v46, v47
    s_add_u32 s51, s56, 512
    buffer_store_dwordx4 v[16:19], v7, s[36:39], s51 offen
    s_nop 1
    v_mul_f32 v48, v48, v96
    v_fma_f32 v48, v97, v28, v48
    v_mul_f32 v49, v49, v98
    v_fma_f32 v49, v99, v28, v49
    v_mul_f32 v50, v50, v100
    v_fma_f32 v50, v101, v28, v50
    v_mul_f32 v51, v51, v102
    v_fma_f32 v51, v103, v28, v51
    v_mul_f32 v52, v52, v104
    v_fma_f32 v52, v105, v28, v52
    v_mul_f32 v53, v53, v106
    v_fma_f32 v53, v107, v28, v53
    v_mul_f32 v54, v54, v108
    v_fma_f32 v54, v109, v28, v54
    v_mul_f32 v55, v55, v110
    v_fma_f32 v55, v111, v28, v55
    v_mul_f32 v56, v56, v112
    v_fma_f32 v56, v113, v28, v56
    v_mul_f32 v57, v57, v114
    v_fma_f32 v57, v115, v28, v57
    v_mul_f32 v58, v58, v116
    v_fma_f32 v58, v117, v28, v58
    v_mul_f32 v59, v59, v118
    v_fma_f32 v59, v119, v28, v59
    v_mul_f32 v60, v60, v120
    v_fma_f32 v60, v121, v28, v60
    v_mul_f32 v61, v61, v122
    v_fma_f32 v61, v123, v28, v61
    v_mul_f32 v62, v62, v124
    v_fma_f32 v62, v125, v28, v62
    v_mul_f32 v63, v63, v126
    v_fma_f32 v63, v127, v28, v63
    v_cvt_pk_bf16_f32 v12, v48, v49
    v_cvt_pk_bf16_f32 v13, v50, v51
    v_cvt_pk_bf16_f32 v14, v52, v53
    v_cvt_pk_bf16_f32 v15, v54, v55
    s_add_u32 s51, s56, 1024
    buffer_store_dwordx4 v[12:15], v7, s[36:39], s51 offen
    s_nop 1
    v_cvt_pk_bf16_f32 v16, v56, v57
    v_cvt_pk_bf16_f32 v17, v58, v59
    v_cvt_pk_bf16_f32 v18, v60, v61
    v_cvt_pk_bf16_f32 v19, v62, v63
    s_add_u32 s51, s56, 1536
    buffer_store_dwordx4 v[16:19], v7, s[36:39], s51 offen
    s_nop 1
L_qkv1_kernel_end:
    s_endpgm
.globl attn_kernel
.p2align 8
.type attn_kernel,@function
attn_kernel:
    s_cmp_ge_u32 s2, 256
    s_cbranch_scc1 L_attn_kernel_end
    s_load_dwordx16 s[4:19], s[0:1], 0
    s_load_dwordx4 s[20:23], s[0:1], 64
    s_load_dwordx2 s[24:25], s[0:1], 80
    s_and_b32 s48, s2, 31
    s_lshr_b32 s49, s2, 5
    v_lshrrev_b32 v2, 6, v0
    v_and_b32 v1, 63, v0
    s_nop 0
    v_readfirstlane_b32 s50, v2
    s_waitcnt lgkmcnt(0)
    s_mov_b32 s28, s24
    s_and_b32 s29, s25, 0xffff
    s_mov_b32 s30, 0x00200000
    s_mov_b32 s31, 0x00020000
    s_add_u32 s32, s24, 0x00200000
    s_addc_u32 s33, s25, 0
    s_and_b32 s33, s33, 0xffff
    s_mov_b32 s34, 0x00200000
    s_mov_b32 s35, 0x00020000
    s_add_u32 s36, s24, 0x00400000
    s_addc_u32 s37, s25, 0
    s_and_b32 s37, s37, 0xffff
    s_mov_b32 s38, 0x00200000
    s_mov_b32 s39, 0x00020000
    s_add_u32 s40, s24, 0x00600000
    s_addc_u32 s41, s25, 0
    s_and_b32 s41, s41, 0xffff
    s_mov_b32 s42, 0x00200000
    s_mov_b32 s43, 0x00020000
    v_lshlrev_b32 v3, 4, v1
    s_lshl_b32 s51, s48, 16
    s_lshl_b32 s52, s49, 13
    s_add_u32 s51, s51, s52
    s_lshl_b32 s52, s50, 10
    s_add_u32 s51, s51, s52
    buffer_load_dwordx4 v[28:31], v3, s[28:31], s51 offen
    s_lshl_b32 s51, s48, 16
    s_lshl_b32 s52, s50, 13
    s_add_u32 s51, s51, s52
    s_add_u32 m0, s52, 0
    s_add_u32 s53, s51, 0
    buffer_load_dwordx4 v3, s[32:35], s53 offen offset:0 lds
    buffer_load_dwordx4 v3, s[32:35], s53 offen offset:1024 lds
    buffer_load_dwordx4 v3, s[32:35], s53 offen offset:2048 lds
    buffer_load_dwordx4 v3, s[32:35], s53 offen offset:3072 lds
    s_add_u32 m0, s52, 4096
    s_add_u32 s53, s51, 4096
    buffer_load_dwordx4 v3, s[32:35], s53 offen offset:0 lds
    buffer_load_dwordx4 v3, s[32:35], s53 offen offset:1024 lds
    buffer_load_dwordx4 v3, s[32:35], s53 offen offset:2048 lds
    buffer_load_dwordx4 v3, s[32:35], s53 offen offset:3072 lds
    s_add_u32 m0, s52, 65536
    s_add_u32 s53, s51, 0
    buffer_load_dwordx4 v3, s[36:39], s53 offen offset:0 lds
    buffer_load_dwordx4 v3, s[36:39], s53 offen offset:1024 lds
    buffer_load_dwordx4 v3, s[36:39], s53 offen offset:2048 lds
    buffer_load_dwordx4 v3, s[36:39], s53 offen offset:3072 lds
    s_add_u32 m0, s52, 69632
    s_add_u32 s53, s51, 4096
    buffer_load_dwordx4 v3, s[36:39], s53 offen offset:0 lds
    buffer_load_dwordx4 v3, s[36:39], s53 offen offset:1024 lds
    buffer_load_dwordx4 v3, s[36:39], s53 offen offset:2048 lds
    buffer_load_dwordx4 v3, s[36:39], s53 offen offset:3072 lds
    v_mov_b32 v8, 0x3f803f80
    v_mov_b32 v9, 0x3f803f80
    v_lshlrev_b32 v12, 3, v0
    v_add_u32 v12, 131072, v12
    ds_write_b64 v12, v[8:9]
    v_lshrrev_b32 v5, 5, v1
    v_and_b32 v13, 15, v1
    v_lshlrev_b32 v13, 4, v13
    v_lshl_add_u32 v13, v5, 8, v13
    v_add_u32 v14, 65536, v13
    v_add_u32 v15, 131072, v13
    v_and_b32 v16, 16, v1
    v_cmp_eq_u32 vcc, 0, v16
    v_mov_b32 v16, 0
    v_mov_b32 v19, 4096
    s_nop 1
    v_cndmask_b32 v17, v16, v19, vcc
    v_cndmask_b32 v18, v15, v14, vcc
    v_mov_b32 v19, 0x12800000
    s_waitcnt vmcnt(8) lgkmcnt(0)
    s_barrier
    s_lshl_b32 s51, s50, 13
    v_add_u32 v22, s51, v3
    ds_read_b128 v[32:35], v22 offset:0
    ds_read_b128 v[36:39], v22 offset:1024
    ds_read_b128 v[40:43], v22 offset:2048
    ds_read_b128 v[44:47], v22 offset:3072
    ds_read_b128 v[48:51], v22 offset:4096
    ds_read_b128 v[52:55], v22 offset:5120
    ds_read_b128 v[56:59], v22 offset:6144
    ds_read_b128 v[60:63], v22 offset:7168
    v_mov_b32 v24, 0
    s_waitcnt lgkmcnt(7)
    v_mov_b32 v64, 0
    v_dot2_f32_bf16 v64, v32, v32, v64
    v_dot2_f32_bf16 v64, v33, v33, v64
    v_dot2_f32_bf16 v64, v34, v34, v64
    v_dot2_f32_bf16 v64, v35, v35, v64
    s_waitcnt lgkmcnt(6)
    v_mov_b32 v65, 0
    v_dot2_f32_bf16 v65, v36, v36, v65
    v_dot2_f32_bf16 v65, v37, v37, v65
    v_dot2_f32_bf16 v65, v38, v38, v65
    v_dot2_f32_bf16 v65, v39, v39, v65
    s_waitcnt lgkmcnt(5)
    v_mov_b32 v66, 0
    v_dot2_f32_bf16 v66, v40, v40, v66
    v_dot2_f32_bf16 v66, v41, v41, v66
    v_dot2_f32_bf16 v66, v42, v42, v66
    v_dot2_f32_bf16 v66, v43, v43, v66
    s_waitcnt lgkmcnt(4)
    v_mov_b32 v67, 0
    v_dot2_f32_bf16 v67, v44, v44, v67
    v_dot2_f32_bf16 v67, v45, v45, v67
    v_dot2_f32_bf16 v67, v46, v46, v67
    v_dot2_f32_bf16 v67, v47, v47, v67
    s_waitcnt lgkmcnt(3)
    v_mov_b32 v68, 0
    v_dot2_f32_bf16 v68, v48, v48, v68
    v_dot2_f32_bf16 v68, v49, v49, v68
    v_dot2_f32_bf16 v68, v50, v50, v68
    v_dot2_f32_bf16 v68, v51, v51, v68
    s_waitcnt lgkmcnt(2)
    v_mov_b32 v69, 0
    v_dot2_f32_bf16 v69, v52, v52, v69
    v_dot2_f32_bf16 v69, v53, v53, v69
    v_dot2_f32_bf16 v69, v54, v54, v69
    v_dot2_f32_bf16 v69, v55, v55, v69
    s_waitcnt lgkmcnt(1)
    v_mov_b32 v70, 0
    v_dot2_f32_bf16 v70, v56, v56, v70
    v_dot2_f32_bf16 v70, v57, v57, v70
    v_dot2_f32_bf16 v70, v58, v58, v70
    v_dot2_f32_bf16 v70, v59, v59, v70
    s_waitcnt lgkmcnt(0)
    v_mov_b32 v71, 0
    v_dot2_f32_bf16 v71, v60, v60, v71
    v_dot2_f32_bf16 v71, v61, v61, v71
    v_dot2_f32_bf16 v71, v62, v62, v71
    v_dot2_f32_bf16 v71, v63, v63, v71
    v_mov_b32 v25, 0
    v_dot2_f32_bf16 v25, v28, v28, v25
    v_dot2_f32_bf16 v25, v29, v29, v25
    v_dot2_f32_bf16 v25, v30, v30, v25
    v_dot2_f32_bf16 v25, v31, v31, v25
    s_nop 2
    v_max3_f32 v24, v64, v65, v66
    v_max3_f32 v26, v67, v68, v69
    v_max3_f32 v24, v24, v70, v71
    v_max_f32 v24, v24, v26
    s_nop 1
    v_max_f32_dpp v24, v24, v24 quad_perm:[1,0,3,2] row_mask:0xf bank_mask:0xf
    s_nop 1
    v_max_f32_dpp v24, v24, v24 quad_perm:[2,3,0,1] row_mask:0xf bank_mask:0xf
    s_nop 1
    v_max_f32_dpp v24, v24, v24 row_half_mirror row_mask:0xf bank_mask:0xf
    s_nop 1
    v_max_f32_dpp v24, v24, v24 row_mirror row_mask:0xf bank_mask:0xf
    v_lshrrev_b32 v26, 4, v1
    v_lshlrev_b32 v26, 2, v26
    s_lshl_b32 s51, s50, 4
    s_add_u32 s51, s51, 135168
    v_add_u32 v26, s51, v26
    ds_write_b32 v26, v24
    v_mov_b32 v26, v25
    s_nop 1
    v_permlane32_swap_b32 v25, v26
    s_nop 1
    v_add_f32 v25, v25, v26
    s_waitcnt vmcnt(0) lgkmcnt(0)
    s_barrier
    v_mov_b32 v26, 135168
    ds_read_b128 v[32:35], v26 offset:0
    ds_read_b128 v[36:39], v26 offset:16
    ds_read_b128 v[40:43], v26 offset:32
    ds_read_b128 v[44:47], v26 offset:48
    ds_read_b128 v[48:51], v26 offset:64
    ds_read_b128 v[52:55], v26 offset:80
    ds_read_b128 v[56:59], v26 offset:96
    ds_read_b128 v[60:63], v26 offset:112
    s_waitcnt lgkmcnt(0)
    v_max3_f32 v64, v32, v36, v40
    v_max3_f32 v64, v64, v44, v48
    v_max3_f32 v64, v64, v52, v56
    v_max_f32 v64, v64, v60
    v_max3_f32 v65, v33, v37, v41
    v_max3_f32 v65, v65, v45, v49
    v_max3_f32 v65, v65, v53, v57
    v_max_f32 v65, v65, v61
    v_max3_f32 v66, v34, v38, v42
    v_max3_f32 v66, v66, v46, v50
    v_max3_f32 v66, v66, v54, v58
    v_max_f32 v66, v66, v62
    v_max3_f32 v67, v35, v39, v43
    v_max3_f32 v67, v67, v47, v51
    v_max3_f32 v67, v67, v55, v59
    v_max_f32 v67, v67, v63
    v_max_f32 v64, v64, v65
    v_max_f32 v66, v66, v67
    v_add_f32 v64, v64, v66
    v_mul_f32 v24, v25, v64
    v_sqrt_f32 v24, v24
    s_nop 0
    v_fma_f32 v24, v24, 1.0, 0.5
    v_mul_f32 v24, 0xbf8020c5, v24
    s_mov_b32 s54, 0
L_attn_kernel_pass2_1:
    v_mov_b32 v32, v24
    v_mov_b32 v33, v24
    v_mov_b32 v34, v24
    v_mov_b32 v35, v24
    v_mov_b32 v36, v24
    v_mov_b32 v37, v24
    v_mov_b32 v38, v24
    v_mov_b32 v39, v24
    v_mov_b32 v40, v24
    v_mov_b32 v41, v24
    v_mov_b32 v42, v24
    v_mov_b32 v43, v24
    v_mov_b32 v44, v24
    v_mov_b32 v45, v24
    v_mov_b32 v46, v24
    v_mov_b32 v47, v24
    v_mov_b32 v80, 0
    v_mov_b32 v81, 0
    v_mov_b32 v82, 0
    v_mov_b32 v83, 0
    v_mov_b32 v84, 0
    v_mov_b32 v85, 0
    v_mov_b32 v86, 0
    v_mov_b32 v87, 0
    v_mov_b32 v88, 0
    v_mov_b32 v89, 0
    v_mov_b32 v90, 0
    v_mov_b32 v91, 0
    v_mov_b32 v92, 0
    v_mov_b32 v93, 0
    v_mov_b32 v94, 0
    v_mov_b32 v95, 0
    v_mov_b32 v22, v3
    v_mov_b32 v23, v18
    ds_read_b128 v[104:107], v22
    ds_read_b128 v[108:111], v22 offset:1024
    ds_read_b128 v[112:115], v23 offset:0
    ds_read_b128 v[116:119], v23 offset:512
    ds_read_b128 v[120:123], v23 offset:1024
    ds_read_b128 v[124:127], v23 offset:1536
    s_waitcnt lgkmcnt(5)
    v_mfma_f32_32x32x16_bf16 v[48:63], v[104:107], v[28:31], v[32:47]
    s_mov_b32 s52, 0
    s_nop 7
    s_nop 3
L_attn_kernel_p2_2:
    s_waitcnt lgkmcnt(0)
    v_mfma_f32_32x32x16_bf16 v[64:79], v[108:111], v[28:31], v[32:47]
    ds_read_b128 v[104:107], v22 offset:2048
    ds_read_b128 v[108:111], v22 offset:3072
    v_exp_f32 v48, v48
    v_exp_f32 v49, v49
    v_exp_f32 v50, v50
    v_exp_f32 v51, v51
    v_cvt_pk_bf16_f32 v96, v48, v49
    v_exp_f32 v52, v52
    v_exp_f32 v53, v53
    v_cvt_pk_bf16_f32 v97, v50, v51
    v_exp_f32 v54, v54
    v_exp_f32 v55, v55
    v_cvt_pk_bf16_f32 v98, v52, v53
    v_exp_f32 v56, v56
    v_exp_f32 v57, v57
    v_cvt_pk_bf16_f32 v99, v54, v55
    v_exp_f32 v58, v58
    v_exp_f32 v59, v59
    v_cvt_pk_bf16_f32 v100, v56, v57
    v_exp_f32 v60, v60
    v_exp_f32 v61, v61
    v_cvt_pk_bf16_f32 v101, v58, v59
    v_exp_f32 v62, v62
    v_exp_f32 v63, v63
    v_cvt_pk_bf16_f32 v102, v60, v61
    v_mfma_f32_32x32x16_bf16 v[80:95], v[112:115], v[96:99], v[80:95]
    v_cvt_pk_bf16_f32 v103, v62, v63
    s_nop 1
    v_mfma_f32_32x32x16_bf16 v[80:95], v[116:119], v[100:103], v[80:95]
    ds_read_b128 v[112:115], v23 offset:2048
    ds_read_b128 v[116:119], v23 offset:2560
    s_waitcnt lgkmcnt(2)
    v_mfma_f32_32x32x16_bf16 v[48:63], v[104:107], v[28:31], v[32:47]
    v_exp_f32 v64, v64
    v_exp_f32 v65, v65
    v_exp_f32 v66, v66
    v_exp_f32 v67, v67
    v_cvt_pk_bf16_f32 v96, v64, v65
    v_exp_f32 v68, v68
    v_exp_f32 v69, v69
    v_cvt_pk_bf16_f32 v97, v66, v67
    v_exp_f32 v70, v70
    v_exp_f32 v71, v71
    v_cvt_pk_bf16_f32 v98, v68, v69
    v_exp_f32 v72, v72
    v_exp_f32 v73, v73
    v_cvt_pk_bf16_f32 v99, v70, v71
    v_exp_f32 v74, v74
    v_exp_f32 v75, v75
    v_cvt_pk_bf16_f32 v100, v72, v73
    v_exp_f32 v76, v76
    v_exp_f32 v77, v77
    v_cvt_pk_bf16_f32 v101, v74, v75
    v_exp_f32 v78, v78
    v_exp_f32 v79, v79
    v_cvt_pk_bf16_f32 v102, v76, v77
    v_mfma_f32_32x32x16_bf16 v[80:95], v[120:123], v[96:99], v[80:95]
    v_cvt_pk_bf16_f32 v103, v78, v79
    s_nop 1
    v_mfma_f32_32x32x16_bf16 v[80:95], v[124:127], v[100:103], v[80:95]
    ds_read_b128 v[120:123], v23 offset:3072
    ds_read_b128 v[124:127], v23 offset:3584
    s_waitcnt lgkmcnt(0)
    v_mfma_f32_32x32x16_bf16 v[64:79], v[108:111], v[28:31], v[32:47]
    ds_read_b128 v[104:107], v22 offset:4096
    ds_read_b128 v[108:111], v22 offset:5120
    v_exp_f32 v48, v48
    v_exp_f32 v49, v49
    v_exp_f32 v50, v50
    v_exp_f32 v51, v51
    v_cvt_pk_bf16_f32 v96, v48, v49
    v_exp_f32 v52, v52
    v_exp_f32 v53, v53
    v_cvt_pk_bf16_f32 v97, v50, v51
    v_exp_f32 v54, v54
    v_exp_f32 v55, v55
    v_cvt_pk_bf16_f32 v98, v52, v53
    v_exp_f32 v56, v56
    v_exp_f32 v57, v57
    v_cvt_pk_bf16_f32 v99, v54, v55
    v_exp_f32 v58, v58
    v_exp_f32 v59, v59
    v_cvt_pk_bf16_f32 v100, v56, v57
    v_exp_f32 v60, v60
    v_exp_f32 v61, v61
    v_cvt_pk_bf16_f32 v101, v58, v59
    v_exp_f32 v62, v62
    v_exp_f32 v63, v63
    v_cvt_pk_bf16_f32 v102, v60, v61
    v_mfma_f32_32x32x16_bf16 v[80:95], v[112:115], v[96:99], v[80:95]
    v_cvt_pk_bf16_f32 v103, v62, v63
    s_nop 1
    v_mfma_f32_32x32x16_bf16 v[80:95], v[116:119], v[100:103], v[80:95]
    v_add_u32 v23, v23, v17
    ds_read_b128 v[112:115], v23 offset:0
    ds_read_b128 v[116:119], v23 offset:512
    s_waitcnt lgkmcnt(2)
    v_mfma_f32_32x32x16_bf16 v[48:63], v[104:107], v[28:31], v[32:47]
    v_add_u32 v22, 4096, v22
    s_add_u32 s52, s52, 1
    s_cmp_lt_u32 s52, 16
    v_exp_f32 v64, v64
    v_exp_f32 v65, v65
    v_exp_f32 v66, v66
    v_exp_f32 v67, v67
    v_cvt_pk_bf16_f32 v96, v64, v65
    v_exp_f32 v68, v68
    v_exp_f32 v69, v69
    v_cvt_pk_bf16_f32 v97, v66, v67
    v_exp_f32 v70, v70
    v_exp_f32 v71, v71
    v_cvt_pk_bf16_f32 v98, v68, v69
    v_exp_f32 v72, v72
    v_exp_f32 v73, v73
    v_cvt_pk_bf16_f32 v99, v70, v71
    v_exp_f32 v74, v74
    v_exp_f32 v75, v75
    v_cvt_pk_bf16_f32 v100, v72, v73
    v_exp_f32 v76, v76
    v_exp_f32 v77, v77
    v_cvt_pk_bf16_f32 v101, v74, v75
    v_exp_f32 v78, v78
    v_exp_f32 v79, v79
    v_cvt_pk_bf16_f32 v102, v76, v77
    v_mfma_f32_32x32x16_bf16 v[80:95], v[120:123], v[96:99], v[80:95]
    v_cvt_pk_bf16_f32 v103, v78, v79
    s_nop 1
    v_mfma_f32_32x32x16_bf16 v[80:95], v[124:127], v[100:103], v[80:95]
    ds_read_b128 v[120:123], v23 offset:1024
    ds_read_b128 v[124:127], v23 offset:1536
    s_cbranch_scc1 L_attn_kernel_p2_2
    s_waitcnt lgkmcnt(0)
    s_nop 15
    s_nop 3
    v_cmp_nge_f32 vcc, v88, v19
    s_cmp_lg_u32 s54, 0
    s_cbranch_scc1 L_attn_kernel_ok_3
    s_cbranch_vccz L_attn_kernel_ok_3
    s_mov_b32 s54, 1
    v_mov_b32 v22, v3
    v_mov_b32 v24, 0xff800000
    v_mov_b32 v25, 0xff800000
    v_mov_b32 v26, 0xff800000
    v_mov_b32 v27, 0xff800000
    ds_read_b128 v[96:99], v22 offset:0
    ds_read_b128 v[100:103], v22 offset:1024
    ds_read_b128 v[104:107], v22 offset:2048
    ds_read_b128 v[108:111], v22 offset:3072
    s_waitcnt lgkmcnt(2)
    v_mfma_f32_32x32x16_bf16 v[32:47], v[96:99], v[28:31], 0
    v_mfma_f32_32x32x16_bf16 v[48:63], v[100:103], v[28:31], 0
    ds_read_b128 v[96:99], v22 offset:4096
    ds_read_b128 v[100:103], v22 offset:5120
    s_mov_b32 s52, 0
L_attn_kernel_p1_4:
    s_waitcnt lgkmcnt(2)
    v_mfma_f32_32x32x16_bf16 v[64:79], v[104:107], v[28:31], 0
    v_mfma_f32_32x32x16_bf16 v[80:95], v[108:111], v[28:31], 0
    ds_read_b128 v[104:107], v22 offset:6144
    ds_read_b128 v[108:111], v22 offset:7168
    s_add_u32 s52, s52, 1
    s_cmp_lt_u32 s52, 16
    v_add_u32 v22, 4096, v22
    s_nop 4
    v_max3_f32 v24, v24, v32, v33
    v_max3_f32 v25, v25, v34, v35
    v_max3_f32 v26, v26, v36, v37
    v_max3_f32 v27, v27, v38, v39
    v_max3_f32 v24, v24, v40, v41
    v_max3_f32 v25, v25, v42, v43
    v_max3_f32 v26, v26, v44, v45
    v_max3_f32 v27, v27, v46, v47
    v_max3_f32 v24, v24, v48, v49
    v_max3_f32 v25, v25, v50, v51
    v_max3_f32 v26, v26, v52, v53
    v_max3_f32 v27, v27, v54, v55
    v_max3_f32 v24, v24, v56, v57
    v_max3_f32 v25, v25, v58, v59
    v_max3_f32 v26, v26, v60, v61
    v_max3_f32 v27, v27, v62, v63
    s_waitcnt lgkmcnt(2)
    v_mfma_f32_32x32x16_bf16 v[32:47], v[96:99], v[28:31], 0
    v_mfma_f32_32x32x16_bf16 v[48:63], v[100:103], v[28:31], 0
    ds_read_b128 v[96:99], v22 offset:4096
    ds_read_b128 v[100:103], v22 offset:5120
    v_max3_f32 v24, v24, v64, v65
    v_max3_f32 v25, v25, v66, v67
    v_max3_f32 v26, v26, v68, v69
    v_max3_f32 v27, v27, v70, v71
    v_max3_f32 v24, v24, v72, v73
    v_max3_f32 v25, v25, v74, v75
    v_max3_f32 v26, v26, v76, v77
    v_max3_f32 v27, v27, v78, v79
    v_max3_f32 v24, v24, v80, v81
    v_max3_f32 v25, v25, v82, v83
    v_max3_f32 v26, v26, v84, v85
    v_max3_f32 v27, v27, v86, v87
    v_max3_f32 v24, v24, v88, v89
    v_max3_f32 v25, v25, v90, v91
    v_max3_f32 v26, v26, v92, v93
    v_max3_f32 v27, v27, v94, v95
    s_cbranch_scc1 L_attn_kernel_p1_4
    v_max3_f32 v24, v24, v25, v26
    v_max_f32 v24, v24, v27
    v_mov_b32 v25, v24
    s_nop 1
    v_permlane32_swap_b32 v24, v25
    s_nop 1
    v_max_f32 v24, v24, v25
    v_sub_f32 v24, 0, v24
    s_waitcnt lgkmcnt(0)
    s_nop 7
    s_branch L_attn_kernel_pass2_1
L_attn_kernel_ok_3:
    v_rcp_f32 v24, v88
    s_nop 0
    v_mul_f32 v80, v80, v24
    v_mul_f32 v81, v81, v24
    v_mul_f32 v82, v82, v24
    v_mul_f32 v83, v83, v24
    v_mul_f32 v84, v84, v24
    v_mul_f32 v85, v85, v24
    v_mul_f32 v86, v86, v24
    v_mul_f32 v87, v87, v24
    v_cvt_pk_bf16_f32 v96, v80, v81
    v_cvt_pk_bf16_f32 v97, v82, v83
    v_cvt_pk_bf16_f32 v98, v84, v85
    v_cvt_pk_bf16_f32 v99, v86, v87
    v_and_b32 v24, 31, v1
    v_lshlrev_b32 v24, 4, v24
    v_lshl_add_u32 v24, v5, 3, v24
    s_lshl_b32 s51, s49, 18
    s_lshl_b32 s52, s50, 15
    s_add_u32 s51, s51, s52
    s_lshl_b32 s52, s48, 10
    s_add_u32 s51, s51, s52
    buffer_store_dwordx2 v[96:97], v24, s[40:43], s51 offen
    buffer_store_dwordx2 v[98:99], v24, s[40:43], s51 offen offset:512
    s_waitcnt lgkmcnt(0)
L_attn_kernel_end:
    s_endpgm
.globl wo1_kernel
.p2align 8
.type wo1_kernel,@function
wo1_kernel:
    s_cmp_ge_u32 s2, 256
    s_cbranch_scc1 L_wo1_kernel_end
    s_load_dwordx16 s[4:19], s[0:1], 0
    s_load_dwordx4 s[20:23], s[0:1], 64
    s_load_dwordx2 s[24:25], s[0:1], 80
    s_and_b32 s51, s2, 7
    s_lshl_b32 s48, s51, 2
    s_lshr_b32 s51, s2, 6
    s_add_u32 s48, s48, s51
    s_lshr_b32 s49, s2, 3
    s_and_b32 s49, s49, 7
    v_lshrrev_b32 v2, 6, v0
    v_and_b32 v1, 63, v0
    v_lshlrev_b32 v3, 4, v1
    v_readfirstlane_b32 s50, v2
    s_waitcnt lgkmcnt(0)
    s_add_u32 s28, s24, 0x00600000
    s_addc_u32 s29, s25, 0
    s_and_b32 s29, s29, 0xffff
    s_mov_b32 s30, 0x00200000
    s_mov_b32 s31, 0x00020000
    s_add_u32 s32, s24, 0x01800000
    s_addc_u32 s33, s25, 0
    s_and_b32 s33, s33, 0xffff
    s_mov_b32 s34, 0x00080000
    s_mov_b32 s35, 0x00020000
    s_mov_b32 s36, s4
    s_and_b32 s37, s5, 0xffff
    s_mov_b32 s38, 0x00200000
    s_mov_b32 s39, 0x00020000
    s_add_u32 s40, s24, 0x00800000
    s_addc_u32 s41, s25, 0
    s_and_b32 s41, s41, 0xffff
    s_mov_b32 s42, 0x00200000
    s_mov_b32 s43, 0x00020000
    s_add_u32 s56, s24, 0x02100000
    s_addc_u32 s57, s25, 0
    s_and_b32 s57, s57, 0xffff
    s_mov_b32 s58, 0x00080000
    s_mov_b32 s59, 0x00020000
    s_mul_i32 s51, s50, 8192
    s_mul_i32 s53, s48, 65536
    s_add_u32 s53, s53, s51
    s_mul_i32 s54, s49, 65536
    s_add_u32 s54, s54, s51
    v_lshrrev_b32 v15, 5, v1
    v_and_b32 v14, 31, v1
    v_lshlrev_b32 v16, 4, v14
    v_lshl_add_u32 v16, v15, 3, v16
    s_lshr_b32 s51, s50, 1
    s_lshl_b32 s52, s48, 1
    s_add_u32 s51, s51, s52
    s_lshl_b32 s55, s51, 15
    s_lshl_b32 s52, s49, 12
    s_add_u32 s55, s55, s52
    s_and_b32 s52, s50, 1
    s_lshl_b32 s52, s52, 11
    s_add_u32 s55, s55, s52
    s_add_u32 s51, s53, 0
    buffer_load_dwordx4 a[0:3], v3, s[28:31], s51 offen
    s_add_u32 s51, s53, 32768
    buffer_load_dwordx4 a[4:7], v3, s[28:31], s51 offen
    s_add_u32 s51, s54, 0
    buffer_load_dwordx4 a[8:11], v3, s[32:35], s51 offen
    s_add_u32 s51, s54, 32768
    buffer_load_dwordx4 a[12:15], v3, s[32:35], s51 offen
    s_add_u32 s51, s53, 1024
    buffer_load_dwordx4 a[16:19], v3, s[28:31], s51 offen
    s_add_u32 s51, s53, 33792
    buffer_load_dwordx4 a[20:23], v3, s[28:31], s51 offen
    s_add_u32 s51, s54, 1024
    buffer_load_dwordx4 a[24:27], v3, s[32:35], s51 offen
    s_add_u32 s51, s54, 33792
    buffer_load_dwordx4 a[28:31], v3, s[32:35], s51 offen
    s_add_u32 s51, s53, 2048
    buffer_load_dwordx4 a[32:35], v3, s[28:31], s51 offen
    s_add_u32 s51, s53, 34816
    buffer_load_dwordx4 a[36:39], v3, s[28:31], s51 offen
    s_add_u32 s51, s54, 2048
    buffer_load_dwordx4 a[40:43], v3, s[32:35], s51 offen
    s_add_u32 s51, s54, 34816
    buffer_load_dwordx4 a[44:47], v3, s[32:35], s51 offen
    s_add_u32 s51, s53, 3072
    buffer_load_dwordx4 a[48:51], v3, s[28:31], s51 offen
    s_add_u32 s51, s53, 35840
    buffer_load_dwordx4 a[52:55], v3, s[28:31], s51 offen
    s_add_u32 s51, s54, 3072
    buffer_load_dwordx4 a[56:59], v3, s[32:35], s51 offen
    s_add_u32 s51, s54, 35840
    buffer_load_dwordx4 a[60:63], v3, s[32:35], s51 offen
    s_add_u32 s51, s53, 4096
    buffer_load_dwordx4 a[64:67], v3, s[28:31], s51 offen
    s_add_u32 s51, s53, 36864
    buffer_load_dwordx4 a[68:71], v3, s[28:31], s51 offen
    s_add_u32 s51, s54, 4096
    buffer_load_dwordx4 a[72:75], v3, s[32:35], s51 offen
    s_add_u32 s51, s54, 36864
    buffer_load_dwordx4 a[76:79], v3, s[32:35], s51 offen
    s_add_u32 s51, s53, 5120
    buffer_load_dwordx4 a[80:83], v3, s[28:31], s51 offen
    s_add_u32 s51, s53, 37888
    buffer_load_dwordx4 a[84:87], v3, s[28:31], s51 offen
    s_add_u32 s51, s54, 5120
    buffer_load_dwordx4 a[88:91], v3, s[32:35], s51 offen
    s_add_u32 s51, s54, 37888
    buffer_load_dwordx4 a[92:95], v3, s[32:35], s51 offen
    s_lshr_b32 s51, s50, 1
    s_lshl_b32 s51, s51, 5
    s_lshl_b32 s52, s48, 6
    s_add_u32 s51, s51, s52
    v_add_u32 v19, s51, v14
    v_lshlrev_b32 v19, 10, v19
    v_lshl_add_u32 v19, v15, 3, v19
    s_lshl_b32 s51, s49, 7
    s_and_b32 s52, s50, 1
    s_lshl_b32 s52, s52, 6
    s_add_u32 s51, s51, s52
    buffer_load_dwordx2 v[40:41], v19, s[36:39], s51 offen offset:0
    buffer_load_dwordx2 v[42:43], v19, s[36:39], s51 offen offset:16
    buffer_load_dwordx2 v[44:45], v19, s[36:39], s51 offen offset:32
    buffer_load_dwordx2 v[46:47], v19, s[36:39], s51 offen offset:48
    v_mov_b32 v64, 0
    v_mov_b32 v65, 0
    v_mov_b32 v66, 0
    v_mov_b32 v67, 0
    v_mov_b32 v68, 0
    v_mov_b32 v69, 0
    v_mov_b32 v70, 0
    v_mov_b32 v71, 0
    v_mov_b32 v72, 0
    v_mov_b32 v73, 0
    v_mov_b32 v74, 0
    v_mov_b32 v75, 0
    v_mov_b32 v76, 0
    v_mov_b32 v77, 0
    v_mov_b32 v78, 0
    v_mov_b32 v79, 0
    v_mov_b32 v80, 0
    v_mov_b32 v81, 0
    v_mov_b32 v82, 0
    v_mov_b32 v83, 0
    v_mov_b32 v84, 0
    v_mov_b32 v85, 0
    v_mov_b32 v86, 0
    v_mov_b32 v87, 0
    v_mov_b32 v88, 0
    v_mov_b32 v89, 0
    v_mov_b32 v90, 0
    v_mov_b32 v91, 0
    v_mov_b32 v92, 0
    v_mov_b32 v93, 0
    v_mov_b32 v94, 0
    v_mov_b32 v95, 0
    v_mov_b32 v96, 0
    v_mov_b32 v97, 0
    v_mov_b32 v98, 0
    v_mov_b32 v99, 0
    v_mov_b32 v100, 0
    v_mov_b32 v101, 0
    v_mov_b32 v102, 0
    v_mov_b32 v103, 0
    v_mov_b32 v104, 0
    v_mov_b32 v105, 0
    v_mov_b32 v106, 0
    v_mov_b32 v107, 0
    v_mov_b32 v108, 0
    v_mov_b32 v109, 0
    v_mov_b32 v110, 0
    v_mov_b32 v111, 0
    v_mov_b32 v112, 0
    v_mov_b32 v113, 0
    v_mov_b32 v114, 0
    v_mov_b32 v115, 0
    v_mov_b32 v116, 0
    v_mov_b32 v117, 0
    v_mov_b32 v118, 0
    v_mov_b32 v119, 0
    v_mov_b32 v120, 0
    v_mov_b32 v121, 0
    v_mov_b32 v122, 0
    v_mov_b32 v123, 0
    v_mov_b32 v124, 0
    v_mov_b32 v125, 0
    v_mov_b32 v126, 0
    v_mov_b32 v127, 0
    s_waitcnt vmcnt(24)
    v_mfma_f32_32x32x16_bf16 v[64:79], a[8:11], a[0:3], v[64:79]
    v_mfma_f32_32x32x16_bf16 v[80:95], a[12:15], a[0:3], v[80:95]
    v_mfma_f32_32x32x16_bf16 v[96:111], a[8:11], a[4:7], v[96:111]
    v_mfma_f32_32x32x16_bf16 v[112:127], a[12:15], a[4:7], v[112:127]
    s_add_u32 s51, s53, 6144
    buffer_load_dwordx4 a[96:99], v3, s[28:31], s51 offen
    s_add_u32 s51, s53, 38912
    buffer_load_dwordx4 a[100:103], v3, s[28:31], s51 offen
    s_add_u32 s51, s54, 6144
    buffer_load_dwordx4 a[104:107], v3, s[32:35], s51 offen
    s_add_u32 s51, s54, 38912
    buffer_load_dwordx4 a[108:111], v3, s[32:35], s51 offen
    s_waitcnt vmcnt(24)
    v_mfma_f32_32x32x16_bf16 v[64:79], a[24:27], a[16:19], v[64:79]
    v_mfma_f32_32x32x16_bf16 v[80:95], a[28:31], a[16:19], v[80:95]
    v_mfma_f32_32x32x16_bf16 v[96:111], a[24:27], a[20:23], v[96:111]
    v_mfma_f32_32x32x16_bf16 v[112:127], a[28:31], a[20:23], v[112:127]
    s_add_u32 s51, s53, 7168
    buffer_load_dwordx4 a[112:115], v3, s[28:31], s51 offen
    s_add_u32 s51, s53, 39936
    buffer_load_dwordx4 a[116:119], v3, s[28:31], s51 offen
    s_add_u32 s51, s54, 7168
    buffer_load_dwordx4 a[120:123], v3, s[32:35], s51 offen
    s_add_u32 s51, s54, 39936
    buffer_load_dwordx4 a[124:127], v3, s[32:35], s51 offen
    s_waitcnt vmcnt(24)
    v_mfma_f32_32x32x16_bf16 v[64:79], a[40:43], a[32:35], v[64:79]
    v_mfma_f32_32x32x16_bf16 v[80:95], a[44:47], a[32:35], v[80:95]
    v_mfma_f32_32x32x16_bf16 v[96:111], a[40:43], a[36:39], v[96:111]
    v_mfma_f32_32x32x16_bf16 v[112:127], a[44:47], a[36:39], v[112:127]
    s_waitcnt vmcnt(20)
    v_mfma_f32_32x32x16_bf16 v[64:79], a[56:59], a[48:51], v[64:79]
    v_mfma_f32_32x32x16_bf16 v[80:95], a[60:63], a[48:51], v[80:95]
    v_mfma_f32_32x32x16_bf16 v[96:111], a[56:59], a[52:55], v[96:111]
    v_mfma_f32_32x32x16_bf16 v[112:127], a[60:63], a[52:55], v[112:127]
    s_waitcnt vmcnt(16)
    v_mfma_f32_32x32x16_bf16 v[64:79], a[72:75], a[64:67], v[64:79]
    v_mfma_f32_32x32x16_bf16 v[80:95], a[76:79], a[64:67], v[80:95]
    v_mfma_f32_32x32x16_bf16 v[96:111], a[72:75], a[68:71], v[96:111]
    v_mfma_f32_32x32x16_bf16 v[112:127], a[76:79], a[68:71], v[112:127]
    s_waitcnt vmcnt(12)
    v_mfma_f32_32x32x16_bf16 v[64:79], a[88:91], a[80:83], v[64:79]
    v_mfma_f32_32x32x16_bf16 v[80:95], a[92:95], a[80:83], v[80:95]
    v_mfma_f32_32x32x16_bf16 v[96:111], a[88:91], a[84:87], v[96:111]
    v_mfma_f32_32x32x16_bf16 v[112:127], a[92:95], a[84:87], v[112:127]
    s_waitcnt vmcnt(4)
    v_mfma_f32_32x32x16_bf16 v[64:79], a[104:107], a[96:99], v[64:79]
    v_mfma_f32_32x32x16_bf16 v[80:95], a[108:111], a[96:99], v[80:95]
    v_mfma_f32_32x32x16_bf16 v[96:111], a[104:107], a[100:103], v[96:111]
    v_mfma_f32_32x32x16_bf16 v[112:127], a[108:111], a[100:103], v[112:127]
    s_waitcnt vmcnt(0)
    v_mfma_f32_32x32x16_bf16 v[64:79], a[120:123], a[112:115], v[64:79]
    v_mfma_f32_32x32x16_bf16 v[80:95], a[124:127], a[112:115], v[80:95]
    v_mfma_f32_32x32x16_bf16 v[96:111], a[120:123], a[116:119], v[96:111]
    v_mfma_f32_32x32x16_bf16 v[112:127], a[124:127], a[116:119], v[112:127]
    s_lshl_b32 s52, s50, 12
    v_add_u32 v4, s52, v3
    s_lshl_b32 s52, s50, 14
    v_add_u32 v6, s52, v3
    s_nop 15
    ds_write_b128 v4, v[64:67] offset:0
    ds_write_b128 v4, v[68:71] offset:1024
    ds_write_b128 v4, v[72:75] offset:2048
    ds_write_b128 v4, v[76:79] offset:3072
    ds_write_b128 v4, v[80:83] offset:16384
    ds_write_b128 v4, v[84:87] offset:17408
    ds_write_b128 v4, v[88:91] offset:18432
    ds_write_b128 v4, v[92:95] offset:19456
    ds_write_b128 v4, v[96:99] offset:32768
    ds_write_b128 v4, v[100:103] offset:33792
    ds_write_b128 v4, v[104:107] offset:34816
    ds_write_b128 v4, v[108:111] offset:35840
    ds_write_b128 v4, v[112:115] offset:49152
    ds_write_b128 v4, v[116:119] offset:50176
    ds_write_b128 v4, v[120:123] offset:51200
    ds_write_b128 v4, v[124:127] offset:52224
    s_waitcnt lgkmcnt(0)
    s_barrier
    ds_read_b128 v[64:67], v6 offset:0
    ds_read_b128 v[68:71], v6 offset:1024
    ds_read_b128 v[72:75], v6 offset:2048
    ds_read_b128 v[76:79], v6 offset:3072
    ds_read_b128 v[80:83], v6 offset:4096
    ds_read_b128 v[84:87], v6 offset:5120
    ds_read_b128 v[88:91], v6 offset:6144
    ds_read_b128 v[92:95], v6 offset:7168
    ds_read_b128 v[96:99], v6 offset:8192
    ds_read_b128 v[100:103], v6 offset:9216
    ds_read_b128 v[104:107], v6 offset:10240
    ds_read_b128 v[108:111], v6 offset:11264
    ds_read_b128 v[112:115], v6 offset:12288
    ds_read_b128 v[116:119], v6 offset:13312
    ds_read_b128 v[120:123], v6 offset:14336
    ds_read_b128 v[124:127], v6 offset:15360
    v_mov_b32 v18, v16
    v_mov_b32 v7, 0x3f803f80
    v_mov_b32 v8, 0
    v_mov_b32 v9, 0
    s_waitcnt vmcnt(0) lgkmcnt(0)
    v_pk_add_f32 v[64:65], v[64:65], v[80:81]
    v_pk_add_f32 v[96:97], v[96:97], v[112:113]
    v_pk_add_f32 v[66:67], v[66:67], v[82:83]
    v_pk_add_f32 v[98:99], v[98:99], v[114:115]
    v_pk_add_f32 v[68:69], v[68:69], v[84:85]
    v_pk_add_f32 v[100:101], v[100:101], v[116:117]
    v_pk_add_f32 v[70:71], v[70:71], v[86:87]
    v_pk_add_f32 v[102:103], v[102:103], v[118:119]
    v_pk_add_f32 v[72:73], v[72:73], v[88:89]
    v_pk_add_f32 v[104:105], v[104:105], v[120:121]
    v_pk_add_f32 v[74:75], v[74:75], v[90:91]
    v_pk_add_f32 v[106:107], v[106:107], v[122:123]
    v_pk_add_f32 v[76:77], v[76:77], v[92:93]
    v_pk_add_f32 v[108:109], v[108:109], v[124:125]
    v_pk_add_f32 v[78:79], v[78:79], v[94:95]
    v_pk_add_f32 v[110:111], v[110:111], v[126:127]
    v_pk_add_f32 v[64:65], v[64:65], v[96:97]
    v_pk_add_f32 v[66:67], v[66:67], v[98:99]
    v_pk_add_f32 v[68:69], v[68:69], v[100:101]
    v_pk_add_f32 v[70:71], v[70:71], v[102:103]
    v_pk_add_f32 v[72:73], v[72:73], v[104:105]
    v_pk_add_f32 v[74:75], v[74:75], v[106:107]
    v_pk_add_f32 v[76:77], v[76:77], v[108:109]
    v_pk_add_f32 v[78:79], v[78:79], v[110:111]
    v_cvt_pk_bf16_f32 v56, v64, v65
    v_lshlrev_b32 v64, 16, v56
    v_and_b32 v65, 0xffff0000, v56
    v_cvt_pk_bf16_f32 v57, v66, v67
    v_lshlrev_b32 v66, 16, v57
    v_and_b32 v67, 0xffff0000, v57
    v_lshlrev_b32 v58, 16, v40
    v_and_b32 v59, 0xffff0000, v40
    v_pk_add_f32 v[64:65], v[64:65], v[58:59]
    v_lshlrev_b32 v58, 16, v41
    v_and_b32 v59, 0xffff0000, v41
    v_pk_add_f32 v[66:67], v[66:67], v[58:59]
    v_cvt_pk_bf16_f32 v20, v64, v65
    v_cvt_pk_bf16_f32 v21, v66, v67
    buffer_store_dwordx2 v[20:21], v18, s[40:43], s55 offen offset:0
    v_dot2_f32_bf16 v8, v20, v7, v8
    v_dot2_f32_bf16 v9, v20, v20, v9
    v_dot2_f32_bf16 v8, v21, v7, v8
    v_dot2_f32_bf16 v9, v21, v21, v9
    v_cvt_pk_bf16_f32 v56, v68, v69
    v_lshlrev_b32 v68, 16, v56
    v_and_b32 v69, 0xffff0000, v56
    v_cvt_pk_bf16_f32 v57, v70, v71
    v_lshlrev_b32 v70, 16, v57
    v_and_b32 v71, 0xffff0000, v57
    v_lshlrev_b32 v58, 16, v42
    v_and_b32 v59, 0xffff0000, v42
    v_pk_add_f32 v[68:69], v[68:69], v[58:59]
    v_lshlrev_b32 v58, 16, v43
    v_and_b32 v59, 0xffff0000, v43
    v_pk_add_f32 v[70:71], v[70:71], v[58:59]
    v_cvt_pk_bf16_f32 v22, v68, v69
    v_cvt_pk_bf16_f32 v23, v70, v71
    buffer_store_dwordx2 v[22:23], v18, s[40:43], s55 offen offset:512
    v_dot2_f32_bf16 v8, v22, v7, v8
    v_dot2_f32_bf16 v9, v22, v22, v9
    v_dot2_f32_bf16 v8, v23, v7, v8
    v_dot2_f32_bf16 v9, v23, v23, v9
    v_cvt_pk_bf16_f32 v56, v72, v73
    v_lshlrev_b32 v72, 16, v56
    v_and_b32 v73, 0xffff0000, v56
    v_cvt_pk_bf16_f32 v57, v74, v75
    v_lshlrev_b32 v74, 16, v57
    v_and_b32 v75, 0xffff0000, v57
    v_lshlrev_b32 v58, 16, v44
    v_and_b32 v59, 0xffff0000, v44
    v_pk_add_f32 v[72:73], v[72:73], v[58:59]
    v_lshlrev_b32 v58, 16, v45
    v_and_b32 v59, 0xffff0000, v45
    v_pk_add_f32 v[74:75], v[74:75], v[58:59]
    v_cvt_pk_bf16_f32 v24, v72, v73
    v_cvt_pk_bf16_f32 v25, v74, v75
    buffer_store_dwordx2 v[24:25], v18, s[40:43], s55 offen offset:1024
    v_dot2_f32_bf16 v8, v24, v7, v8
    v_dot2_f32_bf16 v9, v24, v24, v9
    v_dot2_f32_bf16 v8, v25, v7, v8
    v_dot2_f32_bf16 v9, v25, v25, v9
    v_cvt_pk_bf16_f32 v56, v76, v77
    v_lshlrev_b32 v76, 16, v56
    v_and_b32 v77, 0xffff0000, v56
    v_cvt_pk_bf16_f32 v57, v78, v79
    v_lshlrev_b32 v78, 16, v57
    v_and_b32 v79, 0xffff0000, v57
    v_lshlrev_b32 v58, 16, v46
    v_and_b32 v59, 0xffff0000, v46
    v_pk_add_f32 v[76:77], v[76:77], v[58:59]
    v_lshlrev_b32 v58, 16, v47
    v_and_b32 v59, 0xffff0000, v47
    v_pk_add_f32 v[78:79], v[78:79], v[58:59]
    v_cvt_pk_bf16_f32 v26, v76, v77
    v_cvt_pk_bf16_f32 v27, v78, v79
    buffer_store_dwordx2 v[26:27], v18, s[40:43], s55 offen offset:1536
    v_dot2_f32_bf16 v8, v26, v7, v8
    v_dot2_f32_bf16 v9, v26, v26, v9
    v_dot2_f32_bf16 v8, v27, v7, v8
    v_dot2_f32_bf16 v9, v27, v27, v9
    v_mov_b32 v10, v16
    s_lshr_b32 s51, s50, 1
    s_lshl_b32 s52, s48, 1
    s_add_u32 s51, s51, s52
    s_lshl_b32 s51, s51, 9
    s_lshl_b32 s52, s49, 16
    s_add_u32 s51, s51, s52
    s_and_b32 s52, s50, 1
    s_lshl_b32 s52, s52, 15
    s_add_u32 s51, s51, s52
    buffer_store_dwordx2 v[8:9], v10, s[56:59], s51 offen
L_wo1_kernel_end:
    s_endpgm
.globl ffn1a_kernel
.p2align 8
.type ffn1a_kernel,@function
ffn1a_kernel:
    s_cmp_ge_u32 s2, 224
    s_cbranch_scc1 L_ffn1a_kernel_end
    s_load_dwordx16 s[4:19], s[0:1], 0
    s_load_dwordx4 s[20:23], s[0:1], 64
    s_load_dwordx2 s[24:25], s[0:1], 80
    s_and_b32 s51, s2, 7
    s_mul_i32 s51, s51, 28
    s_lshr_b32 s54, s2, 3
    s_add_u32 s54, s54, s51
    s_mov_b32 s51, 0x04924925
    s_mul_hi_u32 s48, s54, s51
    s_mul_i32 s51, s48, 56
    s_sub_u32 s54, s54, s51
    s_lshr_b32 s49, s54, 3
    s_and_b32 s54, s54, 7
    s_lshl_b32 s48, s48, 3
    s_add_u32 s48, s48, s54
    v_lshrrev_b32 v2, 6, v0
    v_and_b32 v1, 63, v0
    v_lshrrev_b32 v5, 5, v1
    v_readfirstlane_b32 s50, v2
    v_lshlrev_b32 v3, 4, v1
    s_waitcnt lgkmcnt(0)
    s_add_u32 s28, s24, 0x00800000
    s_addc_u32 s29, s25, 0
    s_and_b32 s29, s29, 0xffff
    s_mov_b32 s30, 0x00200000
    s_mov_b32 s31, 0x00020000
    s_add_u32 s32, s24, 0x01900000
    s_addc_u32 s33, s25, 0
    s_and_b32 s33, s33, 0xffff
    s_mov_b32 s34, 0x001c0000
    s_mov_b32 s35, 0x00020000
    s_add_u32 s44, s24, 0x02100000
    s_addc_u32 s45, s25, 0
    s_and_b32 s45, s45, 0xffff
    s_mov_b32 s46, 0x00080000
    s_mov_b32 s47, 0x00020000
    s_add_u32 s64, s24, 0x02410000
    s_addc_u32 s65, s25, 0
    s_and_b32 s65, s65, 0xffff
    s_mov_b32 s66, 0x00001c00
    s_mov_b32 s67, 0x00020000
    s_lshl_b32 s51, s48, 16
    s_lshl_b32 s54, s50, 13
    s_add_u32 s51, s51, s54
    s_add_u32 m0, s54, 0
    s_add_u32 s59, s51, 0
    buffer_load_dwordx4 v3, s[28:31], s59 offen offset:0 lds
    buffer_load_dwordx4 v3, s[28:31], s59 offen offset:1024 lds
    buffer_load_dwordx4 v3, s[28:31], s59 offen offset:2048 lds
    buffer_load_dwordx4 v3, s[28:31], s59 offen offset:3072 lds
    s_add_u32 m0, s54, 4096
    s_add_u32 s59, s51, 4096
    buffer_load_dwordx4 v3, s[28:31], s59 offen offset:0 lds
    buffer_load_dwordx4 v3, s[28:31], s59 offen offset:1024 lds
    buffer_load_dwordx4 v3, s[28:31], s59 offen offset:2048 lds
    buffer_load_dwordx4 v3, s[28:31], s59 offen offset:3072 lds
    s_lshl_b32 s58, s49, 3
    s_add_u32 s58, s58, s50
    s_lshl_b32 s52, s58, 15
    s_lshl_b32 s57, s58, 5
    s_add_u32 s61, s52, 0
    buffer_load_dwordx4 a[0:3], v3, s[32:35], s61 offen offset:0
    buffer_load_dwordx4 a[4:7], v3, s[32:35], s61 offen offset:1024
    buffer_load_dwordx4 a[8:11], v3, s[32:35], s61 offen offset:2048
    buffer_load_dwordx4 a[12:15], v3, s[32:35], s61 offen offset:3072
    s_add_u32 s61, s52, 4096
    buffer_load_dwordx4 a[16:19], v3, s[32:35], s61 offen offset:0
    buffer_load_dwordx4 a[20:23], v3, s[32:35], s61 offen offset:1024
    buffer_load_dwordx4 a[24:27], v3, s[32:35], s61 offen offset:2048
    buffer_load_dwordx4 a[28:31], v3, s[32:35], s61 offen offset:3072
    v_lshrrev_b32 v24, 3, v1
    v_and_b32 v25, 7, v1
    v_lshlrev_b32 v25, 16, v25
    v_lshl_add_u32 v24, v24, 4, v25
    s_lshl_b32 s60, s48, 10
    s_lshl_b32 s59, s50, 7
    s_add_u32 s60, s60, s59
    buffer_load_dwordx4 v[64:67], v24, s[44:47], s60 offen
    s_add_u32 s60, s60, 32768
    buffer_load_dwordx4 v[68:71], v24, s[44:47], s60 offen
    v_mov_b32 v32, 0
    v_mov_b32 v33, 0
    v_mov_b32 v34, 0
    v_mov_b32 v35, 0
    v_mov_b32 v36, 0
    v_mov_b32 v37, 0
    v_mov_b32 v38, 0
    v_mov_b32 v39, 0
    v_mov_b32 v40, 0
    v_mov_b32 v41, 0
    v_mov_b32 v42, 0
    v_mov_b32 v43, 0
    v_mov_b32 v44, 0
    v_mov_b32 v45, 0
    v_mov_b32 v46, 0
    v_mov_b32 v47, 0
    v_mov_b32 v48, 0
    v_mov_b32 v49, 0
    v_mov_b32 v50, 0
    v_mov_b32 v51, 0
    v_mov_b32 v52, 0
    v_mov_b32 v53, 0
    v_mov_b32 v54, 0
    v_mov_b32 v55, 0
    v_mov_b32 v56, 0
    v_mov_b32 v57, 0
    v_mov_b32 v58, 0
    v_mov_b32 v59, 0
    v_mov_b32 v60, 0
    v_mov_b32 v61, 0
    v_mov_b32 v62, 0
    v_mov_b32 v63, 0
    v_and_b32 v4, 31, v1
    v_lshlrev_b32 v7, 4, v4
    v_lshl_add_u32 v7, v5, 3, v7
    v_lshlrev_b32 v6, 4, v5
    s_lshl_b32 s51, s57, 2
    buffer_load_dwordx4 v[8:11], v6, s[64:67], s51 offen offset:0
    buffer_load_dwordx4 v[12:15], v6, s[64:67], s51 offen offset:32
    buffer_load_dwordx4 v[16:19], v6, s[64:67], s51 offen offset:64
    buffer_load_dwordx4 v[20:23], v6, s[64:67], s51 offen offset:96
    s_mov_b32 s40, s14
    s_and_b32 s41, s15, 0xffff
    s_mov_b32 s42, 0x00000e00
    s_mov_b32 s43, 0x00020000
    s_add_u32 s36, s24, 0x00a00000
    s_addc_u32 s37, s25, 0
    s_and_b32 s37, s37, 0xffff
    s_mov_b32 s38, 0x00700000
    s_mov_b32 s39, 0x00020000
    s_lshl_b32 s55, s57, 1
    v_lshlrev_b32 v6, 3, v5
    buffer_load_dwordx2 v[88:89], v6, s[40:43], s55 offen offset:0
    buffer_load_dwordx2 v[90:91], v6, s[40:43], s55 offen offset:16
    buffer_load_dwordx2 v[92:93], v6, s[40:43], s55 offen offset:32
    buffer_load_dwordx2 v[94:95], v6, s[40:43], s55 offen offset:48
    s_mul_i32 s56, s48, 229376
    s_lshl_b32 s51, s57, 6
    s_add_u32 s56, s56, s51
    s_cmp_ge_u32 s50, 4
    s_cbranch_scc1 L_ffn1a_kernel_prio_1
    s_setprio 2
L_ffn1a_kernel_prio_1:
    s_waitcnt vmcnt(18)
    s_barrier
    ds_read_b128 v[96:99], v3 offset:0
    ds_read_b128 v[100:103], v3 offset:32768
    ds_read_b128 v[104:107], v3 offset:1024
    ds_read_b128 v[108:111], v3 offset:33792
    ds_read_b128 v[112:115], v3 offset:2048
    ds_read_b128 v[116:119], v3 offset:34816
    s_add_u32 s61, s52, 8192
    buffer_load_dwordx4 a[32:35], v3, s[32:35], s61 offen offset:0
    s_waitcnt vmcnt(18) lgkmcnt(4)
    v_mfma_f32_32x32x16_bf16 v[32:47], a[0:3], v[96:99], v[32:47]
    v_mfma_f32_32x32x16_bf16 v[48:63], a[0:3], v[100:103], v[48:63]
    ds_read_b128 v[120:123], v3 offset:3072
    ds_read_b128 v[124:127], v3 offset:35840
    buffer_load_dwordx4 a[36:39], v3, s[32:35], s61 offen offset:1024
    s_waitcnt vmcnt(18) lgkmcnt(4)
    v_mfma_f32_32x32x16_bf16 v[32:47], a[4:7], v[104:107], v[32:47]
    v_mfma_f32_32x32x16_bf16 v[48:63], a[4:7], v[108:111], v[48:63]
    ds_read_b128 v[96:99], v3 offset:4096
    ds_read_b128 v[100:103], v3 offset:36864
    buffer_load_dwordx4 a[40:43], v3, s[32:35], s61 offen offset:2048
    s_waitcnt vmcnt(18) lgkmcnt(4)
    v_mfma_f32_32x32x16_bf16 v[32:47], a[8:11], v[112:115], v[32:47]
    v_mfma_f32_32x32x16_bf16 v[48:63], a[8:11], v[116:119], v[48:63]
    ds_read_b128 v[104:107], v3 offset:5120
    ds_read_b128 v[108:111], v3 offset:37888
    buffer_load_dwordx4 a[44:47], v3, s[32:35], s61 offen offset:3072
    s_waitcnt vmcnt(18) lgkmcnt(4)
    v_mfma_f32_32x32x16_bf16 v[32:47], a[12:15], v[120:123], v[32:47]
    v_mfma_f32_32x32x16_bf16 v[48:63], a[12:15], v[124:127], v[48:63]
    ds_read_b128 v[112:115], v3 offset:6144
    ds_read_b128 v[116:119], v3 offset:38912
    s_add_u32 s61, s52, 12288
    buffer_load_dwordx4 a[48:51], v3, s[32:35], s61 offen offset:0
    s_waitcnt vmcnt(18) lgkmcnt(4)
    v_mfma_f32_32x32x16_bf16 v[32:47], a[16:19], v[96:99], v[32:47]
    v_mfma_f32_32x32x16_bf16 v[48:63], a[16:19], v[100:103], v[48:63]
    ds_read_b128 v[120:123], v3 offset:7168
    ds_read_b128 v[124:127], v3 offset:39936
    buffer_load_dwordx4 a[52:55], v3, s[32:35], s61 offen offset:1024
    s_waitcnt vmcnt(18) lgkmcnt(4)
    v_mfma_f32_32x32x16_bf16 v[32:47], a[20:23], v[104:107], v[32:47]
    v_mfma_f32_32x32x16_bf16 v[48:63], a[20:23], v[108:111], v[48:63]
    ds_read_b128 v[96:99], v3 offset:8192
    ds_read_b128 v[100:103], v3 offset:40960
    buffer_load_dwordx4 a[56:59], v3, s[32:35], s61 offen offset:2048
    s_waitcnt vmcnt(15)
    v_pk_add_f32 v[64:65], v[64:65], v[66:67]
    v_pk_add_f32 v[68:69], v[68:69], v[70:71]
    v_pk_add_f32 v[24:25], v[64:65], v[68:69]
    s_nop 1
    v_add_f32_dpp v24, v24, v24 quad_perm:[1,0,3,2] row_mask:0xf bank_mask:0xf
    v_add_f32_dpp v25, v25, v25 quad_perm:[1,0,3,2] row_mask:0xf bank_mask:0xf
    s_nop 1
    v_add_f32_dpp v24, v24, v24 quad_perm:[2,3,0,1] row_mask:0xf bank_mask:0xf
    v_add_f32_dpp v25, v25, v25 quad_perm:[2,3,0,1] row_mask:0xf bank_mask:0xf
    s_nop 1
    v_add_f32_dpp v24, v24, v24 row_half_mirror row_mask:0xf bank_mask:0xf
    v_add_f32_dpp v25, v25, v25 row_half_mirror row_mask:0xf bank_mask:0xf
    v_mul_f32 v29, 0x3b000000, v24
    v_mul_f32 v28, 0x3b000000, v25
    v_fma_f32 v28, -v29, v29, v28
    v_max_f32 v28, 0, v28
    v_cvt_pk_bf16_f32 v30, v29, v28
    v_lshlrev_b32 v29, 16, v30
    v_and_b32 v28, 0xffff0000, v30
    v_add_f32 v28, 0x3727c5ac, v28
    v_cvt_pk_bf16_f32 v30, v28, v28
    v_and_b32 v28, 0xffff0000, v30
    v_sqrt_f32 v28, v28
    s_nop 0
    v_cvt_pk_bf16_f32 v30, v28, v28
    v_and_b32 v28, 0xffff0000, v30
    v_rcp_f32 v28, v28
    s_nop 0
    v_mul_f32 v29, v29, v28
    v_sub_f32 v29, 0, v29
    v_lshrrev_b32 v30, 3, v1
    v_lshlrev_b32 v30, 3, v30
    s_lshl_b32 s59, s50, 6
    s_add_u32 s59, s59, 65536
    v_add_u32 v30, s59, v30
    ds_write_b64 v30, v[28:29]
    s_waitcnt lgkmcnt(0)
    s_waitcnt vmcnt(18) lgkmcnt(4)
    v_mfma_f32_32x32x16_bf16 v[32:47], a[24:27], v[112:115], v[32:47]
    v_mfma_f32_32x32x16_bf16 v[48:63], a[24:27], v[116:119], v[48:63]
    ds_read_b128 v[104:107], v3 offset:9216
    ds_read_b128 v[108:111], v3 offset:41984
    buffer_load_dwordx4 a[60:63], v3, s[32:35], s61 offen offset:3072
    s_waitcnt vmcnt(18) lgkmcnt(4)
    v_mfma_f32_32x32x16_bf16 v[32:47], a[28:31], v[120:123], v[32:47]
    v_mfma_f32_32x32x16_bf16 v[48:63], a[28:31], v[124:127], v[48:63]
    ds_read_b128 v[112:115], v3 offset:10240
    ds_read_b128 v[116:119], v3 offset:43008
    s_add_u32 s61, s52, 16384
    buffer_load_dwordx4 a[64:67], v3, s[32:35], s61 offen offset:0
    s_barrier
    s_waitcnt vmcnt(8) lgkmcnt(4)
    v_mfma_f32_32x32x16_bf16 v[32:47], a[32:35], v[96:99], v[32:47]
    v_mfma_f32_32x32x16_bf16 v[48:63], a[32:35], v[100:103], v[48:63]
    ds_read_b128 v[120:123], v3 offset:11264
    ds_read_b128 v[124:127], v3 offset:44032
    buffer_load_dwordx4 a[68:71], v3, s[32:35], s61 offen offset:1024
    s_waitcnt vmcnt(8) lgkmcnt(4)
    v_mfma_f32_32x32x16_bf16 v[32:47], a[36:39], v[104:107], v[32:47]
    v_mfma_f32_32x32x16_bf16 v[48:63], a[36:39], v[108:111], v[48:63]
    ds_read_b128 v[96:99], v3 offset:12288
    ds_read_b128 v[100:103], v3 offset:45056
    buffer_load_dwordx4 a[72:75], v3, s[32:35], s61 offen offset:2048
    s_waitcnt vmcnt(8) lgkmcnt(4)
    v_mfma_f32_32x32x16_bf16 v[32:47], a[40:43], v[112:115], v[32:47]
    v_mfma_f32_32x32x16_bf16 v[48:63], a[40:43], v[116:119], v[48:63]
    ds_read_b128 v[104:107], v3 offset:13312
    ds_read_b128 v[108:111], v3 offset:46080
    buffer_load_dwordx4 a[76:79], v3, s[32:35], s61 offen offset:3072
    s_waitcnt vmcnt(8) lgkmcnt(4)
    v_mfma_f32_32x32x16_bf16 v[32:47], a[44:47], v[120:123], v[32:47]
    v_mfma_f32_32x32x16_bf16 v[48:63], a[44:47], v[124:127], v[48:63]
    ds_read_b128 v[112:115], v3 offset:14336
    ds_read_b128 v[116:119], v3 offset:47104
    s_add_u32 s61, s52, 20480
    buffer_load_dwordx4 a[80:83], v3, s[32:35], s61 offen offset:0
    s_waitcnt vmcnt(8) lgkmcnt(4)
    v_mfma_f32_32x32x16_bf16 v[32:47], a[48:51], v[96:99], v[32:47]
    v_mfma_f32_32x32x16_bf16 v[48:63], a[48:51], v[100:103], v[48:63]
    ds_read_b128 v[120:123], v3 offset:15360
    ds_read_b128 v[124:127], v3 offset:48128
    buffer_load_dwordx4 a[84:87], v3, s[32:35], s61 offen offset:1024
    s_waitcnt vmcnt(8) lgkmcnt(4)
    v_mfma_f32_32x32x16_bf16 v[32:47], a[52:55], v[104:107], v[32:47]
    v_mfma_f32_32x32x16_bf16 v[48:63], a[52:55], v[108:111], v[48:63]
    ds_read_b128 v[96:99], v3 offset:16384
    ds_read_b128 v[100:103], v3 offset:49152
    buffer_load_dwordx4 a[88:91], v3, s[32:35], s61 offen offset:2048
    s_waitcnt vmcnt(8) lgkmcnt(4)
    v_mfma_f32_32x32x16_bf16 v[32:47], a[56:59], v[112:115], v[32:47]
    v_mfma_f32_32x32x16_bf16 v[48:63], a[56:59], v[116:119], v[48:63]
    ds_read_b128 v[104:107], v3 offset:17408
    ds_read_b128 v[108:111], v3 offset:50176
    buffer_load_dwordx4 a[92:95], v3, s[32:35], s61 offen offset:3072
    s_waitcnt vmcnt(8) lgkmcnt(4)
    v_mfma_f32_32x32x16_bf16 v[32:47], a[60:63], v[120:123], v[32:47]
    v_mfma_f32_32x32x16_bf16 v[48:63], a[60:63], v[124:127], v[48:63]
    ds_read_b128 v[112:115], v3 offset:18432
    ds_read_b128 v[116:119], v3 offset:51200
    s_add_u32 s61, s52, 24576
    buffer_load_dwordx4 a[96:99], v3, s[32:35], s61 offen offset:0
    s_waitcnt vmcnt(8) lgkmcnt(4)
    v_mfma_f32_32x32x16_bf16 v[32:47], a[64:67], v[96:99], v[32:47]
    v_mfma_f32_32x32x16_bf16 v[48:63], a[64:67], v[100:103], v[48:63]
    ds_read_b128 v[120:123], v3 offset:19456
    ds_read_b128 v[124:127], v3 offset:52224
    buffer_load_dwordx4 a[100:103], v3, s[32:35], s61 offen offset:1024
    s_waitcnt vmcnt(8) lgkmcnt(4)
    v_mfma_f32_32x32x16_bf16 v[32:47], a[68:71], v[104:107], v[32:47]
    v_mfma_f32_32x32x16_bf16 v[48:63], a[68:71], v[108:111], v[48:63]
    ds_read_b128 v[96:99], v3 offset:20480
    ds_read_b128 v[100:103], v3 offset:53248
    buffer_load_dwordx4 a[104:107], v3, s[32:35], s61 offen offset:2048
    s_waitcnt vmcnt(8) lgkmcnt(4)
    v_mfma_f32_32x32x16_bf16 v[32:47], a[72:75], v[112:115], v[32:47]
    v_mfma_f32_32x32x16_bf16 v[48:63], a[72:75], v[116:119], v[48:63]
    ds_read_b128 v[104:107], v3 offset:21504
    ds_read_b128 v[108:111], v3 offset:54272
    buffer_load_dwordx4 a[108:111], v3, s[32:35], s61 offen offset:3072
    s_waitcnt vmcnt(8) lgkmcnt(4)
    v_mfma_f32_32x32x16_bf16 v[32:47], a[76:79], v[120:123], v[32:47]
    v_mfma_f32_32x32x16_bf16 v[48:63], a[76:79], v[124:127], v[48:63]
    ds_read_b128 v[112:115], v3 offset:22528
    ds_read_b128 v[116:119], v3 offset:55296
    s_add_u32 s61, s52, 28672
    buffer_load_dwordx4 a[112:115], v3, s[32:35], s61 offen offset:0
    s_waitcnt vmcnt(8) lgkmcnt(4)
    v_mfma_f32_32x32x16_bf16 v[32:47], a[80:83], v[96:99], v[32:47]
    v_mfma_f32_32x32x16_bf16 v[48:63], a[80:83], v[100:103], v[48:63]
    ds_read_b128 v[120:123], v3 offset:23552
    ds_read_b128 v[124:127], v3 offset:56320
    buffer_load_dwordx4 a[116:119], v3, s[32:35], s61 offen offset:1024
    s_waitcnt vmcnt(8) lgkmcnt(4)
    v_mfma_f32_32x32x16_bf16 v[32:47], a[84:87], v[104:107], v[32:47]
    v_mfma_f32_32x32x16_bf16 v[48:63], a[84:87], v[108:111], v[48:63]
    ds_read_b128 v[96:99], v3 offset:24576
    ds_read_b128 v[100:103], v3 offset:57344
    buffer_load_dwordx4 a[120:123], v3, s[32:35], s61 offen offset:2048
    s_waitcnt vmcnt(8) lgkmcnt(4)
    v_mfma_f32_32x32x16_bf16 v[32:47], a[88:91], v[112:115], v[32:47]
    v_mfma_f32_32x32x16_bf16 v[48:63], a[88:91], v[116:119], v[48:63]
    ds_read_b128 v[104:107], v3 offset:25600
    ds_read_b128 v[108:111], v3 offset:58368
    buffer_load_dwordx4 a[124:127], v3, s[32:35], s61 offen offset:3072
    s_waitcnt vmcnt(8) lgkmcnt(4)
    v_mfma_f32_32x32x16_bf16 v[32:47], a[92:95], v[120:123], v[32:47]
    v_mfma_f32_32x32x16_bf16 v[48:63], a[92:95], v[124:127], v[48:63]
    ds_read_b128 v[112:115], v3 offset:26624
    ds_read_b128 v[116:119], v3 offset:59392
    s_waitcnt vmcnt(7) lgkmcnt(4)
    v_mfma_f32_32x32x16_bf16 v[32:47], a[96:99], v[96:99], v[32:47]
    v_mfma_f32_32x32x16_bf16 v[48:63], a[96:99], v[100:103], v[48:63]
    ds_read_b128 v[120:123], v3 offset:27648
    ds_read_b128 v[124:127], v3 offset:60416
    s_waitcnt vmcnt(6) lgkmcnt(4)
    v_mfma_f32_32x32x16_bf16 v[32:47], a[100:103], v[104:107], v[32:47]
    v_mfma_f32_32x32x16_bf16 v[48:63], a[100:103], v[108:111], v[48:63]
    ds_read_b128 v[96:99], v3 offset:28672
    ds_read_b128 v[100:103], v3 offset:61440
    s_waitcnt vmcnt(5) lgkmcnt(4)
    v_mfma_f32_32x32x16_bf16 v[32:47], a[104:107], v[112:115], v[32:47]
    v_mfma_f32_32x32x16_bf16 v[48:63], a[104:107], v[116:119], v[48:63]
    ds_read_b128 v[104:107], v3 offset:29696
    ds_read_b128 v[108:111], v3 offset:62464
    s_waitcnt vmcnt(4) lgkmcnt(4)
    v_mfma_f32_32x32x16_bf16 v[32:47], a[108:111], v[120:123], v[32:47]
    v_mfma_f32_32x32x16_bf16 v[48:63], a[108:111], v[124:127], v[48:63]
    ds_read_b128 v[112:115], v3 offset:30720
    ds_read_b128 v[116:119], v3 offset:63488
    s_waitcnt vmcnt(3) lgkmcnt(4)
    v_mfma_f32_32x32x16_bf16 v[32:47], a[112:115], v[96:99], v[32:47]
    v_mfma_f32_32x32x16_bf16 v[48:63], a[112:115], v[100:103], v[48:63]
    ds_read_b128 v[120:123], v3 offset:31744
    ds_read_b128 v[124:127], v3 offset:64512
    s_waitcnt vmcnt(2) lgkmcnt(4)
    v_mfma_f32_32x32x16_bf16 v[32:47], a[116:119], v[104:107], v[32:47]
    v_mfma_f32_32x32x16_bf16 v[48:63], a[116:119], v[108:111], v[48:63]
    s_waitcnt vmcnt(1) lgkmcnt(2)
    v_mfma_f32_32x32x16_bf16 v[32:47], a[120:123], v[112:115], v[32:47]
    v_mfma_f32_32x32x16_bf16 v[48:63], a[120:123], v[116:119], v[48:63]
    s_waitcnt vmcnt(0) lgkmcnt(0)
    v_mfma_f32_32x32x16_bf16 v[32:47], a[124:127], v[120:123], v[32:47]
    v_mfma_f32_32x32x16_bf16 v[48:63], a[124:127], v[124:127], v[48:63]
    v_lshlrev_b32 v30, 3, v4
    v_add_u32 v30, 65536, v30
    ds_read_b64 v[28:29], v30
    ds_read_b64 v[30:31], v30 offset:256
    s_waitcnt lgkmcnt(0)
    v_mov_b32 v64, v28
    v_mov_b32 v65, v28
    v_mov_b32 v66, v29
    v_mov_b32 v67, v29
    v_mov_b32 v68, v30
    v_mov_b32 v69, v30
    v_mov_b32 v70, v31
    v_mov_b32 v71, v31
    s_waitcnt vmcnt(24)
    v_mov_b32 v120, 0xbdd2d3e8
    v_mov_b32 v121, 0xbdd2d3e8
    v_mov_b32 v122, 0xc0135761
    v_mov_b32 v123, 0xc0135761
    v_mov_b32 v124, 1.0
    v_mov_b32 v125, 1.0
    v_lshlrev_b32 v96, 16, v88
    v_and_b32 v97, 0xffff0000, v88
    v_lshlrev_b32 v98, 16, v89
    v_and_b32 v99, 0xffff0000, v89
    v_lshlrev_b32 v100, 16, v90
    v_and_b32 v101, 0xffff0000, v90
    v_lshlrev_b32 v102, 16, v91
    v_and_b32 v103, 0xffff0000, v91
    v_lshlrev_b32 v104, 16, v92
    v_and_b32 v105, 0xffff0000, v92
    v_lshlrev_b32 v106, 16, v93
    v_and_b32 v107, 0xffff0000, v93
    v_lshlrev_b32 v108, 16, v94
    v_and_b32 v109, 0xffff0000, v94
    v_lshlrev_b32 v110, 16, v95
    v_and_b32 v111, 0xffff0000, v95
    v_pk_mul_f32 v[32:33], v[32:33], v[64:65]
    v_pk_mul_f32 v[34:35], v[34:35], v[64:65]
    v_pk_fma_f32 v[32:33], v[8:9], v[66:67], v[32:33]
    v_pk_fma_f32 v[34:35], v[10:11], v[66:67], v[34:35]
    v_pk_add_f32 v[32:33], v[32:33], v[96:97]
    v_pk_add_f32 v[34:35], v[34:35], v[98:99]
    v_cvt_pk_bf16_f32 v72, v32, v33
    v_lshlrev_b32 v32, 16, v72
    v_and_b32 v33, 0xffff0000, v72
    v_cvt_pk_bf16_f32 v73, v34, v35
    v_lshlrev_b32 v34, 16, v73
    v_and_b32 v35, 0xffff0000, v73
    v_pk_mul_f32 v[76:77], v[32:33], v[32:33]
    v_pk_mul_f32 v[78:79], v[34:35], v[34:35]
    v_pk_fma_f32 v[76:77], v[76:77], v[120:121], v[122:123]
    v_pk_fma_f32 v[78:79], v[78:79], v[120:121], v[122:123]
    v_pk_mul_f32 v[76:77], v[76:77], v[32:33]
    v_pk_mul_f32 v[78:79], v[78:79], v[34:35]
    v_exp_f32 v76, v76
    v_exp_f32 v77, v77
    v_exp_f32 v78, v78
    v_exp_f32 v79, v79
    s_nop 0
    v_pk_add_f32 v[76:77], v[76:77], v[124:125]
    v_pk_add_f32 v[78:79], v[78:79], v[124:125]
    v_rcp_f32 v76, v76
    v_rcp_f32 v77, v77
    v_rcp_f32 v78, v78
    v_rcp_f32 v79, v79
    s_nop 0
    v_pk_mul_f32 v[32:33], v[32:33], v[76:77]
    v_pk_mul_f32 v[34:35], v[34:35], v[78:79]
    v_cvt_pk_bf16_f32 v80, v32, v33
    v_cvt_pk_bf16_f32 v81, v34, v35
    s_add_u32 s51, s56, 0
    buffer_store_dwordx2 v[80:81], v7, s[36:39], s51 offen
    v_pk_mul_f32 v[36:37], v[36:37], v[64:65]
    v_pk_mul_f32 v[38:39], v[38:39], v[64:65]
    v_pk_fma_f32 v[36:37], v[12:13], v[66:67], v[36:37]
    v_pk_fma_f32 v[38:39], v[14:15], v[66:67], v[38:39]
    v_pk_add_f32 v[36:37], v[36:37], v[100:101]
    v_pk_add_f32 v[38:39], v[38:39], v[102:103]
    v_cvt_pk_bf16_f32 v72, v36, v37
    v_lshlrev_b32 v36, 16, v72
    v_and_b32 v37, 0xffff0000, v72
    v_cvt_pk_bf16_f32 v73, v38, v39
    v_lshlrev_b32 v38, 16, v73
    v_and_b32 v39, 0xffff0000, v73
    v_pk_mul_f32 v[76:77], v[36:37], v[36:37]
    v_pk_mul_f32 v[78:79], v[38:39], v[38:39]
    v_pk_fma_f32 v[76:77], v[76:77], v[120:121], v[122:123]
    v_pk_fma_f32 v[78:79], v[78:79], v[120:121], v[122:123]
    v_pk_mul_f32 v[76:77], v[76:77], v[36:37]
    v_pk_mul_f32 v[78:79], v[78:79], v[38:39]
    v_exp_f32 v76, v76
    v_exp_f32 v77, v77
    v_exp_f32 v78, v78
    v_exp_f32 v79, v79
    s_nop 0
    v_pk_add_f32 v[76:77], v[76:77], v[124:125]
    v_pk_add_f32 v[78:79], v[78:79], v[124:125]
    v_rcp_f32 v76, v76
    v_rcp_f32 v77, v77
    v_rcp_f32 v78, v78
    v_rcp_f32 v79, v79
    s_nop 0
    v_pk_mul_f32 v[36:37], v[36:37], v[76:77]
    v_pk_mul_f32 v[38:39], v[38:39], v[78:79]
    v_cvt_pk_bf16_f32 v82, v36, v37
    v_cvt_pk_bf16_f32 v83, v38, v39
    s_add_u32 s51, s56, 512
    buffer_store_dwordx2 v[82:83], v7, s[36:39], s51 offen
    v_pk_mul_f32 v[40:41], v[40:41], v[64:65]
    v_pk_mul_f32 v[42:43], v[42:43], v[64:65]
    v_pk_fma_f32 v[40:41], v[16:17], v[66:67], v[40:41]
    v_pk_fma_f32 v[42:43], v[18:19], v[66:67], v[42:43]
    v_pk_add_f32 v[40:41], v[40:41], v[104:105]
    v_pk_add_f32 v[42:43], v[42:43], v[106:107]
    v_cvt_pk_bf16_f32 v72, v40, v41
    v_lshlrev_b32 v40, 16, v72
    v_and_b32 v41, 0xffff0000, v72
    v_cvt_pk_bf16_f32 v73, v42, v43
    v_lshlrev_b32 v42, 16, v73
    v_and_b32 v43, 0xffff0000, v73
    v_pk_mul_f32 v[76:77], v[40:41], v[40:41]
    v_pk_mul_f32 v[78:79], v[42:43], v[42:43]
    v_pk_fma_f32 v[76:77], v[76:77], v[120:121], v[122:123]
    v_pk_fma_f32 v[78:79], v[78:79], v[120:121], v[122:123]
    v_pk_mul_f32 v[76:77], v[76:77], v[40:41]
    v_pk_mul_f32 v[78:79], v[78:79], v[42:43]
    v_exp_f32 v76, v76
    v_exp_f32 v77, v77
    v_exp_f32 v78, v78
    v_exp_f32 v79, v79
    s_nop 0
    v_pk_add_f32 v[76:77], v[76:77], v[124:125]
    v_pk_add_f32 v[78:79], v[78:79], v[124:125]
    v_rcp_f32 v76, v76
    v_rcp_f32 v77, v77
    v_rcp_f32 v78, v78
    v_rcp_f32 v79, v79
    s_nop 0
    v_pk_mul_f32 v[40:41], v[40:41], v[76:77]
    v_pk_mul_f32 v[42:43], v[42:43], v[78:79]
    v_cvt_pk_bf16_f32 v80, v40, v41
    v_cvt_pk_bf16_f32 v81, v42, v43
    s_add_u32 s51, s56, 1024
    buffer_store_dwordx2 v[80:81], v7, s[36:39], s51 offen
    v_pk_mul_f32 v[44:45], v[44:45], v[64:65]
    v_pk_mul_f32 v[46:47], v[46:47], v[64:65]
    v_pk_fma_f32 v[44:45], v[20:21], v[66:67], v[44:45]
    v_pk_fma_f32 v[46:47], v[22:23], v[66:67], v[46:47]
    v_pk_add_f32 v[44:45], v[44:45], v[108:109]
    v_pk_add_f32 v[46:47], v[46:47], v[110:111]
    v_cvt_pk_bf16_f32 v72, v44, v45
    v_lshlrev_b32 v44, 16, v72
    v_and_b32 v45, 0xffff0000, v72
    v_cvt_pk_bf16_f32 v73, v46, v47
    v_lshlrev_b32 v46, 16, v73
    v_and_b32 v47, 0xffff0000, v73
    v_pk_mul_f32 v[76:77], v[44:45], v[44:45]
    v_pk_mul_f32 v[78:79], v[46:47], v[46:47]
    v_pk_fma_f32 v[76:77], v[76:77], v[120:121], v[122:123]
    v_pk_fma_f32 v[78:79], v[78:79], v[120:121], v[122:123]
    v_pk_mul_f32 v[76:77], v[76:77], v[44:45]
    v_pk_mul_f32 v[78:79], v[78:79], v[46:47]
    v_exp_f32 v76, v76
    v_exp_f32 v77, v77
    v_exp_f32 v78, v78
    v_exp_f32 v79, v79
    s_nop 0
    v_pk_add_f32 v[76:77], v[76:77], v[124:125]
    v_pk_add_f32 v[78:79], v[78:79], v[124:125]
    v_rcp_f32 v76, v76
    v_rcp_f32 v77, v77
    v_rcp_f32 v78, v78
    v_rcp_f32 v79, v79
    s_nop 0
    v_pk_mul_f32 v[44:45], v[44:45], v[76:77]
    v_pk_mul_f32 v[46:47], v[46:47], v[78:79]
    v_cvt_pk_bf16_f32 v82, v44, v45
    v_cvt_pk_bf16_f32 v83, v46, v47
    s_add_u32 s51, s56, 1536
    buffer_store_dwordx2 v[82:83], v7, s[36:39], s51 offen
    v_pk_mul_f32 v[48:49], v[48:49], v[68:69]
    v_pk_mul_f32 v[50:51], v[50:51], v[68:69]
    v_pk_fma_f32 v[48:49], v[8:9], v[70:71], v[48:49]
    v_pk_fma_f32 v[50:51], v[10:11], v[70:71], v[50:51]
    v_pk_add_f32 v[48:49], v[48:49], v[96:97]
    v_pk_add_f32 v[50:51], v[50:51], v[98:99]
    v_cvt_pk_bf16_f32 v72, v48, v49
    v_lshlrev_b32 v48, 16, v72
    v_and_b32 v49, 0xffff0000, v72
    v_cvt_pk_bf16_f32 v73, v50, v51
    v_lshlrev_b32 v50, 16, v73
    v_and_b32 v51, 0xffff0000, v73
    v_pk_mul_f32 v[76:77], v[48:49], v[48:49]
    v_pk_mul_f32 v[78:79], v[50:51], v[50:51]
    v_pk_fma_f32 v[76:77], v[76:77], v[120:121], v[122:123]
    v_pk_fma_f32 v[78:79], v[78:79], v[120:121], v[122:123]
    v_pk_mul_f32 v[76:77], v[76:77], v[48:49]
    v_pk_mul_f32 v[78:79], v[78:79], v[50:51]
    v_exp_f32 v76, v76
    v_exp_f32 v77, v77
    v_exp_f32 v78, v78
    v_exp_f32 v79, v79
    s_nop 0
    v_pk_add_f32 v[76:77], v[76:77], v[124:125]
    v_pk_add_f32 v[78:79], v[78:79], v[124:125]
    v_rcp_f32 v76, v76
    v_rcp_f32 v77, v77
    v_rcp_f32 v78, v78
    v_rcp_f32 v79, v79
    s_nop 0
    v_pk_mul_f32 v[48:49], v[48:49], v[76:77]
    v_pk_mul_f32 v[50:51], v[50:51], v[78:79]
    v_cvt_pk_bf16_f32 v80, v48, v49
    v_cvt_pk_bf16_f32 v81, v50, v51
    s_add_u32 s51, s56, 114688
    buffer_store_dwordx2 v[80:81], v7, s[36:39], s51 offen
    v_pk_mul_f32 v[52:53], v[52:53], v[68:69]
    v_pk_mul_f32 v[54:55], v[54:55], v[68:69]
    v_pk_fma_f32 v[52:53], v[12:13], v[70:71], v[52:53]
    v_pk_fma_f32 v[54:55], v[14:15], v[70:71], v[54:55]
    v_pk_add_f32 v[52:53], v[52:53], v[100:101]
    v_pk_add_f32 v[54:55], v[54:55], v[102:103]
    v_cvt_pk_bf16_f32 v72, v52, v53
    v_lshlrev_b32 v52, 16, v72
    v_and_b32 v53, 0xffff0000, v72
    v_cvt_pk_bf16_f32 v73, v54, v55
    v_lshlrev_b32 v54, 16, v73
    v_and_b32 v55, 0xffff0000, v73
    v_pk_mul_f32 v[76:77], v[52:53], v[52:53]
    v_pk_mul_f32 v[78:79], v[54:55], v[54:55]
    v_pk_fma_f32 v[76:77], v[76:77], v[120:121], v[122:123]
    v_pk_fma_f32 v[78:79], v[78:79], v[120:121], v[122:123]
    v_pk_mul_f32 v[76:77], v[76:77], v[52:53]
    v_pk_mul_f32 v[78:79], v[78:79], v[54:55]
    v_exp_f32 v76, v76
    v_exp_f32 v77, v77
    v_exp_f32 v78, v78
    v_exp_f32 v79, v79
    s_nop 0
    v_pk_add_f32 v[76:77], v[76:77], v[124:125]
    v_pk_add_f32 v[78:79], v[78:79], v[124:125]
    v_rcp_f32 v76, v76
    v_rcp_f32 v77, v77
    v_rcp_f32 v78, v78
    v_rcp_f32 v79, v79
    s_nop 0
    v_pk_mul_f32 v[52:53], v[52:53], v[76:77]
    v_pk_mul_f32 v[54:55], v[54:55], v[78:79]
    v_cvt_pk_bf16_f32 v82, v52, v53
    v_cvt_pk_bf16_f32 v83, v54, v55
    s_add_u32 s51, s56, 115200
    buffer_store_dwordx2 v[82:83], v7, s[36:39], s51 offen
    v_pk_mul_f32 v[56:57], v[56:57], v[68:69]
    v_pk_mul_f32 v[58:59], v[58:59], v[68:69]
    v_pk_fma_f32 v[56:57], v[16:17], v[70:71], v[56:57]
    v_pk_fma_f32 v[58:59], v[18:19], v[70:71], v[58:59]
    v_pk_add_f32 v[56:57], v[56:57], v[104:105]
    v_pk_add_f32 v[58:59], v[58:59], v[106:107]
    v_cvt_pk_bf16_f32 v72, v56, v57
    v_lshlrev_b32 v56, 16, v72
    v_and_b32 v57, 0xffff0000, v72
    v_cvt_pk_bf16_f32 v73, v58, v59
    v_lshlrev_b32 v58, 16, v73
    v_and_b32 v59, 0xffff0000, v73
    v_pk_mul_f32 v[76:77], v[56:57], v[56:57]
    v_pk_mul_f32 v[78:79], v[58:59], v[58:59]
    v_pk_fma_f32 v[76:77], v[76:77], v[120:121], v[122:123]
    v_pk_fma_f32 v[78:79], v[78:79], v[120:121], v[122:123]
    v_pk_mul_f32 v[76:77], v[76:77], v[56:57]
    v_pk_mul_f32 v[78:79], v[78:79], v[58:59]
    v_exp_f32 v76, v76
    v_exp_f32 v77, v77
    v_exp_f32 v78, v78
    v_exp_f32 v79, v79
    s_nop 0
    v_pk_add_f32 v[76:77], v[76:77], v[124:125]
    v_pk_add_f32 v[78:79], v[78:79], v[124:125]
    v_rcp_f32 v76, v76
    v_rcp_f32 v77, v77
    v_rcp_f32 v78, v78
    v_rcp_f32 v79, v79
    s_nop 0
    v_pk_mul_f32 v[56:57], v[56:57], v[76:77]
    v_pk_mul_f32 v[58:59], v[58:59], v[78:79]
    v_cvt_pk_bf16_f32 v80, v56, v57
    v_cvt_pk_bf16_f32 v81, v58, v59
    s_add_u32 s51, s56, 115712
    buffer_store_dwordx2 v[80:81], v7, s[36:39], s51 offen
    v_pk_mul_f32 v[60:61], v[60:61], v[68:69]
    v_pk_mul_f32 v[62:63], v[62:63], v[68:69]
    v_pk_fma_f32 v[60:61], v[20:21], v[70:71], v[60:61]
    v_pk_fma_f32 v[62:63], v[22:23], v[70:71], v[62:63]
    v_pk_add_f32 v[60:61], v[60:61], v[108:109]
    v_pk_add_f32 v[62:63], v[62:63], v[110:111]
    v_cvt_pk_bf16_f32 v72, v60, v61
    v_lshlrev_b32 v60, 16, v72
    v_and_b32 v61, 0xffff0000, v72
    v_cvt_pk_bf16_f32 v73, v62, v63
    v_lshlrev_b32 v62, 16, v73
    v_and_b32 v63, 0xffff0000, v73
    v_pk_mul_f32 v[76:77], v[60:61], v[60:61]
    v_pk_mul_f32 v[78:79], v[62:63], v[62:63]
    v_pk_fma_f32 v[76:77], v[76:77], v[120:121], v[122:123]
    v_pk_fma_f32 v[78:79], v[78:79], v[120:121], v[122:123]
    v_pk_mul_f32 v[76:77], v[76:77], v[60:61]
    v_pk_mul_f32 v[78:79], v[78:79], v[62:63]
    v_exp_f32 v76, v76
    v_exp_f32 v77, v77
    v_exp_f32 v78, v78
    v_exp_f32 v79, v79
    s_nop 0
    v_pk_add_f32 v[76:77], v[76:77], v[124:125]
    v_pk_add_f32 v[78:79], v[78:79], v[124:125]
    v_rcp_f32 v76, v76
    v_rcp_f32 v77, v77
    v_rcp_f32 v78, v78
    v_rcp_f32 v79, v79
    s_nop 0
    v_pk_mul_f32 v[60:61], v[60:61], v[76:77]
    v_pk_mul_f32 v[62:63], v[62:63], v[78:79]
    v_cvt_pk_bf16_f32 v82, v60, v61
    v_cvt_pk_bf16_f32 v83, v62, v63
    s_add_u32 s51, s56, 116224
    buffer_store_dwordx2 v[82:83], v7, s[36:39], s51 offen
L_ffn1a_kernel_end:
    s_endpgm
.globl ffn2a_kernel
.p2align 8
.type ffn2a_kernel,@function
ffn2a_kernel:
    s_cmp_ge_u32 s2, 256
    s_cbranch_scc1 L_ffn2a_kernel_end
    s_load_dwordx16 s[4:19], s[0:1], 0
    s_load_dwordx4 s[20:23], s[0:1], 64
    s_load_dwordx2 s[24:25], s[0:1], 80
    s_and_b32 s51, s2, 7
    s_lshl_b32 s48, s51, 2
    s_lshr_b32 s51, s2, 6
    s_add_u32 s48, s48, s51
    s_lshr_b32 s49, s2, 3
    s_and_b32 s49, s49, 7
    v_lshrrev_b32 v2, 6, v0
    v_and_b32 v1, 63, v0
    v_lshlrev_b32 v3, 4, v1
    v_readfirstlane_b32 s50, v2
    s_waitcnt lgkmcnt(0)
    s_add_u32 s28, s24, 0x00a00000
    s_addc_u32 s29, s25, 0
    s_and_b32 s29, s29, 0xffff
    s_mov_b32 s30, 0x00700000
    s_mov_b32 s31, 0x00020000
    s_add_u32 s32, s24, 0x01b00000
    s_addc_u32 s33, s25, 0
    s_and_b32 s33, s33, 0xffff
    s_mov_b32 s34, 0x001c0000
    s_mov_b32 s35, 0x00020000
    s_add_u32 s36, s24, 0x00800000
    s_addc_u32 s37, s25, 0
    s_and_b32 s37, s37, 0xffff
    s_mov_b32 s38, 0x00200000
    s_mov_b32 s39, 0x00020000
    s_add_u32 s40, s24, 0x01200000
    s_addc_u32 s41, s25, 0
    s_and_b32 s41, s41, 0xffff
    s_mov_b32 s42, 0x00200000
    s_mov_b32 s43, 0x00020000
    s_mov_b32 s44, s18
    s_and_b32 s45, s19, 0xffff
    s_mov_b32 s46, 0x00000400
    s_mov_b32 s47, 0x00020000
    s_add_u32 s56, s24, 0x02200000
    s_addc_u32 s57, s25, 0
    s_and_b32 s57, s57, 0xffff
    s_mov_b32 s58, 0x00080000
    s_mov_b32 s59, 0x00020000
    s_mul_i32 s51, s50, 28672
    s_mul_i32 s53, s48, 229376
    s_add_u32 s53, s53, s51
    s_mul_i32 s54, s49, 229376
    s_add_u32 s54, s54, s51
    v_lshrrev_b32 v15, 5, v1
    v_and_b32 v14, 31, v1
    v_lshlrev_b32 v16, 4, v14
    v_lshl_add_u32 v16, v15, 3, v16
    s_lshr_b32 s51, s50, 1
    s_lshl_b32 s52, s48, 1
    s_add_u32 s51, s51, s52
    s_lshl_b32 s55, s51, 15
    s_lshl_b32 s52, s49, 12
    s_add_u32 s55, s55, s52
    s_and_b32 s52, s50, 1
    s_lshl_b32 s52, s52, 11
    s_add_u32 s55, s55, s52
    s_add_u32 s51, s53, 0
    buffer_load_dwordx4 a[0:3], v3, s[28:31], s51 offen
    s_add_u32 s51, s53, 114688
    buffer_load_dwordx4 a[4:7], v3, s[28:31], s51 offen
    s_add_u32 s51, s54, 0
    buffer_load_dwordx4 a[8:11], v3, s[32:35], s51 offen
    s_add_u32 s51, s54, 114688
    buffer_load_dwordx4 a[12:15], v3, s[32:35], s51 offen
    s_add_u32 s51, s53, 1024
    buffer_load_dwordx4 a[16:19], v3, s[28:31], s51 offen
    s_add_u32 s51, s53, 115712
    buffer_load_dwordx4 a[20:23], v3, s[28:31], s51 offen
    s_add_u32 s51, s54, 1024
    buffer_load_dwordx4 a[24:27], v3, s[32:35], s51 offen
    s_add_u32 s51, s54, 115712
    buffer_load_dwordx4 a[28:31], v3, s[32:35], s51 offen
    s_add_u32 s51, s53, 2048
    buffer_load_dwordx4 a[32:35], v3, s[28:31], s51 offen
    s_add_u32 s51, s53, 116736
    buffer_load_dwordx4 a[36:39], v3, s[28:31], s51 offen
    s_add_u32 s51, s54, 2048
    buffer_load_dwordx4 a[40:43], v3, s[32:35], s51 offen
    s_add_u32 s51, s54, 116736
    buffer_load_dwordx4 a[44:47], v3, s[32:35], s51 offen
    s_add_u32 s51, s53, 3072
    buffer_load_dwordx4 a[48:51], v3, s[28:31], s51 offen
    s_add_u32 s51, s53, 117760
    buffer_load_dwordx4 a[52:55], v3, s[28:31], s51 offen
    s_add_u32 s51, s54, 3072
    buffer_load_dwordx4 a[56:59], v3, s[32:35], s51 offen
    s_add_u32 s51, s54, 117760
    buffer_load_dwordx4 a[60:63], v3, s[32:35], s51 offen
    s_add_u32 s51, s53, 4096
    buffer_load_dwordx4 a[64:67], v3, s[28:31], s51 offen
    s_add_u32 s51, s53, 118784
    buffer_load_dwordx4 a[68:71], v3, s[28:31], s51 offen
    s_add_u32 s51, s54, 4096
    buffer_load_dwordx4 a[72:75], v3, s[32:35], s51 offen
    s_add_u32 s51, s54, 118784
    buffer_load_dwordx4 a[76:79], v3, s[32:35], s51 offen
    s_add_u32 s51, s53, 5120
    buffer_load_dwordx4 a[80:83], v3, s[28:31], s51 offen
    s_add_u32 s51, s53, 119808
    buffer_load_dwordx4 a[84:87], v3, s[28:31], s51 offen
    s_add_u32 s51, s54, 5120
    buffer_load_dwordx4 a[88:91], v3, s[32:35], s51 offen
    s_add_u32 s51, s54, 119808
    buffer_load_dwordx4 a[92:95], v3, s[32:35], s51 offen
    buffer_load_dwordx2 v[40:41], v16, s[36:39], s55 offen offset:0
    buffer_load_dwordx2 v[42:43], v16, s[36:39], s55 offen offset:512
    buffer_load_dwordx2 v[44:45], v16, s[36:39], s55 offen offset:1024
    buffer_load_dwordx2 v[46:47], v16, s[36:39], s55 offen offset:1536
    s_lshl_b32 s51, s49, 7
    s_and_b32 s52, s50, 1
    s_lshl_b32 s52, s52, 6
    s_add_u32 s51, s51, s52
    v_lshlrev_b32 v17, 3, v15
    buffer_load_dwordx2 v[48:49], v17, s[44:47], s51 offen offset:0
    buffer_load_dwordx2 v[50:51], v17, s[44:47], s51 offen offset:16
    buffer_load_dwordx2 v[52:53], v17, s[44:47], s51 offen offset:32
    buffer_load_dwordx2 v[54:55], v17, s[44:47], s51 offen offset:48
    v_mov_b32 v64, 0
    v_mov_b32 v65, 0
    v_mov_b32 v66, 0
    v_mov_b32 v67, 0
    v_mov_b32 v68, 0
    v_mov_b32 v69, 0
    v_mov_b32 v70, 0
    v_mov_b32 v71, 0
    v_mov_b32 v72, 0
    v_mov_b32 v73, 0
    v_mov_b32 v74, 0
    v_mov_b32 v75, 0
    v_mov_b32 v76, 0
    v_mov_b32 v77, 0
    v_mov_b32 v78, 0
    v_mov_b32 v79, 0
    v_mov_b32 v80, 0
    v_mov_b32 v81, 0
    v_mov_b32 v82, 0
    v_mov_b32 v83, 0
    v_mov_b32 v84, 0
    v_mov_b32 v85, 0
    v_mov_b32 v86, 0
    v_mov_b32 v87, 0
    v_mov_b32 v88, 0
    v_mov_b32 v89, 0
    v_mov_b32 v90, 0
    v_mov_b32 v91, 0
    v_mov_b32 v92, 0
    v_mov_b32 v93, 0
    v_mov_b32 v94, 0
    v_mov_b32 v95, 0
    v_mov_b32 v96, 0
    v_mov_b32 v97, 0
    v_mov_b32 v98, 0
    v_mov_b32 v99, 0
    v_mov_b32 v100, 0
    v_mov_b32 v101, 0
    v_mov_b32 v102, 0
    v_mov_b32 v103, 0
    v_mov_b32 v104, 0
    v_mov_b32 v105, 0
    v_mov_b32 v106, 0
    v_mov_b32 v107, 0
    v_mov_b32 v108, 0
    v_mov_b32 v109, 0
    v_mov_b32 v110, 0
    v_mov_b32 v111, 0
    v_mov_b32 v112, 0
    v_mov_b32 v113, 0
    v_mov_b32 v114, 0
    v_mov_b32 v115, 0
    v_mov_b32 v116, 0
    v_mov_b32 v117, 0
    v_mov_b32 v118, 0
    v_mov_b32 v119, 0
    v_mov_b32 v120, 0
    v_mov_b32 v121, 0
    v_mov_b32 v122, 0
    v_mov_b32 v123, 0
    v_mov_b32 v124, 0
    v_mov_b32 v125, 0
    v_mov_b32 v126, 0
    v_mov_b32 v127, 0
    s_waitcnt vmcnt(28)
    v_mfma_f32_32x32x16_bf16 v[64:79], a[8:11], a[0:3], v[64:79]
    v_mfma_f32_32x32x16_bf16 v[80:95], a[12:15], a[0:3], v[80:95]
    v_mfma_f32_32x32x16_bf16 v[96:111], a[8:11], a[4:7], v[96:111]
    v_mfma_f32_32x32x16_bf16 v[112:127], a[12:15], a[4:7], v[112:127]
    s_add_u32 s51, s53, 6144
    buffer_load_dwordx4 a[96:99], v3, s[28:31], s51 offen
    s_add_u32 s51, s53, 120832
    buffer_load_dwordx4 a[100:103], v3, s[28:31], s51 offen
    s_add_u32 s51, s54, 6144
    buffer_load_dwordx4 a[104:107], v3, s[32:35], s51 offen
    s_add_u32 s51, s54, 120832
    buffer_load_dwordx4 a[108:111], v3, s[32:35], s51 offen
    s_waitcnt vmcnt(28)
    v_mfma_f32_32x32x16_bf16 v[64:79], a[24:27], a[16:19], v[64:79]
    v_mfma_f32_32x32x16_bf16 v[80:95], a[28:31], a[16:19], v[80:95]
    v_mfma_f32_32x32x16_bf16 v[96:111], a[24:27], a[20:23], v[96:111]
    v_mfma_f32_32x32x16_bf16 v[112:127], a[28:31], a[20:23], v[112:127]
    s_add_u32 s51, s53, 7168
    buffer_load_dwordx4 a[112:115], v3, s[28:31], s51 offen
    s_add_u32 s51, s53, 121856
    buffer_load_dwordx4 a[116:119], v3, s[28:31], s51 offen
    s_add_u32 s51, s54, 7168
    buffer_load_dwordx4 a[120:123], v3, s[32:35], s51 offen
    s_add_u32 s51, s54, 121856
    buffer_load_dwordx4 a[124:127], v3, s[32:35], s51 offen
    s_waitcnt vmcnt(28)
    v_mfma_f32_32x32x16_bf16 v[64:79], a[40:43], a[32:35], v[64:79]
    v_mfma_f32_32x32x16_bf16 v[80:95], a[44:47], a[32:35], v[80:95]
    v_mfma_f32_32x32x16_bf16 v[96:111], a[40:43], a[36:39], v[96:111]
    v_mfma_f32_32x32x16_bf16 v[112:127], a[44:47], a[36:39], v[112:127]
    s_add_u32 s51, s53, 8192
    buffer_load_dwordx4 a[128:131], v3, s[28:31], s51 offen
    s_add_u32 s51, s53, 122880
    buffer_load_dwordx4 a[132:135], v3, s[28:31], s51 offen
    s_add_u32 s51, s54, 8192
    buffer_load_dwordx4 a[136:139], v3, s[32:35], s51 offen
    s_add_u32 s51, s54, 122880
    buffer_load_dwordx4 a[140:143], v3, s[32:35], s51 offen
    s_waitcnt vmcnt(28)
    v_mfma_f32_32x32x16_bf16 v[64:79], a[56:59], a[48:51], v[64:79]
    v_mfma_f32_32x32x16_bf16 v[80:95], a[60:63], a[48:51], v[80:95]
    v_mfma_f32_32x32x16_bf16 v[96:111], a[56:59], a[52:55], v[96:111]
    v_mfma_f32_32x32x16_bf16 v[112:127], a[60:63], a[52:55], v[112:127]
    s_add_u32 s51, s53, 9216
    buffer_load_dwordx4 a[144:147], v3, s[28:31], s51 offen
    s_add_u32 s51, s53, 123904
    buffer_load_dwordx4 a[148:151], v3, s[28:31], s51 offen
    s_add_u32 s51, s54, 9216
    buffer_load_dwordx4 a[152:155], v3, s[32:35], s51 offen
    s_add_u32 s51, s54, 123904
    buffer_load_dwordx4 a[156:159], v3, s[32:35], s51 offen
    s_waitcnt vmcnt(28)
    v_mfma_f32_32x32x16_bf16 v[64:79], a[72:75], a[64:67], v[64:79]
    v_mfma_f32_32x32x16_bf16 v[80:95], a[76:79], a[64:67], v[80:95]
    v_mfma_f32_32x32x16_bf16 v[96:111], a[72:75], a[68:71], v[96:111]
    v_mfma_f32_32x32x16_bf16 v[112:127], a[76:79], a[68:71], v[112:127]
    s_add_u32 s51, s53, 10240
    buffer_load_dwordx4 a[160:163], v3, s[28:31], s51 offen
    s_add_u32 s51, s53, 124928
    buffer_load_dwordx4 a[164:167], v3, s[28:31], s51 offen
    s_add_u32 s51, s54, 10240
    buffer_load_dwordx4 a[168:171], v3, s[32:35], s51 offen
    s_add_u32 s51, s54, 124928
    buffer_load_dwordx4 a[172:175], v3, s[32:35], s51 offen
    s_waitcnt vmcnt(28)
    v_mfma_f32_32x32x16_bf16 v[64:79], a[88:91], a[80:83], v[64:79]
    v_mfma_f32_32x32x16_bf16 v[80:95], a[92:95], a[80:83], v[80:95]
    v_mfma_f32_32x32x16_bf16 v[96:111], a[88:91], a[84:87], v[96:111]
    v_mfma_f32_32x32x16_bf16 v[112:127], a[92:95], a[84:87], v[112:127]
    s_add_u32 s51, s53, 11264
    buffer_load_dwordx4 a[176:179], v3, s[28:31], s51 offen
    s_add_u32 s51, s53, 125952
    buffer_load_dwordx4 a[180:183], v3, s[28:31], s51 offen
    s_add_u32 s51, s54, 11264
    buffer_load_dwordx4 a[184:187], v3, s[32:35], s51 offen
    s_add_u32 s51, s54, 125952
    buffer_load_dwordx4 a[188:191], v3, s[32:35], s51 offen
    s_waitcnt vmcnt(20)
    v_mfma_f32_32x32x16_bf16 v[64:79], a[104:107], a[96:99], v[64:79]
    v_mfma_f32_32x32x16_bf16 v[80:95], a[108:111], a[96:99], v[80:95]
    v_mfma_f32_32x32x16_bf16 v[96:111], a[104:107], a[100:103], v[96:111]
    v_mfma_f32_32x32x16_bf16 v[112:127], a[108:111], a[100:103], v[112:127]
    s_add_u32 s51, s53, 12288
    buffer_load_dwordx4 a[192:195], v3, s[28:31], s51 offen
    s_add_u32 s51, s53, 126976
    buffer_load_dwordx4 a[196:199], v3, s[28:31], s51 offen
    s_add_u32 s51, s54, 12288
    buffer_load_dwordx4 a[200:203], v3, s[32:35], s51 offen
    s_add_u32 s51, s54, 126976
    buffer_load_dwordx4 a[204:207], v3, s[32:35], s51 offen
    s_waitcnt vmcnt(20)
    v_mfma_f32_32x32x16_bf16 v[64:79], a[120:123], a[112:115], v[64:79]
    v_mfma_f32_32x32x16_bf16 v[80:95], a[124:127], a[112:115], v[80:95]
    v_mfma_f32_32x32x16_bf16 v[96:111], a[120:123], a[116:119], v[96:111]
    v_mfma_f32_32x32x16_bf16 v[112:127], a[124:127], a[116:119], v[112:127]
    s_add_u32 s51, s53, 13312
    buffer_load_dwordx4 a[208:211], v3, s[28:31], s51 offen
    s_add_u32 s51, s53, 128000
    buffer_load_dwordx4 a[212:215], v3, s[28:31], s51 offen
    s_add_u32 s51, s54, 13312
    buffer_load_dwordx4 a[216:219], v3, s[32:35], s51 offen
    s_add_u32 s51, s54, 128000
    buffer_load_dwordx4 a[220:223], v3, s[32:35], s51 offen
    s_waitcnt vmcnt(20)
    v_mfma_f32_32x32x16_bf16 v[64:79], a[136:139], a[128:131], v[64:79]
    v_mfma_f32_32x32x16_bf16 v[80:95], a[140:143], a[128:131], v[80:95]
    v_mfma_f32_32x32x16_bf16 v[96:111], a[136:139], a[132:135], v[96:111]
    v_mfma_f32_32x32x16_bf16 v[112:127], a[140:143], a[132:135], v[112:127]
    s_add_u32 s51, s53, 14336
    buffer_load_dwordx4 a[0:3], v3, s[28:31], s51 offen
    s_add_u32 s51, s53, 129024
    buffer_load_dwordx4 a[4:7], v3, s[28:31], s51 offen
    s_add_u32 s51, s54, 14336
    buffer_load_dwordx4 a[8:11], v3, s[32:35], s51 offen
    s_add_u32 s51, s54, 129024
    buffer_load_dwordx4 a[12:15], v3, s[32:35], s51 offen
    s_waitcnt vmcnt(20)
    v_mfma_f32_32x32x16_bf16 v[64:79], a[152:155], a[144:147], v[64:79]
    v_mfma_f32_32x32x16_bf16 v[80:95], a[156:159], a[144:147], v[80:95]
    v_mfma_f32_32x32x16_bf16 v[96:111], a[152:155], a[148:151], v[96:111]
    v_mfma_f32_32x32x16_bf16 v[112:127], a[156:159], a[148:151], v[112:127]
    s_add_u32 s51, s53, 15360
    buffer_load_dwordx4 a[16:19], v3, s[28:31], s51 offen
    s_add_u32 s51, s53, 130048
    buffer_load_dwordx4 a[20:23], v3, s[28:31], s51 offen
    s_add_u32 s51, s54, 15360
    buffer_load_dwordx4 a[24:27], v3, s[32:35], s51 offen
    s_add_u32 s51, s54, 130048
    buffer_load_dwordx4 a[28:31], v3, s[32:35], s51 offen
    s_waitcnt vmcnt(20)
    v_mfma_f32_32x32x16_bf16 v[64:79], a[168:171], a[160:163], v[64:79]
    v_mfma_f32_32x32x16_bf16 v[80:95], a[172:175], a[160:163], v[80:95]
    v_mfma_f32_32x32x16_bf16 v[96:111], a[168:171], a[164:167], v[96:111]
    v_mfma_f32_32x32x16_bf16 v[112:127], a[172:175], a[164:167], v[112:127]
    s_add_u32 s51, s53, 16384
    buffer_load_dwordx4 a[32:35], v3, s[28:31], s51 offen
    s_add_u32 s51, s53, 131072
    buffer_load_dwordx4 a[36:39], v3, s[28:31], s51 offen
    s_add_u32 s51, s54, 16384
    buffer_load_dwordx4 a[40:43], v3, s[32:35], s51 offen
    s_add_u32 s51, s54, 131072
    buffer_load_dwordx4 a[44:47], v3, s[32:35], s51 offen
    s_waitcnt vmcnt(20)
    v_mfma_f32_32x32x16_bf16 v[64:79], a[184:187], a[176:179], v[64:79]
    v_mfma_f32_32x32x16_bf16 v[80:95], a[188:191], a[176:179], v[80:95]
    v_mfma_f32_32x32x16_bf16 v[96:111], a[184:187], a[180:183], v[96:111]
    v_mfma_f32_32x32x16_bf16 v[112:127], a[188:191], a[180:183], v[112:127]
    s_add_u32 s51, s53, 17408
    buffer_load_dwordx4 a[48:51], v3, s[28:31], s51 offen
    s_add_u32 s51, s53, 132096
    buffer_load_dwordx4 a[52:55], v3, s[28:31], s51 offen
    s_add_u32 s51, s54, 17408
    buffer_load_dwordx4 a[56:59], v3, s[32:35], s51 offen
    s_add_u32 s51, s54, 132096
    buffer_load_dwordx4 a[60:63], v3, s[32:35], s51 offen
    s_waitcnt vmcnt(20)
    v_mfma_f32_32x32x16_bf16 v[64:79], a[200:203], a[192:195], v[64:79]
    v_mfma_f32_32x32x16_bf16 v[80:95], a[204:207], a[192:195], v[80:95]
    v_mfma_f32_32x32x16_bf16 v[96:111], a[200:203], a[196:199], v[96:111]
    v_mfma_f32_32x32x16_bf16 v[112:127], a[204:207], a[196:199], v[112:127]
    s_add_u32 s51, s53, 18432
    buffer_load_dwordx4 a[64:67], v3, s[28:31], s51 offen
    s_add_u32 s51, s53, 133120
    buffer_load_dwordx4 a[68:71], v3, s[28:31], s51 offen
    s_add_u32 s51, s54, 18432
    buffer_load_dwordx4 a[72:75], v3, s[32:35], s51 offen
    s_add_u32 s51, s54, 133120
    buffer_load_dwordx4 a[76:79], v3, s[32:35], s51 offen
    s_waitcnt vmcnt(20)
    v_mfma_f32_32x32x16_bf16 v[64:79], a[216:219], a[208:211], v[64:79]
    v_mfma_f32_32x32x16_bf16 v[80:95], a[220:223], a[208:211], v[80:95]
    v_mfma_f32_32x32x16_bf16 v[96:111], a[216:219], a[212:215], v[96:111]
    v_mfma_f32_32x32x16_bf16 v[112:127], a[220:223], a[212:215], v[112:127]
    s_add_u32 s51, s53, 19456
    buffer_load_dwordx4 a[80:83], v3, s[28:31], s51 offen
    s_add_u32 s51, s53, 134144
    buffer_load_dwordx4 a[84:87], v3, s[28:31], s51 offen
    s_add_u32 s51, s54, 19456
    buffer_load_dwordx4 a[88:91], v3, s[32:35], s51 offen
    s_add_u32 s51, s54, 134144
    buffer_load_dwordx4 a[92:95], v3, s[32:35], s51 offen
    s_waitcnt vmcnt(20)
    v_mfma_f32_32x32x16_bf16 v[64:79], a[8:11], a[0:3], v[64:79]
    v_mfma_f32_32x32x16_bf16 v[80:95], a[12:15], a[0:3], v[80:95]
    v_mfma_f32_32x32x16_bf16 v[96:111], a[8:11], a[4:7], v[96:111]
    v_mfma_f32_32x32x16_bf16 v[112:127], a[12:15], a[4:7], v[112:127]
    s_add_u32 s51, s53, 20480
    buffer_load_dwordx4 a[96:99], v3, s[28:31], s51 offen
    s_add_u32 s51, s53, 135168
    buffer_load_dwordx4 a[100:103], v3, s[28:31], s51 offen
    s_add_u32 s51, s54, 20480
    buffer_load_dwordx4 a[104:107], v3, s[32:35], s51 offen
    s_add_u32 s51, s54, 135168
    buffer_load_dwordx4 a[108:111], v3, s[32:35], s51 offen
    s_waitcnt vmcnt(20)
    v_mfma_f32_32x32x16_bf16 v[64:79], a[24:27], a[16:19], v[64:79]
    v_mfma_f32_32x32x16_bf16 v[80:95], a[28:31], a[16:19], v[80:95]
    v_mfma_f32_32x32x16_bf16 v[96:111], a[24:27], a[20:23], v[96:111]
    v_mfma_f32_32x32x16_bf16 v[112:127], a[28:31], a[20:23], v[112:127]
    s_add_u32 s51, s53, 21504
    buffer_load_dwordx4 a[112:115], v3, s[28:31], s51 offen
    s_add_u32 s51, s53, 136192
    buffer_load_dwordx4 a[116:119], v3, s[28:31], s51 offen
    s_add_u32 s51, s54, 21504
    buffer_load_dwordx4 a[120:123], v3, s[32:35], s51 offen
    s_add_u32 s51, s54, 136192
    buffer_load_dwordx4 a[124:127], v3, s[32:35], s51 offen
    s_waitcnt vmcnt(20)
    v_mfma_f32_32x32x16_bf16 v[64:79], a[40:43], a[32:35], v[64:79]
    v_mfma_f32_32x32x16_bf16 v[80:95], a[44:47], a[32:35], v[80:95]
    v_mfma_f32_32x32x16_bf16 v[96:111], a[40:43], a[36:39], v[96:111]
    v_mfma_f32_32x32x16_bf16 v[112:127], a[44:47], a[36:39], v[112:127]
    s_add_u32 s51, s53, 22528
    buffer_load_dwordx4 a[128:131], v3, s[28:31], s51 offen
    s_add_u32 s51, s53, 137216
    buffer_load_dwordx4 a[132:135], v3, s[28:31], s51 offen
    s_add_u32 s51, s54, 22528
    buffer_load_dwordx4 a[136:139], v3, s[32:35], s51 offen
    s_add_u32 s51, s54, 137216
    buffer_load_dwordx4 a[140:143], v3, s[32:35], s51 offen
    s_waitcnt vmcnt(20)
    v_mfma_f32_32x32x16_bf16 v[64:79], a[56:59], a[48:51], v[64:79]
    v_mfma_f32_32x32x16_bf16 v[80:95], a[60:63], a[48:51], v[80:95]
    v_mfma_f32_32x32x16_bf16 v[96:111], a[56:59], a[52:55], v[96:111]
    v_mfma_f32_32x32x16_bf16 v[112:127], a[60:63], a[52:55], v[112:127]
    s_add_u32 s51, s53, 23552
    buffer_load_dwordx4 a[144:147], v3, s[28:31], s51 offen
    s_add_u32 s51, s53, 138240
    buffer_load_dwordx4 a[148:151], v3, s[28:31], s51 offen
    s_add_u32 s51, s54, 23552
    buffer_load_dwordx4 a[152:155], v3, s[32:35], s51 offen
    s_add_u32 s51, s54, 138240
    buffer_load_dwordx4 a[156:159], v3, s[32:35], s51 offen
    s_waitcnt vmcnt(20)
    v_mfma_f32_32x32x16_bf16 v[64:79], a[72:75], a[64:67], v[64:79]
    v_mfma_f32_32x32x16_bf16 v[80:95], a[76:79], a[64:67], v[80:95]
    v_mfma_f32_32x32x16_bf16 v[96:111], a[72:75], a[68:71], v[96:111]
    v_mfma_f32_32x32x16_bf16 v[112:127], a[76:79], a[68:71], v[112:127]
    s_add_u32 s51, s53, 24576
    buffer_load_dwordx4 a[160:163], v3, s[28:31], s51 offen
    s_add_u32 s51, s53, 139264
    buffer_load_dwordx4 a[164:167], v3, s[28:31], s51 offen
    s_add_u32 s51, s54, 24576
    buffer_load_dwordx4 a[168:171], v3, s[32:35], s51 offen
    s_add_u32 s51, s54, 139264
    buffer_load_dwordx4 a[172:175], v3, s[32:35], s51 offen
    s_waitcnt vmcnt(20)
    v_mfma_f32_32x32x16_bf16 v[64:79], a[88:91], a[80:83], v[64:79]
    v_mfma_f32_32x32x16_bf16 v[80:95], a[92:95], a[80:83], v[80:95]
    v_mfma_f32_32x32x16_bf16 v[96:111], a[88:91], a[84:87], v[96:111]
    v_mfma_f32_32x32x16_bf16 v[112:127], a[92:95], a[84:87], v[112:127]
    s_add_u32 s51, s53, 25600
    buffer_load_dwordx4 a[176:179], v3, s[28:31], s51 offen
    s_add_u32 s51, s53, 140288
    buffer_load_dwordx4 a[180:183], v3, s[28:31], s51 offen
    s_add_u32 s51, s54, 25600
    buffer_load_dwordx4 a[184:187], v3, s[32:35], s51 offen
    s_add_u32 s51, s54, 140288
    buffer_load_dwordx4 a[188:191], v3, s[32:35], s51 offen
    s_waitcnt vmcnt(20)
    v_mfma_f32_32x32x16_bf16 v[64:79], a[104:107], a[96:99], v[64:79]
    v_mfma_f32_32x32x16_bf16 v[80:95], a[108:111], a[96:99], v[80:95]
    v_mfma_f32_32x32x16_bf16 v[96:111], a[104:107], a[100:103], v[96:111]
    v_mfma_f32_32x32x16_bf16 v[112:127], a[108:111], a[100:103], v[112:127]
    s_add_u32 s51, s53, 26624
    buffer_load_dwordx4 a[192:195], v3, s[28:31], s51 offen
    s_add_u32 s51, s53, 141312
    buffer_load_dwordx4 a[196:199], v3, s[28:31], s51 offen
    s_add_u32 s51, s54, 26624
    buffer_load_dwordx4 a[200:203], v3, s[32:35], s51 offen
    s_add_u32 s51, s54, 141312
    buffer_load_dwordx4 a[204:207], v3, s[32:35], s51 offen
    s_waitcnt vmcnt(20)
    v_mfma_f32_32x32x16_bf16 v[64:79], a[120:123], a[112:115], v[64:79]
    v_mfma_f32_32x32x16_bf16 v[80:95], a[124:127], a[112:115], v[80:95]
    v_mfma_f32_32x32x16_bf16 v[96:111], a[120:123], a[116:119], v[96:111]
    v_mfma_f32_32x32x16_bf16 v[112:127], a[124:127], a[116:119], v[112:127]
    s_add_u32 s51, s53, 27648
    buffer_load_dwordx4 a[208:211], v3, s[28:31], s51 offen
    s_add_u32 s51, s53, 142336
    buffer_load_dwordx4 a[212:215], v3, s[28:31], s51 offen
    s_add_u32 s51, s54, 27648
    buffer_load_dwordx4 a[216:219], v3, s[32:35], s51 offen
    s_add_u32 s51, s54, 142336
    buffer_load_dwordx4 a[220:223], v3, s[32:35], s51 offen
    s_waitcnt vmcnt(20)
    v_mfma_f32_32x32x16_bf16 v[64:79], a[136:139], a[128:131], v[64:79]
    v_mfma_f32_32x32x16_bf16 v[80:95], a[140:143], a[128:131], v[80:95]
    v_mfma_f32_32x32x16_bf16 v[96:111], a[136:139], a[132:135], v[96:111]
    v_mfma_f32_32x32x16_bf16 v[112:127], a[140:143], a[132:135], v[112:127]
    s_waitcnt vmcnt(16)
    v_mfma_f32_32x32x16_bf16 v[64:79], a[152:155], a[144:147], v[64:79]
    v_mfma_f32_32x32x16_bf16 v[80:95], a[156:159], a[144:147], v[80:95]
    v_mfma_f32_32x32x16_bf16 v[96:111], a[152:155], a[148:151], v[96:111]
    v_mfma_f32_32x32x16_bf16 v[112:127], a[156:159], a[148:151], v[112:127]
    s_waitcnt vmcnt(12)
    v_mfma_f32_32x32x16_bf16 v[64:79], a[168:171], a[160:163], v[64:79]
    v_mfma_f32_32x32x16_bf16 v[80:95], a[172:175], a[160:163], v[80:95]
    v_mfma_f32_32x32x16_bf16 v[96:111], a[168:171], a[164:167], v[96:111]
    v_mfma_f32_32x32x16_bf16 v[112:127], a[172:175], a[164:167], v[112:127]
    s_waitcnt vmcnt(8)
    v_mfma_f32_32x32x16_bf16 v[64:79], a[184:187], a[176:179], v[64:79]
    v_mfma_f32_32x32x16_bf16 v[80:95], a[188:191], a[176:179], v[80:95]
    v_mfma_f32_32x32x16_bf16 v[96:111], a[184:187], a[180:183], v[96:111]
    v_mfma_f32_32x32x16_bf16 v[112:127], a[188:191], a[180:183], v[112:127]
    s_waitcnt vmcnt(4)
    v_mfma_f32_32x32x16_bf16 v[64:79], a[200:203], a[192:195], v[64:79]
    v_mfma_f32_32x32x16_bf16 v[80:95], a[204:207], a[192:195], v[80:95]
    v_mfma_f32_32x32x16_bf16 v[96:111], a[200:203], a[196:199], v[96:111]
    v_mfma_f32_32x32x16_bf16 v[112:127], a[204:207], a[196:199], v[112:127]
    s_waitcnt vmcnt(0)
    v_mfma_f32_32x32x16_bf16 v[64:79], a[216:219], a[208:211], v[64:79]
    v_mfma_f32_32x32x16_bf16 v[80:95], a[220:223], a[208:211], v[80:95]
    v_mfma_f32_32x32x16_bf16 v[96:111], a[216:219], a[212:215], v[96:111]
    v_mfma_f32_32x32x16_bf16 v[112:127], a[220:223], a[212:215], v[112:127]
    s_lshl_b32 s52, s50, 12
    v_add_u32 v4, s52, v3
    s_lshl_b32 s52, s50, 14
    v_add_u32 v6, s52, v3
    s_nop 15
    ds_write_b128 v4, v[64:67] offset:0
    ds_write_b128 v4, v[68:71] offset:1024
    ds_write_b128 v4, v[72:75] offset:2048
    ds_write_b128 v4, v[76:79] offset:3072
    ds_write_b128 v4, v[80:83] offset:16384
    ds_write_b128 v4, v[84:87] offset:17408
    ds_write_b128 v4, v[88:91] offset:18432
    ds_write_b128 v4, v[92:95] offset:19456
    ds_write_b128 v4, v[96:99] offset:32768
    ds_write_b128 v4, v[100:103] offset:33792
    ds_write_b128 v4, v[104:107] offset:34816
    ds_write_b128 v4, v[108:111] offset:35840
    ds_write_b128 v4, v[112:115] offset:49152
    ds_write_b128 v4, v[116:119] offset:50176
    ds_write_b128 v4, v[120:123] offset:51200
    ds_write_b128 v4, v[124:127] offset:52224
    s_waitcnt lgkmcnt(0)
    s_barrier
    ds_read_b128 v[64:67], v6 offset:0
    ds_read_b128 v[68:71], v6 offset:1024
    ds_read_b128 v[72:75], v6 offset:2048
    ds_read_b128 v[76:79], v6 offset:3072
    ds_read_b128 v[80:83], v6 offset:4096
    ds_read_b128 v[84:87], v6 offset:5120
    ds_read_b128 v[88:91], v6 offset:6144
    ds_read_b128 v[92:95], v6 offset:7168
    ds_read_b128 v[96:99], v6 offset:8192
    ds_read_b128 v[100:103], v6 offset:9216
    ds_read_b128 v[104:107], v6 offset:10240
    ds_read_b128 v[108:111], v6 offset:11264
    ds_read_b128 v[112:115], v6 offset:12288
    ds_read_b128 v[116:119], v6 offset:13312
    ds_read_b128 v[120:123], v6 offset:14336
    ds_read_b128 v[124:127], v6 offset:15360
    v_mov_b32 v18, v16
    v_mov_b32 v7, 0x3f803f80
    v_mov_b32 v8, 0
    v_mov_b32 v9, 0
    s_waitcnt vmcnt(0) lgkmcnt(0)
    v_pk_add_f32 v[64:65], v[64:65], v[80:81]
    v_pk_add_f32 v[96:97], v[96:97], v[112:113]
    v_pk_add_f32 v[66:67], v[66:67], v[82:83]
    v_pk_add_f32 v[98:99], v[98:99], v[114:115]
    v_pk_add_f32 v[68:69], v[68:69], v[84:85]
    v_pk_add_f32 v[100:101], v[100:101], v[116:117]
    v_pk_add_f32 v[70:71], v[70:71], v[86:87]
    v_pk_add_f32 v[102:103], v[102:103], v[118:119]
    v_pk_add_f32 v[72:73], v[72:73], v[88:89]
    v_pk_add_f32 v[104:105], v[104:105], v[120:121]
    v_pk_add_f32 v[74:75], v[74:75], v[90:91]
    v_pk_add_f32 v[106:107], v[106:107], v[122:123]
    v_pk_add_f32 v[76:77], v[76:77], v[92:93]
    v_pk_add_f32 v[108:109], v[108:109], v[124:125]
    v_pk_add_f32 v[78:79], v[78:79], v[94:95]
    v_pk_add_f32 v[110:111], v[110:111], v[126:127]
    v_pk_add_f32 v[64:65], v[64:65], v[96:97]
    v_pk_add_f32 v[66:67], v[66:67], v[98:99]
    v_pk_add_f32 v[68:69], v[68:69], v[100:101]
    v_pk_add_f32 v[70:71], v[70:71], v[102:103]
    v_pk_add_f32 v[72:73], v[72:73], v[104:105]
    v_pk_add_f32 v[74:75], v[74:75], v[106:107]
    v_pk_add_f32 v[76:77], v[76:77], v[108:109]
    v_pk_add_f32 v[78:79], v[78:79], v[110:111]
    v_cvt_pk_bf16_f32 v56, v64, v65
    v_lshlrev_b32 v64, 16, v56
    v_and_b32 v65, 0xffff0000, v56
    v_cvt_pk_bf16_f32 v57, v66, v67
    v_lshlrev_b32 v66, 16, v57
    v_and_b32 v67, 0xffff0000, v57
    v_lshlrev_b32 v58, 16, v48
    v_and_b32 v59, 0xffff0000, v48
    v_pk_add_f32 v[64:65], v[64:65], v[58:59]
    v_lshlrev_b32 v58, 16, v49
    v_and_b32 v59, 0xffff0000, v49
    v_pk_add_f32 v[66:67], v[66:67], v[58:59]
    v_cvt_pk_bf16_f32 v56, v64, v65
    v_lshlrev_b32 v64, 16, v56
    v_and_b32 v65, 0xffff0000, v56
    v_cvt_pk_bf16_f32 v57, v66, v67
    v_lshlrev_b32 v66, 16, v57
    v_and_b32 v67, 0xffff0000, v57
    v_lshlrev_b32 v58, 16, v40
    v_and_b32 v59, 0xffff0000, v40
    v_pk_add_f32 v[64:65], v[64:65], v[58:59]
    v_lshlrev_b32 v58, 16, v41
    v_and_b32 v59, 0xffff0000, v41
    v_pk_add_f32 v[66:67], v[66:67], v[58:59]
    v_cvt_pk_bf16_f32 v20, v64, v65
    v_cvt_pk_bf16_f32 v21, v66, v67
    buffer_store_dwordx2 v[20:21], v18, s[40:43], s55 offen offset:0
    v_dot2_f32_bf16 v8, v20, v7, v8
    v_dot2_f32_bf16 v9, v20, v20, v9
    v_dot2_f32_bf16 v8, v21, v7, v8
    v_dot2_f32_bf16 v9, v21, v21, v9
    v_cvt_pk_bf16_f32 v56, v68, v69
    v_lshlrev_b32 v68, 16, v56
    v_and_b32 v69, 0xffff0000, v56
    v_cvt_pk_bf16_f32 v57, v70, v71
    v_lshlrev_b32 v70, 16, v57
    v_and_b32 v71, 0xffff0000, v57
    v_lshlrev_b32 v58, 16, v50
    v_and_b32 v59, 0xffff0000, v50
    v_pk_add_f32 v[68:69], v[68:69], v[58:59]
    v_lshlrev_b32 v58, 16, v51
    v_and_b32 v59, 0xffff0000, v51
    v_pk_add_f32 v[70:71], v[70:71], v[58:59]
    v_cvt_pk_bf16_f32 v56, v68, v69
    v_lshlrev_b32 v68, 16, v56
    v_and_b32 v69, 0xffff0000, v56
    v_cvt_pk_bf16_f32 v57, v70, v71
    v_lshlrev_b32 v70, 16, v57
    v_and_b32 v71, 0xffff0000, v57
    v_lshlrev_b32 v58, 16, v42
    v_and_b32 v59, 0xffff0000, v42
    v_pk_add_f32 v[68:69], v[68:69], v[58:59]
    v_lshlrev_b32 v58, 16, v43
    v_and_b32 v59, 0xffff0000, v43
    v_pk_add_f32 v[70:71], v[70:71], v[58:59]
    v_cvt_pk_bf16_f32 v22, v68, v69
    v_cvt_pk_bf16_f32 v23, v70, v71
    buffer_store_dwordx2 v[22:23], v18, s[40:43], s55 offen offset:512
    v_dot2_f32_bf16 v8, v22, v7, v8
    v_dot2_f32_bf16 v9, v22, v22, v9
    v_dot2_f32_bf16 v8, v23, v7, v8
    v_dot2_f32_bf16 v9, v23, v23, v9
    v_cvt_pk_bf16_f32 v56, v72, v73
    v_lshlrev_b32 v72, 16, v56
    v_and_b32 v73, 0xffff0000, v56
    v_cvt_pk_bf16_f32 v57, v74, v75
    v_lshlrev_b32 v74, 16, v57
    v_and_b32 v75, 0xffff0000, v57
    v_lshlrev_b32 v58, 16, v52
    v_and_b32 v59, 0xffff0000, v52
    v_pk_add_f32 v[72:73], v[72:73], v[58:59]
    v_lshlrev_b32 v58, 16, v53
    v_and_b32 v59, 0xffff0000, v53
    v_pk_add_f32 v[74:75], v[74:75], v[58:59]
    v_cvt_pk_bf16_f32 v56, v72, v73
    v_lshlrev_b32 v72, 16, v56
    v_and_b32 v73, 0xffff0000, v56
    v_cvt_pk_bf16_f32 v57, v74, v75
    v_lshlrev_b32 v74, 16, v57
    v_and_b32 v75, 0xffff0000, v57
    v_lshlrev_b32 v58, 16, v44
    v_and_b32 v59, 0xffff0000, v44
    v_pk_add_f32 v[72:73], v[72:73], v[58:59]
    v_lshlrev_b32 v58, 16, v45
    v_and_b32 v59, 0xffff0000, v45
    v_pk_add_f32 v[74:75], v[74:75], v[58:59]
    v_cvt_pk_bf16_f32 v24, v72, v73
    v_cvt_pk_bf16_f32 v25, v74, v75
    buffer_store_dwordx2 v[24:25], v18, s[40:43], s55 offen offset:1024
    v_dot2_f32_bf16 v8, v24, v7, v8
    v_dot2_f32_bf16 v9, v24, v24, v9
    v_dot2_f32_bf16 v8, v25, v7, v8
    v_dot2_f32_bf16 v9, v25, v25, v9
    v_cvt_pk_bf16_f32 v56, v76, v77
    v_lshlrev_b32 v76, 16, v56
    v_and_b32 v77, 0xffff0000, v56
    v_cvt_pk_bf16_f32 v57, v78, v79
    v_lshlrev_b32 v78, 16, v57
    v_and_b32 v79, 0xffff0000, v57
    v_lshlrev_b32 v58, 16, v54
    v_and_b32 v59, 0xffff0000, v54
    v_pk_add_f32 v[76:77], v[76:77], v[58:59]
    v_lshlrev_b32 v58, 16, v55
    v_and_b32 v59, 0xffff0000, v55
    v_pk_add_f32 v[78:79], v[78:79], v[58:59]
    v_cvt_pk_bf16_f32 v56, v76, v77
    v_lshlrev_b32 v76, 16, v56
    v_and_b32 v77, 0xffff0000, v56
    v_cvt_pk_bf16_f32 v57, v78, v79
    v_lshlrev_b32 v78, 16, v57
    v_and_b32 v79, 0xffff0000, v57
    v_lshlrev_b32 v58, 16, v46
    v_and_b32 v59, 0xffff0000, v46
    v_pk_add_f32 v[76:77], v[76:77], v[58:59]
    v_lshlrev_b32 v58, 16, v47
    v_and_b32 v59, 0xffff0000, v47
    v_pk_add_f32 v[78:79], v[78:79], v[58:59]
    v_cvt_pk_bf16_f32 v26, v76, v77
    v_cvt_pk_bf16_f32 v27, v78, v79
    buffer_store_dwordx2 v[26:27], v18, s[40:43], s55 offen offset:1536
    v_dot2_f32_bf16 v8, v26, v7, v8
    v_dot2_f32_bf16 v9, v26, v26, v9
    v_dot2_f32_bf16 v8, v27, v7, v8
    v_dot2_f32_bf16 v9, v27, v27, v9
    v_mov_b32 v10, v16
    s_lshr_b32 s51, s50, 1
    s_lshl_b32 s52, s48, 1
    s_add_u32 s51, s51, s52
    s_lshl_b32 s51, s51, 9
    s_lshl_b32 s52, s49, 16
    s_add_u32 s51, s51, s52
    s_and_b32 s52, s50, 1
    s_lshl_b32 s52, s52, 15
    s_add_u32 s51, s51, s52
    buffer_store_dwordx2 v[8:9], v10, s[56:59], s51 offen
L_ffn2a_kernel_end:
    s_endpgm
.globl qkv2_kernel
.p2align 8
.type qkv2_kernel,@function
qkv2_kernel:
    s_cmp_ge_u32 s2, 192
    s_cbranch_scc1 L_qkv2_kernel_end
    s_load_dwordx16 s[4:19], s[0:1], 0
    s_load_dwordx4 s[20:23], s[0:1], 64
    s_load_dwordx2 s[24:25], s[0:1], 80
    s_and_b32 s51, s2, 7
    s_mul_i32 s51, s51, 24
    s_lshr_b32 s54, s2, 3
    s_add_u32 s54, s54, s51
    s_mov_b32 s51, 0x05555556
    s_mul_hi_u32 s48, s54, s51
    s_mul_i32 s51, s48, 48
    s_sub_u32 s54, s54, s51
    s_lshr_b32 s49, s54, 3
    s_and_b32 s54, s54, 7
    s_lshl_b32 s48, s48, 3
    s_add_u32 s48, s48, s54
    v_lshrrev_b32 v2, 6, v0
    v_and_b32 v1, 63, v0
    v_lshrrev_b32 v5, 5, v1
    v_readfirstlane_b32 s50, v2
    v_lshlrev_b32 v3, 4, v1
    s_waitcnt lgkmcnt(0)
    s_add_u32 s28, s24, 0x01200000
    s_addc_u32 s29, s25, 0
    s_and_b32 s29, s29, 0xffff
    s_mov_b32 s30, 0x00200000
    s_mov_b32 s31, 0x00020000
    s_add_u32 s32, s24, 0x01600000
    s_addc_u32 s33, s25, 0
    s_and_b32 s33, s33, 0xffff
    s_mov_b32 s34, 0x00180000
    s_mov_b32 s35, 0x00020000
    s_add_u32 s44, s24, 0x02200000
    s_addc_u32 s45, s25, 0
    s_and_b32 s45, s45, 0xffff
    s_mov_b32 s46, 0x00080000
    s_mov_b32 s47, 0x00020000
    s_add_u32 s64, s24, 0x02400000
    s_addc_u32 s65, s25, 0
    s_and_b32 s65, s65, 0xffff
    s_mov_b32 s66, 0x00001800
    s_mov_b32 s67, 0x00020000
    s_lshl_b32 s51, s48, 16
    s_lshl_b32 s54, s50, 13
    s_add_u32 s51, s51, s54
    s_add_u32 m0, s54, 0
    s_add_u32 s59, s51, 0
    buffer_load_dwordx4 v3, s[28:31], s59 offen offset:0 lds
    buffer_load_dwordx4 v3, s[28:31], s59 offen offset:1024 lds
    buffer_load_dwordx4 v3, s[28:31], s59 offen offset:2048 lds
    buffer_load_dwordx4 v3, s[28:31], s59 offen offset:3072 lds
    s_add_u32 m0, s54, 4096
    s_add_u32 s59, s51, 4096
    buffer_load_dwordx4 v3, s[28:31], s59 offen offset:0 lds
    buffer_load_dwordx4 v3, s[28:31], s59 offen offset:1024 lds
    buffer_load_dwordx4 v3, s[28:31], s59 offen offset:2048 lds
    buffer_load_dwordx4 v3, s[28:31], s59 offen offset:3072 lds
    s_lshl_b32 s58, s49, 3
    s_add_u32 s58, s58, s50
    s_lshl_b32 s52, s58, 15
    s_lshl_b32 s57, s58, 5
    s_add_u32 s61, s52, 0
    buffer_load_dwordx4 a[0:3], v3, s[32:35], s61 offen offset:0
    buffer_load_dwordx4 a[4:7], v3, s[32:35], s61 offen offset:1024
    buffer_load_dwordx4 a[8:11], v3, s[32:35], s61 offen offset:2048
    buffer_load_dwordx4 a[12:15], v3, s[32:35], s61 offen offset:3072
    s_add_u32 s61, s52, 4096
    buffer_load_dwordx4 a[16:19], v3, s[32:35], s61 offen offset:0
    buffer_load_dwordx4 a[20:23], v3, s[32:35], s61 offen offset:1024
    buffer_load_dwordx4 a[24:27], v3, s[32:35], s61 offen offset:2048
    buffer_load_dwordx4 a[28:31], v3, s[32:35], s61 offen offset:3072
    v_lshrrev_b32 v24, 3, v1
    v_and_b32 v25, 7, v1
    v_lshlrev_b32 v25, 16, v25
    v_lshl_add_u32 v24, v24, 4, v25
    s_lshl_b32 s60, s48, 10
    s_lshl_b32 s59, s50, 7
    s_add_u32 s60, s60, s59
    buffer_load_dwordx4 v[64:67], v24, s[44:47], s60 offen
    s_add_u32 s60, s60, 32768
    buffer_load_dwordx4 v[68:71], v24, s[44:47], s60 offen
    v_mov_b32 v32, 0
    v_mov_b32 v33, 0
    v_mov_b32 v34, 0
    v_mov_b32 v35, 0
    v_mov_b32 v36, 0
    v_mov_b32 v37, 0
    v_mov_b32 v38, 0
    v_mov_b32 v39, 0
    v_mov_b32 v40, 0
    v_mov_b32 v41, 0
    v_mov_b32 v42, 0
    v_mov_b32 v43, 0
    v_mov_b32 v44, 0
    v_mov_b32 v45, 0
    v_mov_b32 v46, 0
    v_mov_b32 v47, 0
    v_mov_b32 v48, 0
    v_mov_b32 v49, 0
    v_mov_b32 v50, 0
    v_mov_b32 v51, 0
    v_mov_b32 v52, 0
    v_mov_b32 v53, 0
    v_mov_b32 v54, 0
    v_mov_b32 v55, 0
    v_mov_b32 v56, 0
    v_mov_b32 v57, 0
    v_mov_b32 v58, 0
    v_mov_b32 v59, 0
    v_mov_b32 v60, 0
    v_mov_b32 v61, 0
    v_mov_b32 v62, 0
    v_mov_b32 v63, 0
    v_and_b32 v4, 31, v1
    v_lshlrev_b32 v7, 4, v4
    v_lshl_add_u32 v7, v5, 3, v7
    s_cmp_ge_u32 s58, 32
    s_cbranch_scc1 L_qkv2_kernel_vpath_1
    v_lshlrev_b32 v6, 4, v5
    s_lshl_b32 s51, s57, 2
    buffer_load_dwordx4 v[8:11], v6, s[64:67], s51 offen offset:0
    buffer_load_dwordx4 v[12:15], v6, s[64:67], s51 offen offset:32
    buffer_load_dwordx4 v[16:19], v6, s[64:67], s51 offen offset:64
    buffer_load_dwordx4 v[20:23], v6, s[64:67], s51 offen offset:96
    s_cmp_lt_u32 s58, 16
    s_cselect_b32 s55, 0x3eb8aa3b, 1.0
    s_mov_b32 s36, s24
    s_and_b32 s37, s25, 0xffff
    s_mov_b32 s38, 0x00600000
    s_mov_b32 s39, 0x00020000
    s_lshl_b32 s56, s58, 17
    s_lshl_b32 s51, s48, 11
    s_add_u32 s56, s56, s51
    s_cmp_ge_u32 s50, 4
    s_cbranch_scc1 L_qkv2_kernel_prio_2
    s_setprio 2
L_qkv2_kernel_prio_2:
    s_waitcnt vmcnt(14)
    s_barrier
    ds_read_b128 v[96:99], v3 offset:0
    ds_read_b128 v[100:103], v3 offset:32768
    ds_read_b128 v[104:107], v3 offset:1024
    ds_read_b128 v[108:111], v3 offset:33792
    ds_read_b128 v[112:115], v3 offset:2048
    ds_read_b128 v[116:119], v3 offset:34816
    s_add_u32 s61, s52, 8192
    buffer_load_dwordx4 a[32:35], v3, s[32:35], s61 offen offset:0
    s_waitcnt vmcnt(14) lgkmcnt(4)
    v_mfma_f32_32x32x16_bf16 v[32:47], a[0:3], v[96:99], v[32:47]
    v_mfma_f32_32x32x16_bf16 v[48:63], a[0:3], v[100:103], v[48:63]
    ds_read_b128 v[120:123], v3 offset:3072
    ds_read_b128 v[124:127], v3 offset:35840
    buffer_load_dwordx4 a[36:39], v3, s[32:35], s61 offen offset:1024
    s_waitcnt vmcnt(14) lgkmcnt(4)
    v_mfma_f32_32x32x16_bf16 v[32:47], a[4:7], v[104:107], v[32:47]
    v_mfma_f32_32x32x16_bf16 v[48:63], a[4:7], v[108:111], v[48:63]
    ds_read_b128 v[96:99], v3 offset:4096
    ds_read_b128 v[100:103], v3 offset:36864
    buffer_load_dwordx4 a[40:43], v3, s[32:35], s61 offen offset:2048
    s_waitcnt vmcnt(14) lgkmcnt(4)
    v_mfma_f32_32x32x16_bf16 v[32:47], a[8:11], v[112:115], v[32:47]
    v_mfma_f32_32x32x16_bf16 v[48:63], a[8:11], v[116:119], v[48:63]
    ds_read_b128 v[104:107], v3 offset:5120
    ds_read_b128 v[108:111], v3 offset:37888
    buffer_load_dwordx4 a[44:47], v3, s[32:35], s61 offen offset:3072
    s_waitcnt vmcnt(14) lgkmcnt(4)
    v_mfma_f32_32x32x16_bf16 v[32:47], a[12:15], v[120:123], v[32:47]
    v_mfma_f32_32x32x16_bf16 v[48:63], a[12:15], v[124:127], v[48:63]
    ds_read_b128 v[112:115], v3 offset:6144
    ds_read_b128 v[116:119], v3 offset:38912
    s_add_u32 s61, s52, 12288
    buffer_load_dwordx4 a[48:51], v3, s[32:35], s61 offen offset:0
    s_waitcnt vmcnt(14) lgkmcnt(4)
    v_mfma_f32_32x32x16_bf16 v[32:47], a[16:19], v[96:99], v[32:47]
    v_mfma_f32_32x32x16_bf16 v[48:63], a[16:19], v[100:103], v[48:63]
    ds_read_b128 v[120:123], v3 offset:7168
    ds_read_b128 v[124:127], v3 offset:39936
    buffer_load_dwordx4 a[52:55], v3, s[32:35], s61 offen offset:1024
    s_waitcnt vmcnt(14) lgkmcnt(4)
    v_mfma_f32_32x32x16_bf16 v[32:47], a[20:23], v[104:107], v[32:47]
    v_mfma_f32_32x32x16_bf16 v[48:63], a[20:23], v[108:111], v[48:63]
    ds_read_b128 v[96:99], v3 offset:8192
    ds_read_b128 v[100:103], v3 offset:40960
    buffer_load_dwordx4 a[56:59], v3, s[32:35], s61 offen offset:2048
    s_waitcnt vmcnt(11)
    v_pk_add_f32 v[64:65], v[64:65], v[66:67]
    v_pk_add_f32 v[68:69], v[68:69], v[70:71]
    v_pk_add_f32 v[24:25], v[64:65], v[68:69]
    s_nop 1
    v_add_f32_dpp v24, v24, v24 quad_perm:[1,0,3,2] row_mask:0xf bank_mask:0xf
    v_add_f32_dpp v25, v25, v25 quad_perm:[1,0,3,2] row_mask:0xf bank_mask:0xf
    s_nop 1
    v_add_f32_dpp v24, v24, v24 quad_perm:[2,3,0,1] row_mask:0xf bank_mask:0xf
    v_add_f32_dpp v25, v25, v25 quad_perm:[2,3,0,1] row_mask:0xf bank_mask:0xf
    s_nop 1
    v_add_f32_dpp v24, v24, v24 row_half_mirror row_mask:0xf bank_mask:0xf
    v_add_f32_dpp v25, v25, v25 row_half_mirror row_mask:0xf bank_mask:0xf
    v_mul_f32 v29, 0x3b000000, v24
    v_mul_f32 v28, 0x3b000000, v25
    v_fma_f32 v28, -v29, v29, v28
    v_max_f32 v28, 0, v28
    v_cvt_pk_bf16_f32 v30, v29, v28
    v_lshlrev_b32 v29, 16, v30
    v_and_b32 v28, 0xffff0000, v30
    v_add_f32 v28, 0x3727c5ac, v28
    v_cvt_pk_bf16_f32 v30, v28, v28
    v_and_b32 v28, 0xffff0000, v30
    v_sqrt_f32 v28, v28
    s_nop 0
    v_cvt_pk_bf16_f32 v30, v28, v28
    v_and_b32 v28, 0xffff0000, v30
    v_rcp_f32 v28, v28
    s_nop 0
    v_mul_f32 v29, v29, v28
    v_sub_f32 v29, 0, v29
    v_lshrrev_b32 v30, 3, v1
    v_lshlrev_b32 v30, 3, v30
    s_lshl_b32 s59, s50, 6
    s_add_u32 s59, s59, 65536
    v_add_u32 v30, s59, v30
    ds_write_b64 v30, v[28:29]
    s_waitcnt lgkmcnt(0)
    s_waitcnt vmcnt(14) lgkmcnt(4)
    v_mfma_f32_32x32x16_bf16 v[32:47], a[24:27], v[112:115], v[32:47]
    v_mfma_f32_32x32x16_bf16 v[48:63], a[24:27], v[116:119], v[48:63]
    ds_read_b128 v[104:107], v3 offset:9216
    ds_read_b128 v[108:111], v3 offset:41984
    buffer_load_dwordx4 a[60:63], v3, s[32:35], s61 offen offset:3072
    s_waitcnt vmcnt(14) lgkmcnt(4)
    v_mfma_f32_32x32x16_bf16 v[32:47], a[28:31], v[120:123], v[32:47]
    v_mfma_f32_32x32x16_bf16 v[48:63], a[28:31], v[124:127], v[48:63]
    ds_read_b128 v[112:115], v3 offset:10240
    ds_read_b128 v[116:119], v3 offset:43008
    s_add_u32 s61, s52, 16384
    buffer_load_dwordx4 a[64:67], v3, s[32:35], s61 offen offset:0
    s_barrier
    s_waitcnt vmcnt(8) lgkmcnt(4)
    v_mfma_f32_32x32x16_bf16 v[32:47], a[32:35], v[96:99], v[32:47]
    v_mfma_f32_32x32x16_bf16 v[48:63], a[32:35], v[100:103], v[48:63]
    ds_read_b128 v[120:123], v3 offset:11264
    ds_read_b128 v[124:127], v3 offset:44032
    buffer_load_dwordx4 a[68:71], v3, s[32:35], s61 offen offset:1024
    s_waitcnt vmcnt(8) lgkmcnt(4)
    v_mfma_f32_32x32x16_bf16 v[32:47], a[36:39], v[104:107], v[32:47]
    v_mfma_f32_32x32x16_bf16 v[48:63], a[36:39], v[108:111], v[48:63]
    ds_read_b128 v[96:99], v3 offset:12288
    ds_read_b128 v[100:103], v3 offset:45056
    buffer_load_dwordx4 a[72:75], v3, s[32:35], s61 offen offset:2048
    s_waitcnt vmcnt(8) lgkmcnt(4)
    v_mfma_f32_32x32x16_bf16 v[32:47], a[40:43], v[112:115], v[32:47]
    v_mfma_f32_32x32x16_bf16 v[48:63], a[40:43], v[116:119], v[48:63]
    ds_read_b128 v[104:107], v3 offset:13312
    ds_read_b128 v[108:111], v3 offset:46080
    buffer_load_dwordx4 a[76:79], v3, s[32:35], s61 offen offset:3072
    s_waitcnt vmcnt(8) lgkmcnt(4)
    v_mfma_f32_32x32x16_bf16 v[32:47], a[44:47], v[120:123], v[32:47]
    v_mfma_f32_32x32x16_bf16 v[48:63], a[44:47], v[124:127], v[48:63]
    ds_read_b128 v[112:115], v3 offset:14336
    ds_read_b128 v[116:119], v3 offset:47104
    s_add_u32 s61, s52, 20480
    buffer_load_dwordx4 a[80:83], v3, s[32:35], s61 offen offset:0
    s_waitcnt vmcnt(8) lgkmcnt(4)
    v_mfma_f32_32x32x16_bf16 v[32:47], a[48:51], v[96:99], v[32:47]
    v_mfma_f32_32x32x16_bf16 v[48:63], a[48:51], v[100:103], v[48:63]
    ds_read_b128 v[120:123], v3 offset:15360
    ds_read_b128 v[124:127], v3 offset:48128
    buffer_load_dwordx4 a[84:87], v3, s[32:35], s61 offen offset:1024
    s_waitcnt vmcnt(8) lgkmcnt(4)
    v_mfma_f32_32x32x16_bf16 v[32:47], a[52:55], v[104:107], v[32:47]
    v_mfma_f32_32x32x16_bf16 v[48:63], a[52:55], v[108:111], v[48:63]
    ds_read_b128 v[96:99], v3 offset:16384
    ds_read_b128 v[100:103], v3 offset:49152
    buffer_load_dwordx4 a[88:91], v3, s[32:35], s61 offen offset:2048
    s_waitcnt vmcnt(8) lgkmcnt(4)
    v_mfma_f32_32x32x16_bf16 v[32:47], a[56:59], v[112:115], v[32:47]
    v_mfma_f32_32x32x16_bf16 v[48:63], a[56:59], v[116:119], v[48:63]
    ds_read_b128 v[104:107], v3 offset:17408
    ds_read_b128 v[108:111], v3 offset:50176
    buffer_load_dwordx4 a[92:95], v3, s[32:35], s61 offen offset:3072
    s_waitcnt vmcnt(8) lgkmcnt(4)
    v_mfma_f32_32x32x16_bf16 v[32:47], a[60:63], v[120:123], v[32:47]
    v_mfma_f32_32x32x16_bf16 v[48:63], a[60:63], v[124:127], v[48:63]
    ds_read_b128 v[112:115], v3 offset:18432
    ds_read_b128 v[116:119], v3 offset:51200
    s_add_u32 s61, s52, 24576
    buffer_load_dwordx4 a[96:99], v3, s[32:35], s61 offen offset:0
    s_waitcnt vmcnt(8) lgkmcnt(4)
    v_mfma_f32_32x32x16_bf16 v[32:47], a[64:67], v[96:99], v[32:47]
    v_mfma_f32_32x32x16_bf16 v[48:63], a[64:67], v[100:103], v[48:63]
    ds_read_b128 v[120:123], v3 offset:19456
    ds_read_b128 v[124:127], v3 offset:52224
    buffer_load_dwordx4 a[100:103], v3, s[32:35], s61 offen offset:1024
    s_waitcnt vmcnt(8) lgkmcnt(4)
    v_mfma_f32_32x32x16_bf16 v[32:47], a[68:71], v[104:107], v[32:47]
    v_mfma_f32_32x32x16_bf16 v[48:63], a[68:71], v[108:111], v[48:63]
    ds_read_b128 v[96:99], v3 offset:20480
    ds_read_b128 v[100:103], v3 offset:53248
    buffer_load_dwordx4 a[104:107], v3, s[32:35], s61 offen offset:2048
    s_waitcnt vmcnt(8) lgkmcnt(4)
    v_mfma_f32_32x32x16_bf16 v[32:47], a[72:75], v[112:115], v[32:47]
    v_mfma_f32_32x32x16_bf16 v[48:63], a[72:75], v[116:119], v[48:63]
    ds_read_b128 v[104:107], v3 offset:21504
    ds_read_b128 v[108:111], v3 offset:54272
    buffer_load_dwordx4 a[108:111], v3, s[32:35], s61 offen offset:3072
    s_waitcnt vmcnt(8) lgkmcnt(4)
    v_mfma_f32_32x32x16_bf16 v[32:47], a[76:79], v[120:123], v[32:47]
    v_mfma_f32_32x32x16_bf16 v[48:63], a[76:79], v[124:127], v[48:63]
    ds_read_b128 v[112:115], v3 offset:22528
    ds_read_b128 v[116:119], v3 offset:55296
    s_add_u32 s61, s52, 28672
    buffer_load_dwordx4 a[112:115], v3, s[32:35], s61 offen offset:0
    s_waitcnt vmcnt(8) lgkmcnt(4)
    v_mfma_f32_32x32x16_bf16 v[32:47], a[80:83], v[96:99], v[32:47]
    v_mfma_f32_32x32x16_bf16 v[48:63], a[80:83], v[100:103], v[48:63]
    ds_read_b128 v[120:123], v3 offset:23552
    ds_read_b128 v[124:127], v3 offset:56320
    buffer_load_dwordx4 a[116:119], v3, s[32:35], s61 offen offset:1024
    s_waitcnt vmcnt(8) lgkmcnt(4)
    v_mfma_f32_32x32x16_bf16 v[32:47], a[84:87], v[104:107], v[32:47]
    v_mfma_f32_32x32x16_bf16 v[48:63], a[84:87], v[108:111], v[48:63]
    ds_read_b128 v[96:99], v3 offset:24576
    ds_read_b128 v[100:103], v3 offset:57344
    buffer_load_dwordx4 a[120:123], v3, s[32:35], s61 offen offset:2048
    s_waitcnt vmcnt(8) lgkmcnt(4)
    v_mfma_f32_32x32x16_bf16 v[32:47], a[88:91], v[112:115], v[32:47]
    v_mfma_f32_32x32x16_bf16 v[48:63], a[88:91], v[116:119], v[48:63]
    ds_read_b128 v[104:107], v3 offset:25600
    ds_read_b128 v[108:111], v3 offset:58368
    buffer_load_dwordx4 a[124:127], v3, s[32:35], s61 offen offset:3072
    s_waitcnt vmcnt(8) lgkmcnt(4)
    v_mfma_f32_32x32x16_bf16 v[32:47], a[92:95], v[120:123], v[32:47]
    v_mfma_f32_32x32x16_bf16 v[48:63], a[92:95], v[124:127], v[48:63]
    ds_read_b128 v[112:115], v3 offset:26624
    ds_read_b128 v[116:119], v3 offset:59392
    s_waitcnt vmcnt(7) lgkmcnt(4)
    v_mfma_f32_32x32x16_bf16 v[32:47], a[96:99], v[96:99], v[32:47]
    v_mfma_f32_32x32x16_bf16 v[48:63], a[96:99], v[100:103], v[48:63]
    ds_read_b128 v[120:123], v3 offset:27648
    ds_read_b128 v[124:127], v3 offset:60416
    s_waitcnt vmcnt(6) lgkmcnt(4)
    v_mfma_f32_32x32x16_bf16 v[32:47], a[100:103], v[104:107], v[32:47]
    v_mfma_f32_32x32x16_bf16 v[48:63], a[100:103], v[108:111], v[48:63]
    ds_read_b128 v[96:99], v3 offset:28672
    ds_read_b128 v[100:103], v3 offset:61440
    s_waitcnt vmcnt(5) lgkmcnt(4)
    v_mfma_f32_32x32x16_bf16 v[32:47], a[104:107], v[112:115], v[32:47]
    v_mfma_f32_32x32x16_bf16 v[48:63], a[104:107], v[116:119], v[48:63]
    ds_read_b128 v[104:107], v3 offset:29696
    ds_read_b128 v[108:111], v3 offset:62464
    s_waitcnt vmcnt(4) lgkmcnt(4)
    v_mfma_f32_32x32x16_bf16 v[32:47], a[108:111], v[120:123], v[32:47]
    v_mfma_f32_32x32x16_bf16 v[48:63], a[108:111], v[124:127], v[48:63]
    ds_read_b128 v[112:115], v3 offset:30720
    ds_read_b128 v[116:119], v3 offset:63488
    s_waitcnt vmcnt(3) lgkmcnt(4)
    v_mfma_f32_32x32x16_bf16 v[32:47], a[112:115], v[96:99], v[32:47]
    v_mfma_f32_32x32x16_bf16 v[48:63], a[112:115], v[100:103], v[48:63]
    ds_read_b128 v[120:123], v3 offset:31744
    ds_read_b128 v[124:127], v3 offset:64512
    s_waitcnt vmcnt(2) lgkmcnt(4)
    v_mfma_f32_32x32x16_bf16 v[32:47], a[116:119], v[104:107], v[32:47]
    v_mfma_f32_32x32x16_bf16 v[48:63], a[116:119], v[108:111], v[48:63]
    s_waitcnt vmcnt(1) lgkmcnt(2)
    v_mfma_f32_32x32x16_bf16 v[32:47], a[120:123], v[112:115], v[32:47]
    v_mfma_f32_32x32x16_bf16 v[48:63], a[120:123], v[116:119], v[48:63]
    s_waitcnt vmcnt(0) lgkmcnt(0)
    v_mfma_f32_32x32x16_bf16 v[32:47], a[124:127], v[120:123], v[32:47]
    v_mfma_f32_32x32x16_bf16 v[48:63], a[124:127], v[124:127], v[48:63]
    v_lshlrev_b32 v30, 3, v4
    v_add_u32 v30, 65536, v30
    ds_read_b64 v[28:29], v30
    ds_read_b64 v[30:31], v30 offset:256
    s_waitcnt lgkmcnt(0)
    v_mul_f32 v28, s55, v28
    v_mul_f32 v29, s55, v29
    v_mul_f32 v30, s55, v30
    v_mul_f32 v31, s55, v31
    v_mov_b32 v64, v28
    v_mov_b32 v65, v28
    v_mov_b32 v66, v29
    v_mov_b32 v67, v29
    v_mov_b32 v68, v30
    v_mov_b32 v69, v30
    v_mov_b32 v70, v31
    v_mov_b32 v71, v31
    s_waitcnt vmcnt(24)
    s_nop 7
    v_pk_mul_f32 v[32:33], v[32:33], v[64:65]
    v_pk_mul_f32 v[34:35], v[34:35], v[64:65]
    v_pk_fma_f32 v[32:33], v[8:9], v[66:67], v[32:33]
    v_pk_fma_f32 v[34:35], v[10:11], v[66:67], v[34:35]
    v_cvt_pk_bf16_f32 v72, v32, v33
    v_cvt_pk_bf16_f32 v73, v34, v35
    s_add_u32 s51, s56, 0
    buffer_store_dwordx2 v[72:73], v7, s[36:39], s51 offen
    v_pk_mul_f32 v[36:37], v[36:37], v[64:65]
    v_pk_mul_f32 v[38:39], v[38:39], v[64:65]
    v_pk_fma_f32 v[36:37], v[12:13], v[66:67], v[36:37]
    v_pk_fma_f32 v[38:39], v[14:15], v[66:67], v[38:39]
    v_cvt_pk_bf16_f32 v74, v36, v37
    v_cvt_pk_bf16_f32 v75, v38, v39
    s_add_u32 s51, s56, 512
    buffer_store_dwordx2 v[74:75], v7, s[36:39], s51 offen
    v_pk_mul_f32 v[40:41], v[40:41], v[64:65]
    v_pk_mul_f32 v[42:43], v[42:43], v[64:65]
    v_pk_fma_f32 v[40:41], v[16:17], v[66:67], v[40:41]
    v_pk_fma_f32 v[42:43], v[18:19], v[66:67], v[42:43]
    v_cvt_pk_bf16_f32 v76, v40, v41
    v_cvt_pk_bf16_f32 v77, v42, v43
    s_add_u32 s51, s56, 65536
    buffer_store_dwordx2 v[76:77], v7, s[36:39], s51 offen
    v_pk_mul_f32 v[44:45], v[44:45], v[64:65]
    v_pk_mul_f32 v[46:47], v[46:47], v[64:65]
    v_pk_fma_f32 v[44:45], v[20:21], v[66:67], v[44:45]
    v_pk_fma_f32 v[46:47], v[22:23], v[66:67], v[46:47]
    v_cvt_pk_bf16_f32 v78, v44, v45
    v_cvt_pk_bf16_f32 v79, v46, v47
    s_add_u32 s51, s56, 66048
    buffer_store_dwordx2 v[78:79], v7, s[36:39], s51 offen
    v_pk_mul_f32 v[48:49], v[48:49], v[68:69]
    v_pk_mul_f32 v[50:51], v[50:51], v[68:69]
    v_pk_fma_f32 v[48:49], v[8:9], v[70:71], v[48:49]
    v_pk_fma_f32 v[50:51], v[10:11], v[70:71], v[50:51]
    v_cvt_pk_bf16_f32 v72, v48, v49
    v_cvt_pk_bf16_f32 v73, v50, v51
    s_add_u32 s51, s56, 1024
    buffer_store_dwordx2 v[72:73], v7, s[36:39], s51 offen
    v_pk_mul_f32 v[52:53], v[52:53], v[68:69]
    v_pk_mul_f32 v[54:55], v[54:55], v[68:69]
    v_pk_fma_f32 v[52:53], v[12:13], v[70:71], v[52:53]
    v_pk_fma_f32 v[54:55], v[14:15], v[70:71], v[54:55]
    v_cvt_pk_bf16_f32 v74, v52, v53
    v_cvt_pk_bf16_f32 v75, v54, v55
    s_add_u32 s51, s56, 1536
    buffer_store_dwordx2 v[74:75], v7, s[36:39], s51 offen
    v_pk_mul_f32 v[56:57], v[56:57], v[68:69]
    v_pk_mul_f32 v[58:59], v[58:59], v[68:69]
    v_pk_fma_f32 v[56:57], v[16:17], v[70:71], v[56:57]
    v_pk_fma_f32 v[58:59], v[18:19], v[70:71], v[58:59]
    v_cvt_pk_bf16_f32 v76, v56, v57
    v_cvt_pk_bf16_f32 v77, v58, v59
    s_add_u32 s51, s56, 66560
    buffer_store_dwordx2 v[76:77], v7, s[36:39], s51 offen
    v_pk_mul_f32 v[60:61], v[60:61], v[68:69]
    v_pk_mul_f32 v[62:63], v[62:63], v[68:69]
    v_pk_fma_f32 v[60:61], v[20:21], v[70:71], v[60:61]
    v_pk_fma_f32 v[62:63], v[22:23], v[70:71], v[62:63]
    v_cvt_pk_bf16_f32 v78, v60, v61
    v_cvt_pk_bf16_f32 v79, v62, v63
    s_add_u32 s51, s56, 67072
    buffer_store_dwordx2 v[78:79], v7, s[36:39], s51 offen
    s_endpgm
L_qkv2_kernel_vpath_1:
    v_lshlrev_b32 v6, 2, v4
    s_lshl_b32 s51, s57, 2
    buffer_load_dword v8, v6, s[64:67], s51 offen
    s_add_u32 s36, s24, 0x00400000
    s_addc_u32 s37, s25, 0
    s_and_b32 s37, s37, 0xffff
    s_mov_b32 s38, 0x00200000
    s_mov_b32 s39, 0x00020000
    s_sub_u32 s51, s58, 32
    s_lshl_b32 s56, s51, 17
    s_lshl_b32 s51, s48, 11
    s_add_u32 s56, s56, s51
    v_bfe_u32 v7, v1, 4, 1
    v_lshlrev_b32 v7, 16, v7
    v_lshl_add_u32 v7, v5, 8, v7
    v_and_b32 v6, 15, v1
    v_lshl_add_u32 v7, v6, 4, v7
    s_cmp_ge_u32 s50, 4
    s_cbranch_scc1 L_qkv2_kernel_prio_3
    s_setprio 2
L_qkv2_kernel_prio_3:
    s_waitcnt vmcnt(11)
    s_barrier
    ds_read_b128 v[96:99], v3 offset:0
    ds_read_b128 v[100:103], v3 offset:32768
    ds_read_b128 v[104:107], v3 offset:1024
    ds_read_b128 v[108:111], v3 offset:33792
    ds_read_b128 v[112:115], v3 offset:2048
    ds_read_b128 v[116:119], v3 offset:34816
    s_add_u32 s61, s52, 8192
    buffer_load_dwordx4 a[32:35], v3, s[32:35], s61 offen offset:0
    s_waitcnt vmcnt(11) lgkmcnt(4)
    v_mfma_f32_32x32x16_bf16 v[32:47], v[96:99], a[0:3], v[32:47]
    v_mfma_f32_32x32x16_bf16 v[48:63], v[100:103], a[0:3], v[48:63]
    ds_read_b128 v[120:123], v3 offset:3072
    ds_read_b128 v[124:127], v3 offset:35840
    buffer_load_dwordx4 a[36:39], v3, s[32:35], s61 offen offset:1024
    s_waitcnt vmcnt(11) lgkmcnt(4)
    v_mfma_f32_32x32x16_bf16 v[32:47], v[104:107], a[4:7], v[32:47]
    v_mfma_f32_32x32x16_bf16 v[48:63], v[108:111], a[4:7], v[48:63]
    ds_read_b128 v[96:99], v3 offset:4096
    ds_read_b128 v[100:103], v3 offset:36864
    buffer_load_dwordx4 a[40:43], v3, s[32:35], s61 offen offset:2048
    s_waitcnt vmcnt(11) lgkmcnt(4)
    v_mfma_f32_32x32x16_bf16 v[32:47], v[112:115], a[8:11], v[32:47]
    v_mfma_f32_32x32x16_bf16 v[48:63], v[116:119], a[8:11], v[48:63]
    ds_read_b128 v[104:107], v3 offset:5120
    ds_read_b128 v[108:111], v3 offset:37888
    buffer_load_dwordx4 a[44:47], v3, s[32:35], s61 offen offset:3072
    s_waitcnt vmcnt(11) lgkmcnt(4)
    v_mfma_f32_32x32x16_bf16 v[32:47], v[120:123], a[12:15], v[32:47]
    v_mfma_f32_32x32x16_bf16 v[48:63], v[124:127], a[12:15], v[48:63]
    ds_read_b128 v[112:115], v3 offset:6144
    ds_read_b128 v[116:119], v3 offset:38912
    s_add_u32 s61, s52, 12288
    buffer_load_dwordx4 a[48:51], v3, s[32:35], s61 offen offset:0
    s_waitcnt vmcnt(11) lgkmcnt(4)
    v_mfma_f32_32x32x16_bf16 v[32:47], v[96:99], a[16:19], v[32:47]
    v_mfma_f32_32x32x16_bf16 v[48:63], v[100:103], a[16:19], v[48:63]
    ds_read_b128 v[120:123], v3 offset:7168
    ds_read_b128 v[124:127], v3 offset:39936
    buffer_load_dwordx4 a[52:55], v3, s[32:35], s61 offen offset:1024
    s_waitcnt vmcnt(11) lgkmcnt(4)
    v_mfma_f32_32x32x16_bf16 v[32:47], v[104:107], a[20:23], v[32:47]
    v_mfma_f32_32x32x16_bf16 v[48:63], v[108:111], a[20:23], v[48:63]
    ds_read_b128 v[96:99], v3 offset:8192
    ds_read_b128 v[100:103], v3 offset:40960
    buffer_load_dwordx4 a[56:59], v3, s[32:35], s61 offen offset:2048
    s_waitcnt vmcnt(8)
    v_pk_add_f32 v[64:65], v[64:65], v[66:67]
    v_pk_add_f32 v[68:69], v[68:69], v[70:71]
    v_pk_add_f32 v[24:25], v[64:65], v[68:69]
    s_nop 1
    v_add_f32_dpp v24, v24, v24 quad_perm:[1,0,3,2] row_mask:0xf bank_mask:0xf
    v_add_f32_dpp v25, v25, v25 quad_perm:[1,0,3,2] row_mask:0xf bank_mask:0xf
    s_nop 1
    v_add_f32_dpp v24, v24, v24 quad_perm:[2,3,0,1] row_mask:0xf bank_mask:0xf
    v_add_f32_dpp v25, v25, v25 quad_perm:[2,3,0,1] row_mask:0xf bank_mask:0xf
    s_nop 1
    v_add_f32_dpp v24, v24, v24 row_half_mirror row_mask:0xf bank_mask:0xf
    v_add_f32_dpp v25, v25, v25 row_half_mirror row_mask:0xf bank_mask:0xf
    v_mul_f32 v29, 0x3b000000, v24
    v_mul_f32 v28, 0x3b000000, v25
    v_fma_f32 v28, -v29, v29, v28
    v_max_f32 v28, 0, v28
    v_cvt_pk_bf16_f32 v30, v29, v28
    v_lshlrev_b32 v29, 16, v30
    v_and_b32 v28, 0xffff0000, v30
    v_add_f32 v28, 0x3727c5ac, v28
    v_cvt_pk_bf16_f32 v30, v28, v28
    v_and_b32 v28, 0xffff0000, v30
    v_sqrt_f32 v28, v28
    s_nop 0
    v_cvt_pk_bf16_f32 v30, v28, v28
    v_and_b32 v28, 0xffff0000, v30
    v_rcp_f32 v28, v28
    s_nop 0
    v_mul_f32 v29, v29, v28
    v_sub_f32 v29, 0, v29
    v_lshrrev_b32 v30, 3, v1
    v_lshlrev_b32 v30, 3, v30
    s_lshl_b32 s59, s50, 6
    s_add_u32 s59, s59, 65536
    v_add_u32 v30, s59, v30
    ds_write_b64 v30, v[28:29]
    s_waitcnt lgkmcnt(0)
    s_waitcnt vmcnt(11) lgkmcnt(4)
    v_mfma_f32_32x32x16_bf16 v[32:47], v[112:115], a[24:27], v[32:47]
    v_mfma_f32_32x32x16_bf16 v[48:63], v[116:119], a[24:27], v[48:63]
    ds_read_b128 v[104:107], v3 offset:9216
    ds_read_b128 v[108:111], v3 offset:41984
    buffer_load_dwordx4 a[60:63], v3, s[32:35], s61 offen offset:3072
    s_waitcnt vmcnt(11) lgkmcnt(4)
    v_mfma_f32_32x32x16_bf16 v[32:47], v[120:123], a[28:31], v[32:47]
    v_mfma_f32_32x32x16_bf16 v[48:63], v[124:127], a[28:31], v[48:63]
    ds_read_b128 v[112:115], v3 offset:10240
    ds_read_b128 v[116:119], v3 offset:43008
    s_add_u32 s61, s52, 16384
    buffer_load_dwordx4 a[64:67], v3, s[32:35], s61 offen offset:0
    s_barrier
    s_waitcnt vmcnt(8) lgkmcnt(4)
    v_mfma_f32_32x32x16_bf16 v[32:47], v[96:99], a[32:35], v[32:47]
    v_mfma_f32_32x32x16_bf16 v[48:63], v[100:103], a[32:35], v[48:63]
    ds_read_b128 v[120:123], v3 offset:11264
    ds_read_b128 v[124:127], v3 offset:44032
    buffer_load_dwordx4 a[68:71], v3, s[32:35], s61 offen offset:1024
    s_waitcnt vmcnt(8) lgkmcnt(4)
    v_mfma_f32_32x32x16_bf16 v[32:47], v[104:107], a[36:39], v[32:47]
    v_mfma_f32_32x32x16_bf16 v[48:63], v[108:111], a[36:39], v[48:63]
    ds_read_b128 v[96:99], v3 offset:12288
    ds_read_b128 v[100:103], v3 offset:45056
    buffer_load_dwordx4 a[72:75], v3, s[32:35], s61 offen offset:2048
    s_waitcnt vmcnt(8) lgkmcnt(4)
    v_mfma_f32_32x32x16_bf16 v[32:47], v[112:115], a[40:43], v[32:47]
    v_mfma_f32_32x32x16_bf16 v[48:63], v[116:119], a[40:43], v[48:63]
    ds_read_b128 v[104:107], v3 offset:13312
    ds_read_b128 v[108:111], v3 offset:46080
    buffer_load_dwordx4 a[76:79], v3, s[32:35], s61 offen offset:3072
    s_waitcnt vmcnt(8) lgkmcnt(4)
    v_mfma_f32_32x32x16_bf16 v[32:47], v[120:123], a[44:47], v[32:47]
    v_mfma_f32_32x32x16_bf16 v[48:63], v[124:127], a[44:47], v[48:63]
    ds_read_b128 v[112:115], v3 offset:14336
    ds_read_b128 v[116:119], v3 offset:47104
    s_add_u32 s61, s52, 20480
    buffer_load_dwordx4 a[80:83], v3, s[32:35], s61 offen offset:0
    s_waitcnt vmcnt(8) lgkmcnt(4)
    v_mfma_f32_32x32x16_bf16 v[32:47], v[96:99], a[48:51], v[32:47]
    v_mfma_f32_32x32x16_bf16 v[48:63], v[100:103], a[48:51], v[48:63]
    ds_read_b128 v[120:123], v3 offset:15360
    ds_read_b128 v[124:127], v3 offset:48128
    buffer_load_dwordx4 a[84:87], v3, s[32:35], s61 offen offset:1024
    s_waitcnt vmcnt(8) lgkmcnt(4)
    v_mfma_f32_32x32x16_bf16 v[32:47], v[104:107], a[52:55], v[32:47]
    v_mfma_f32_32x32x16_bf16 v[48:63], v[108:111], a[52:55], v[48:63]
    ds_read_b128 v[96:99], v3 offset:16384
    ds_read_b128 v[100:103], v3 offset:49152
    buffer_load_dwordx4 a[88:91], v3, s[32:35], s61 offen offset:2048
    s_waitcnt vmcnt(8) lgkmcnt(4)
    v_mfma_f32_32x32x16_bf16 v[32:47], v[112:115], a[56:59], v[32:47]
    v_mfma_f32_32x32x16_bf16 v[48:63], v[116:119], a[56:59], v[48:63]
    ds_read_b128 v[104:107], v3 offset:17408
    ds_read_b128 v[108:111], v3 offset:50176
    buffer_load_dwordx4 a[92:95], v3, s[32:35], s61 offen offset:3072
    s_waitcnt vmcnt(8) lgkmcnt(4)
    v_mfma_f32_32x32x16_bf16 v[32:47], v[120:123], a[60:63], v[32:47]
    v_mfma_f32_32x32x16_bf16 v[48:63], v[124:127], a[60:63], v[48:63]
    ds_read_b128 v[112:115], v3 offset:18432
    ds_read_b128 v[116:119], v3 offset:51200
    s_add_u32 s61, s52, 24576
    buffer_load_dwordx4 a[96:99], v3, s[32:35], s61 offen offset:0
    s_waitcnt vmcnt(8) lgkmcnt(4)
    v_mfma_f32_32x32x16_bf16 v[32:47], v[96:99], a[64:67], v[32:47]
    v_mfma_f32_32x32x16_bf16 v[48:63], v[100:103], a[64:67], v[48:63]
    ds_read_b128 v[120:123], v3 offset:19456
    ds_read_b128 v[124:127], v3 offset:52224
    buffer_load_dwordx4 a[100:103], v3, s[32:35], s61 offen offset:1024
    s_waitcnt vmcnt(8) lgkmcnt(4)
    v_mfma_f32_32x32x16_bf16 v[32:47], v[104:107], a[68:71], v[32:47]
    v_mfma_f32_32x32x16_bf16 v[48:63], v[108:111], a[68:71], v[48:63]
    ds_read_b128 v[96:99], v3 offset:20480
    ds_read_b128 v[100:103], v3 offset:53248
    buffer_load_dwordx4 a[104:107], v3, s[32:35], s61 offen offset:2048
    s_waitcnt vmcnt(8) lgkmcnt(4)
    v_mfma_f32_32x32x16_bf16 v[32:47], v[112:115], a[72:75], v[32:47]
    v_mfma_f32_32x32x16_bf16 v[48:63], v[116:119], a[72:75], v[48:63]
    ds_read_b128 v[104:107], v3 offset:21504
    ds_read_b128 v[108:111], v3 offset:54272
    buffer_load_dwordx4 a[108:111], v3, s[32:35], s61 offen offset:3072
    s_waitcnt vmcnt(8) lgkmcnt(4)
    v_mfma_f32_32x32x16_bf16 v[32:47], v[120:123], a[76:79], v[32:47]
    v_mfma_f32_32x32x16_bf16 v[48:63], v[124:127], a[76:79], v[48:63]
    ds_read_b128 v[112:115], v3 offset:22528
    ds_read_b128 v[116:119], v3 offset:55296
    s_add_u32 s61, s52, 28672
    buffer_load_dwordx4 a[112:115], v3, s[32:35], s61 offen offset:0
    s_waitcnt vmcnt(8) lgkmcnt(4)
    v_mfma_f32_32x32x16_bf16 v[32:47], v[96:99], a[80:83], v[32:47]
    v_mfma_f32_32x32x16_bf16 v[48:63], v[100:103], a[80:83], v[48:63]
    ds_read_b128 v[120:123], v3 offset:23552
    ds_read_b128 v[124:127], v3 offset:56320
    buffer_load_dwordx4 a[116:119], v3, s[32:35], s61 offen offset:1024
    s_waitcnt vmcnt(8) lgkmcnt(4)
    v_mfma_f32_32x32x16_bf16 v[32:47], v[104:107], a[84:87], v[32:47]
    v_mfma_f32_32x32x16_bf16 v[48:63], v[108:111], a[84:87], v[48:63]
    ds_read_b128 v[96:99], v3 offset:24576
    ds_read_b128 v[100:103], v3 offset:57344
    buffer_load_dwordx4 a[120:123], v3, s[32:35], s61 offen offset:2048
    s_waitcnt vmcnt(8) lgkmcnt(4)
    v_mfma_f32_32x32x16_bf16 v[32:47], v[112:115], a[88:91], v[32:47]
    v_mfma_f32_32x32x16_bf16 v[48:63], v[116:119], a[88:91], v[48:63]
    ds_read_b128 v[104:107], v3 offset:25600
    ds_read_b128 v[108:111], v3 offset:58368
    buffer_load_dwordx4 a[124:127], v3, s[32:35], s61 offen offset:3072
    s_waitcnt vmcnt(8) lgkmcnt(4)
    v_mfma_f32_32x32x16_bf16 v[32:47], v[120:123], a[92:95], v[32:47]
    v_mfma_f32_32x32x16_bf16 v[48:63], v[124:127], a[92:95], v[48:63]
    ds_read_b128 v[112:115], v3 offset:26624
    ds_read_b128 v[116:119], v3 offset:59392
    s_waitcnt vmcnt(7) lgkmcnt(4)
    v_mfma_f32_32x32x16_bf16 v[32:47], v[96:99], a[96:99], v[32:47]
    v_mfma_f32_32x32x16_bf16 v[48:63], v[100:103], a[96:99], v[48:63]
    ds_read_b128 v[120:123], v3 offset:27648
    ds_read_b128 v[124:127], v3 offset:60416
    s_waitcnt vmcnt(6) lgkmcnt(4)
    v_mfma_f32_32x32x16_bf16 v[32:47], v[104:107], a[100:103], v[32:47]
    v_mfma_f32_32x32x16_bf16 v[48:63], v[108:111], a[100:103], v[48:63]
    ds_read_b128 v[96:99], v3 offset:28672
    ds_read_b128 v[100:103], v3 offset:61440
    s_waitcnt vmcnt(5) lgkmcnt(4)
    v_mfma_f32_32x32x16_bf16 v[32:47], v[112:115], a[104:107], v[32:47]
    v_mfma_f32_32x32x16_bf16 v[48:63], v[116:119], a[104:107], v[48:63]
    ds_read_b128 v[104:107], v3 offset:29696
    ds_read_b128 v[108:111], v3 offset:62464
    s_waitcnt vmcnt(4) lgkmcnt(4)
    v_mfma_f32_32x32x16_bf16 v[32:47], v[120:123], a[108:111], v[32:47]
    v_mfma_f32_32x32x16_bf16 v[48:63], v[124:127], a[108:111], v[48:63]
    ds_read_b128 v[112:115], v3 offset:30720
    ds_read_b128 v[116:119], v3 offset:63488
    s_waitcnt vmcnt(3) lgkmcnt(4)
    v_mfma_f32_32x32x16_bf16 v[32:47], v[96:99], a[112:115], v[32:47]
    v_mfma_f32_32x32x16_bf16 v[48:63], v[100:103], a[112:115], v[48:63]
    ds_read_b128 v[120:123], v3 offset:31744
    ds_read_b128 v[124:127], v3 offset:64512
    s_waitcnt vmcnt(2) lgkmcnt(4)
    v_mfma_f32_32x32x16_bf16 v[32:47], v[104:107], a[116:119], v[32:47]
    v_mfma_f32_32x32x16_bf16 v[48:63], v[108:111], a[116:119], v[48:63]
    s_waitcnt vmcnt(1) lgkmcnt(2)
    v_mfma_f32_32x32x16_bf16 v[32:47], v[112:115], a[120:123], v[32:47]
    v_mfma_f32_32x32x16_bf16 v[48:63], v[116:119], a[120:123], v[48:63]
    s_waitcnt vmcnt(0) lgkmcnt(0)
    v_mfma_f32_32x32x16_bf16 v[32:47], v[120:123], a[124:127], v[32:47]
    v_mfma_f32_32x32x16_bf16 v[48:63], v[124:127], a[124:127], v[48:63]
    v_lshlrev_b32 v30, 5, v5
    v_add_u32 v30, 65536, v30
    ds_read_b128 v[64:67], v30 offset:0
    ds_read_b128 v[68:71], v30 offset:16
    ds_read_b128 v[72:75], v30 offset:64
    ds_read_b128 v[76:79], v30 offset:80
    ds_read_b128 v[80:83], v30 offset:128
    ds_read_b128 v[84:87], v30 offset:144
    ds_read_b128 v[88:91], v30 offset:192
    ds_read_b128 v[92:95], v30 offset:208
    ds_read_b128 v[96:99], v30 offset:256
    ds_read_b128 v[100:103], v30 offset:272
    ds_read_b128 v[104:107], v30 offset:320
    ds_read_b128 v[108:111], v30 offset:336
    ds_read_b128 v[112:115], v30 offset:384
    ds_read_b128 v[116:119], v30 offset:400
    ds_read_b128 v[120:123], v30 offset:448
    ds_read_b128 v[124:127], v30 offset:464
    s_waitcnt lgkmcnt(0)
    s_waitcnt vmcnt(24)
    v_mul_f32 v32, v32, v64
    v_fma_f32 v32, v65, v8, v32
    v_mul_f32 v33, v33, v66
    v_fma_f32 v33, v67, v8, v33
    v_mul_f32 v34, v34, v68
    v_fma_f32 v34, v69, v8, v34
    v_mul_f32 v35, v35, v70
    v_fma_f32 v35, v71, v8, v35
    v_mul_f32 v36, v36, v72
    v_fma_f32 v36, v73, v8, v36
    v_mul_f32 v37, v37, v74
    v_fma_f32 v37, v75, v8, v37
    v_mul_f32 v38, v38, v76
    v_fma_f32 v38, v77, v8, v38
    v_mul_f32 v39, v39, v78
    v_fma_f32 v39, v79, v8, v39
    v_mul_f32 v40, v40, v80
    v_fma_f32 v40, v81, v8, v40
    v_mul_f32 v41, v41, v82
    v_fma_f32 v41, v83, v8, v41
    v_mul_f32 v42, v42, v84
    v_fma_f32 v42, v85, v8, v42
    v_mul_f32 v43, v43, v86
    v_fma_f32 v43, v87, v8, v43
    v_mul_f32 v44, v44, v88
    v_fma_f32 v44, v89, v8, v44
    v_mul_f32 v45, v45, v90
    v_fma_f32 v45, v91, v8, v45
    v_mul_f32 v46, v46, v92
    v_fma_f32 v46, v93, v8, v46
    v_mul_f32 v47, v47, v94
    v_fma_f32 v47, v95, v8, v47
    v_cvt_pk_bf16_f32 v12, v32, v33
    v_cvt_pk_bf16_f32 v13, v34, v35
    v_cvt_pk_bf16_f32 v14, v36, v37
    v_cvt_pk_bf16_f32 v15, v38, v39
    s_add_u32 s51, s56, 0
    buffer_store_dwordx4 v[12:15], v7, s[36:39], s51 offen
    s_nop 1
    v_cvt_pk_bf16_f32 v16, v40, v41
    v_cvt_pk_bf16_f32 v17, v42, v43
    v_cvt_pk_bf16_f32 v18, v44, v45
    v_cvt_pk_bf16_f32 v19, v46, v47
    s_add_u32 s51, s56, 512
    buffer_store_dwordx4 v[16:19], v7, s[36:39], s51 offen
    s_nop 1
    v_mul_f32 v48, v48, v96
    v_fma_f32 v48, v97, v8, v48
    v_mul_f32 v49, v49, v98
    v_fma_f32 v49, v99, v8, v49
    v_mul_f32 v50, v50, v100
    v_fma_f32 v50, v101, v8, v50
    v_mul_f32 v51, v51, v102
    v_fma_f32 v51, v103, v8, v51
    v_mul_f32 v52, v52, v104
    v_fma_f32 v52, v105, v8, v52
    v_mul_f32 v53, v53, v106
    v_fma_f32 v53, v107, v8, v53
    v_mul_f32 v54, v54, v108
    v_fma_f32 v54, v109, v8, v54
    v_mul_f32 v55, v55, v110
    v_fma_f32 v55, v111, v8, v55
    v_mul_f32 v56, v56, v112
    v_fma_f32 v56, v113, v8, v56
    v_mul_f32 v57, v57, v114
    v_fma_f32 v57, v115, v8, v57
    v_mul_f32 v58, v58, v116
    v_fma_f32 v58, v117, v8, v58
    v_mul_f32 v59, v59, v118
    v_fma_f32 v59, v119, v8, v59
    v_mul_f32 v60, v60, v120
    v_fma_f32 v60, v121, v8, v60
    v_mul_f32 v61, v61, v122
    v_fma_f32 v61, v123, v8, v61
    v_mul_f32 v62, v62, v124
    v_fma_f32 v62, v125, v8, v62
    v_mul_f32 v63, v63, v126
    v_fma_f32 v63, v127, v8, v63
    v_cvt_pk_bf16_f32 v12, v48, v49
    v_cvt_pk_bf16_f32 v13, v50, v51
    v_cvt_pk_bf16_f32 v14, v52, v53
    v_cvt_pk_bf16_f32 v15, v54, v55
    s_add_u32 s51, s56, 1024
    buffer_store_dwordx4 v[12:15], v7, s[36:39], s51 offen
    s_nop 1
    v_cvt_pk_bf16_f32 v16, v56, v57
    v_cvt_pk_bf16_f32 v17, v58, v59
    v_cvt_pk_bf16_f32 v18, v60, v61
    v_cvt_pk_bf16_f32 v19, v62, v63
    s_add_u32 s51, s56, 1536
    buffer_store_dwordx4 v[16:19], v7, s[36:39], s51 offen
    s_nop 1
L_qkv2_kernel_end:
    s_endpgm
.globl wo2_kernel
.p2align 8
.type wo2_kernel,@function
wo2_kernel:
    s_cmp_ge_u32 s2, 256
    s_cbranch_scc1 L_wo2_kernel_end
    s_load_dwordx16 s[4:19], s[0:1], 0
    s_load_dwordx4 s[20:23], s[0:1], 64
    s_load_dwordx2 s[24:25], s[0:1], 80
    s_and_b32 s51, s2, 7
    s_lshl_b32 s48, s51, 2
    s_lshr_b32 s51, s2, 6
    s_add_u32 s48, s48, s51
    s_lshr_b32 s49, s2, 3
    s_and_b32 s49, s49, 7
    v_lshrrev_b32 v2, 6, v0
    v_and_b32 v1, 63, v0
    v_lshlrev_b32 v3, 4, v1
    v_readfirstlane_b32 s50, v2
    s_waitcnt lgkmcnt(0)
    s_add_u32 s28, s24, 0x00600000
    s_addc_u32 s29, s25, 0
    s_and_b32 s29, s29, 0xffff
    s_mov_b32 s30, 0x00200000
    s_mov_b32 s31, 0x00020000
    s_add_u32 s32, s24, 0x01800000
    s_addc_u32 s33, s25, 0
    s_and_b32 s33, s33, 0xffff
    s_mov_b32 s34, 0x00080000
    s_mov_b32 s35, 0x00020000
    s_add_u32 s36, s24, 0x01200000
    s_addc_u32 s37, s25, 0
    s_and_b32 s37, s37, 0xffff
    s_mov_b32 s38, 0x00200000
    s_mov_b32 s39, 0x00020000
    s_add_u32 s40, s24, 0x01400000
    s_addc_u32 s41, s25, 0
    s_and_b32 s41, s41, 0xffff
    s_mov_b32 s42, 0x00200000
    s_mov_b32 s43, 0x00020000
    s_add_u32 s56, s24, 0x02300000
    s_addc_u32 s57, s25, 0
    s_and_b32 s57, s57, 0xffff
    s_mov_b32 s58, 0x00080000
    s_mov_b32 s59, 0x00020000
    s_mul_i32 s51, s50, 8192
    s_mul_i32 s53, s48, 65536
    s_add_u32 s53, s53, s51
    s_mul_i32 s54, s49, 65536
    s_add_u32 s54, s54, s51
    v_lshrrev_b32 v15, 5, v1
    v_and_b32 v14, 31, v1
    v_lshlrev_b32 v16, 4, v14
    v_lshl_add_u32 v16, v15, 3, v16
    s_lshr_b32 s51, s50, 1
    s_lshl_b32 s52, s48, 1
    s_add_u32 s51, s51, s52
    s_lshl_b32 s55, s51, 15
    s_lshl_b32 s52, s49, 12
    s_add_u32 s55, s55, s52
    s_and_b32 s52, s50, 1
    s_lshl_b32 s52, s52, 11
    s_add_u32 s55, s55, s52
    s_add_u32 s51, s53, 0
    buffer_load_dwordx4 a[0:3], v3, s[28:31], s51 offen
    s_add_u32 s51, s53, 32768
    buffer_load_dwordx4 a[4:7], v3, s[28:31], s51 offen
    s_add_u32 s51, s54, 0
    buffer_load_dwordx4 a[8:11], v3, s[32:35], s51 offen
    s_add_u32 s51, s54, 32768
    buffer_load_dwordx4 a[12:15], v3, s[32:35], s51 offen
    s_add_u32 s51, s53, 1024
    buffer_load_dwordx4 a[16:19], v3, s[28:31], s51 offen
    s_add_u32 s51, s53, 33792
    buffer_load_dwordx4 a[20:23], v3, s[28:31], s51 offen
    s_add_u32 s51, s54, 1024
    buffer_load_dwordx4 a[24:27], v3, s[32:35], s51 offen
    s_add_u32 s51, s54, 33792
    buffer_load_dwordx4 a[28:31], v3, s[32:35], s51 offen
    s_add_u32 s51, s53, 2048
    buffer_load_dwordx4 a[32:35], v3, s[28:31], s51 offen
    s_add_u32 s51, s53, 34816
    buffer_load_dwordx4 a[36:39], v3, s[28:31], s51 offen
    s_add_u32 s51, s54, 2048
    buffer_load_dwordx4 a[40:43], v3, s[32:35], s51 offen
    s_add_u32 s51, s54, 34816
    buffer_load_dwordx4 a[44:47], v3, s[32:35], s51 offen
    s_add_u32 s51, s53, 3072
    buffer_load_dwordx4 a[48:51], v3, s[28:31], s51 offen
    s_add_u32 s51, s53, 35840
    buffer_load_dwordx4 a[52:55], v3, s[28:31], s51 offen
    s_add_u32 s51, s54, 3072
    buffer_load_dwordx4 a[56:59], v3, s[32:35], s51 offen
    s_add_u32 s51, s54, 35840
    buffer_load_dwordx4 a[60:63], v3, s[32:35], s51 offen
    s_add_u32 s51, s53, 4096
    buffer_load_dwordx4 a[64:67], v3, s[28:31], s51 offen
    s_add_u32 s51, s53, 36864
    buffer_load_dwordx4 a[68:71], v3, s[28:31], s51 offen
    s_add_u32 s51, s54, 4096
    buffer_load_dwordx4 a[72:75], v3, s[32:35], s51 offen
    s_add_u32 s51, s54, 36864
    buffer_load_dwordx4 a[76:79], v3, s[32:35], s51 offen
    s_add_u32 s51, s53, 5120
    buffer_load_dwordx4 a[80:83], v3, s[28:31], s51 offen
    s_add_u32 s51, s53, 37888
    buffer_load_dwordx4 a[84:87], v3, s[28:31], s51 offen
    s_add_u32 s51, s54, 5120
    buffer_load_dwordx4 a[88:91], v3, s[32:35], s51 offen
    s_add_u32 s51, s54, 37888
    buffer_load_dwordx4 a[92:95], v3, s[32:35], s51 offen
    buffer_load_dwordx2 v[40:41], v16, s[36:39], s55 offen offset:0
    buffer_load_dwordx2 v[42:43], v16, s[36:39], s55 offen offset:512
    buffer_load_dwordx2 v[44:45], v16, s[36:39], s55 offen offset:1024
    buffer_load_dwordx2 v[46:47], v16, s[36:39], s55 offen offset:1536
    v_mov_b32 v64, 0
    v_mov_b32 v65, 0
    v_mov_b32 v66, 0
    v_mov_b32 v67, 0
    v_mov_b32 v68, 0
    v_mov_b32 v69, 0
    v_mov_b32 v70, 0
    v_mov_b32 v71, 0
    v_mov_b32 v72, 0
    v_mov_b32 v73, 0
    v_mov_b32 v74, 0
    v_mov_b32 v75, 0
    v_mov_b32 v76, 0
    v_mov_b32 v77, 0
    v_mov_b32 v78, 0
    v_mov_b32 v79, 0
    v_mov_b32 v80, 0
    v_mov_b32 v81, 0
    v_mov_b32 v82, 0
    v_mov_b32 v83, 0
    v_mov_b32 v84, 0
    v_mov_b32 v85, 0
    v_mov_b32 v86, 0
    v_mov_b32 v87, 0
    v_mov_b32 v88, 0
    v_mov_b32 v89, 0
    v_mov_b32 v90, 0
    v_mov_b32 v91, 0
    v_mov_b32 v92, 0
    v_mov_b32 v93, 0
    v_mov_b32 v94, 0
    v_mov_b32 v95, 0
    v_mov_b32 v96, 0
    v_mov_b32 v97, 0
    v_mov_b32 v98, 0
    v_mov_b32 v99, 0
    v_mov_b32 v100, 0
    v_mov_b32 v101, 0
    v_mov_b32 v102, 0
    v_mov_b32 v103, 0
    v_mov_b32 v104, 0
    v_mov_b32 v105, 0
    v_mov_b32 v106, 0
    v_mov_b32 v107, 0
    v_mov_b32 v108, 0
    v_mov_b32 v109, 0
    v_mov_b32 v110, 0
    v_mov_b32 v111, 0
    v_mov_b32 v112, 0
    v_mov_b32 v113, 0
    v_mov_b32 v114, 0
    v_mov_b32 v115, 0
    v_mov_b32 v116, 0
    v_mov_b32 v117, 0
    v_mov_b32 v118, 0
    v_mov_b32 v119, 0
    v_mov_b32 v120, 0
    v_mov_b32 v121, 0
    v_mov_b32 v122, 0
    v_mov_b32 v123, 0
    v_mov_b32 v124, 0
    v_mov_b32 v125, 0
    v_mov_b32 v126, 0
    v_mov_b32 v127, 0
    s_waitcnt vmcnt(24)
    v_mfma_f32_32x32x16_bf16 v[64:79], a[8:11], a[0:3], v[64:79]
    v_mfma_f32_32x32x16_bf16 v[80:95], a[12:15], a[0:3], v[80:95]
    v_mfma_f32_32x32x16_bf16 v[96:111], a[8:11], a[4:7], v[96:111]
    v_mfma_f32_32x32x16_bf16 v[112:127], a[12:15], a[4:7], v[112:127]
    s_add_u32 s51, s53, 6144
    buffer_load_dwordx4 a[96:99], v3, s[28:31], s51 offen
    s_add_u32 s51, s53, 38912
    buffer_load_dwordx4 a[100:103], v3, s[28:31], s51 offen
    s_add_u32 s51, s54, 6144
    buffer_load_dwordx4 a[104:107], v3, s[32:35], s51 offen
    s_add_u32 s51, s54, 38912
    buffer_load_dwordx4 a[108:111], v3, s[32:35], s51 offen
    s_waitcnt vmcnt(24)
    v_mfma_f32_32x32x16_bf16 v[64:79], a[24:27], a[16:19], v[64:79]
    v_mfma_f32_32x32x16_bf16 v[80:95], a[28:31], a[16:19], v[80:95]
    v_mfma_f32_32x32x16_bf16 v[96:111], a[24:27], a[20:23], v[96:111]
    v_mfma_f32_32x32x16_bf16 v[112:127], a[28:31], a[20:23], v[112:127]
    s_add_u32 s51, s53, 7168
    buffer_load_dwordx4 a[112:115], v3, s[28:31], s51 offen
    s_add_u32 s51, s53, 39936
    buffer_load_dwordx4 a[116:119], v3, s[28:31], s51 offen
    s_add_u32 s51, s54, 7168
    buffer_load_dwordx4 a[120:123], v3, s[32:35], s51 offen
    s_add_u32 s51, s54, 39936
    buffer_load_dwordx4 a[124:127], v3, s[32:35], s51 offen
    s_waitcnt vmcnt(24)
    v_mfma_f32_32x32x16_bf16 v[64:79], a[40:43], a[32:35], v[64:79]
    v_mfma_f32_32x32x16_bf16 v[80:95], a[44:47], a[32:35], v[80:95]
    v_mfma_f32_32x32x16_bf16 v[96:111], a[40:43], a[36:39], v[96:111]
    v_mfma_f32_32x32x16_bf16 v[112:127], a[44:47], a[36:39], v[112:127]
    s_waitcnt vmcnt(20)
    v_mfma_f32_32x32x16_bf16 v[64:79], a[56:59], a[48:51], v[64:79]
    v_mfma_f32_32x32x16_bf16 v[80:95], a[60:63], a[48:51], v[80:95]
    v_mfma_f32_32x32x16_bf16 v[96:111], a[56:59], a[52:55], v[96:111]
    v_mfma_f32_32x32x16_bf16 v[112:127], a[60:63], a[52:55], v[112:127]
    s_waitcnt vmcnt(16)
    v_mfma_f32_32x32x16_bf16 v[64:79], a[72:75], a[64:67], v[64:79]
    v_mfma_f32_32x32x16_bf16 v[80:95], a[76:79], a[64:67], v[80:95]
    v_mfma_f32_32x32x16_bf16 v[96:111], a[72:75], a[68:71], v[96:111]
    v_mfma_f32_32x32x16_bf16 v[112:127], a[76:79], a[68:71], v[112:127]
    s_waitcnt vmcnt(12)
    v_mfma_f32_32x32x16_bf16 v[64:79], a[88:91], a[80:83], v[64:79]
    v_mfma_f32_32x32x16_bf16 v[80:95], a[92:95], a[80:83], v[80:95]
    v_mfma_f32_32x32x16_bf16 v[96:111], a[88:91], a[84:87], v[96:111]
    v_mfma_f32_32x32x16_bf16 v[112:127], a[92:95], a[84:87], v[112:127]
    s_waitcnt vmcnt(4)
    v_mfma_f32_32x32x16_bf16 v[64:79], a[104:107], a[96:99], v[64:79]
    v_mfma_f32_32x32x16_bf16 v[80:95], a[108:111], a[96:99], v[80:95]
    v_mfma_f32_32x32x16_bf16 v[96:111], a[104:107], a[100:103], v[96:111]
    v_mfma_f32_32x32x16_bf16 v[112:127], a[108:111], a[100:103], v[112:127]
    s_waitcnt vmcnt(0)
    v_mfma_f32_32x32x16_bf16 v[64:79], a[120:123], a[112:115], v[64:79]
    v_mfma_f32_32x32x16_bf16 v[80:95], a[124:127], a[112:115], v[80:95]
    v_mfma_f32_32x32x16_bf16 v[96:111], a[120:123], a[116:119], v[96:111]
    v_mfma_f32_32x32x16_bf16 v[112:127], a[124:127], a[116:119], v[112:127]
    s_lshl_b32 s52, s50, 12
    v_add_u32 v4, s52, v3
    s_lshl_b32 s52, s50, 14
    v_add_u32 v6, s52, v3
    s_nop 15
    ds_write_b128 v4, v[64:67] offset:0
    ds_write_b128 v4, v[68:71] offset:1024
    ds_write_b128 v4, v[72:75] offset:2048
    ds_write_b128 v4, v[76:79] offset:3072
    ds_write_b128 v4, v[80:83] offset:16384
    ds_write_b128 v4, v[84:87] offset:17408
    ds_write_b128 v4, v[88:91] offset:18432
    ds_write_b128 v4, v[92:95] offset:19456
    ds_write_b128 v4, v[96:99] offset:32768
    ds_write_b128 v4, v[100:103] offset:33792
    ds_write_b128 v4, v[104:107] offset:34816
    ds_write_b128 v4, v[108:111] offset:35840
    ds_write_b128 v4, v[112:115] offset:49152
    ds_write_b128 v4, v[116:119] offset:50176
    ds_write_b128 v4, v[120:123] offset:51200
    ds_write_b128 v4, v[124:127] offset:52224
    s_waitcnt lgkmcnt(0)
    s_barrier
    ds_read_b128 v[64:67], v6 offset:0
    ds_read_b128 v[68:71], v6 offset:1024
    ds_read_b128 v[72:75], v6 offset:2048
    ds_read_b128 v[76:79], v6 offset:3072
    ds_read_b128 v[80:83], v6 offset:4096
    ds_read_b128 v[84:87], v6 offset:5120
    ds_read_b128 v[88:91], v6 offset:6144
    ds_read_b128 v[92:95], v6 offset:7168
    ds_read_b128 v[96:99], v6 offset:8192
    ds_read_b128 v[100:103], v6 offset:9216
    ds_read_b128 v[104:107], v6 offset:10240
    ds_read_b128 v[108:111], v6 offset:11264
    ds_read_b128 v[112:115], v6 offset:12288
    ds_read_b128 v[116:119], v6 offset:13312
    ds_read_b128 v[120:123], v6 offset:14336
    ds_read_b128 v[124:127], v6 offset:15360
    v_mov_b32 v18, v16
    v_mov_b32 v7, 0x3f803f80
    v_mov_b32 v8, 0
    v_mov_b32 v9, 0
    s_waitcnt vmcnt(0) lgkmcnt(0)
    v_pk_add_f32 v[64:65], v[64:65], v[80:81]
    v_pk_add_f32 v[96:97], v[96:97], v[112:113]
    v_pk_add_f32 v[66:67], v[66:67], v[82:83]
    v_pk_add_f32 v[98:99], v[98:99], v[114:115]
    v_pk_add_f32 v[68:69], v[68:69], v[84:85]
    v_pk_add_f32 v[100:101], v[100:101], v[116:117]
    v_pk_add_f32 v[70:71], v[70:71], v[86:87]
    v_pk_add_f32 v[102:103], v[102:103], v[118:119]
    v_pk_add_f32 v[72:73], v[72:73], v[88:89]
    v_pk_add_f32 v[104:105], v[104:105], v[120:121]
    v_pk_add_f32 v[74:75], v[74:75], v[90:91]
    v_pk_add_f32 v[106:107], v[106:107], v[122:123]
    v_pk_add_f32 v[76:77], v[76:77], v[92:93]
    v_pk_add_f32 v[108:109], v[108:109], v[124:125]
    v_pk_add_f32 v[78:79], v[78:79], v[94:95]
    v_pk_add_f32 v[110:111], v[110:111], v[126:127]
    v_pk_add_f32 v[64:65], v[64:65], v[96:97]
    v_pk_add_f32 v[66:67], v[66:67], v[98:99]
    v_pk_add_f32 v[68:69], v[68:69], v[100:101]
    v_pk_add_f32 v[70:71], v[70:71], v[102:103]
    v_pk_add_f32 v[72:73], v[72:73], v[104:105]
    v_pk_add_f32 v[74:75], v[74:75], v[106:107]
    v_pk_add_f32 v[76:77], v[76:77], v[108:109]
    v_pk_add_f32 v[78:79], v[78:79], v[110:111]
    v_cvt_pk_bf16_f32 v56, v64, v65
    v_lshlrev_b32 v64, 16, v56
    v_and_b32 v65, 0xffff0000, v56
    v_cvt_pk_bf16_f32 v57, v66, v67
    v_lshlrev_b32 v66, 16, v57
    v_and_b32 v67, 0xffff0000, v57
    v_lshlrev_b32 v58, 16, v40
    v_and_b32 v59, 0xffff0000, v40
    v_pk_add_f32 v[64:65], v[64:65], v[58:59]
    v_lshlrev_b32 v58, 16, v41
    v_and_b32 v59, 0xffff0000, v41
    v_pk_add_f32 v[66:67], v[66:67], v[58:59]
    v_cvt_pk_bf16_f32 v20, v64, v65
    v_cvt_pk_bf16_f32 v21, v66, v67
    buffer_store_dwordx2 v[20:21], v18, s[40:43], s55 offen offset:0
    v_dot2_f32_bf16 v8, v20, v7, v8
    v_dot2_f32_bf16 v9, v20, v20, v9
    v_dot2_f32_bf16 v8, v21, v7, v8
    v_dot2_f32_bf16 v9, v21, v21, v9
    v_cvt_pk_bf16_f32 v56, v68, v69
    v_lshlrev_b32 v68, 16, v56
    v_and_b32 v69, 0xffff0000, v56
    v_cvt_pk_bf16_f32 v57, v70, v71
    v_lshlrev_b32 v70, 16, v57
    v_and_b32 v71, 0xffff0000, v57
    v_lshlrev_b32 v58, 16, v42
    v_and_b32 v59, 0xffff0000, v42
    v_pk_add_f32 v[68:69], v[68:69], v[58:59]
    v_lshlrev_b32 v58, 16, v43
    v_and_b32 v59, 0xffff0000, v43
    v_pk_add_f32 v[70:71], v[70:71], v[58:59]
    v_cvt_pk_bf16_f32 v22, v68, v69
    v_cvt_pk_bf16_f32 v23, v70, v71
    buffer_store_dwordx2 v[22:23], v18, s[40:43], s55 offen offset:512
    v_dot2_f32_bf16 v8, v22, v7, v8
    v_dot2_f32_bf16 v9, v22, v22, v9
    v_dot2_f32_bf16 v8, v23, v7, v8
    v_dot2_f32_bf16 v9, v23, v23, v9
    v_cvt_pk_bf16_f32 v56, v72, v73
    v_lshlrev_b32 v72, 16, v56
    v_and_b32 v73, 0xffff0000, v56
    v_cvt_pk_bf16_f32 v57, v74, v75
    v_lshlrev_b32 v74, 16, v57
    v_and_b32 v75, 0xffff0000, v57
    v_lshlrev_b32 v58, 16, v44
    v_and_b32 v59, 0xffff0000, v44
    v_pk_add_f32 v[72:73], v[72:73], v[58:59]
    v_lshlrev_b32 v58, 16, v45
    v_and_b32 v59, 0xffff0000, v45
    v_pk_add_f32 v[74:75], v[74:75], v[58:59]
    v_cvt_pk_bf16_f32 v24, v72, v73
    v_cvt_pk_bf16_f32 v25, v74, v75
    buffer_store_dwordx2 v[24:25], v18, s[40:43], s55 offen offset:1024
    v_dot2_f32_bf16 v8, v24, v7, v8
    v_dot2_f32_bf16 v9, v24, v24, v9
    v_dot2_f32_bf16 v8, v25, v7, v8
    v_dot2_f32_bf16 v9, v25, v25, v9
    v_cvt_pk_bf16_f32 v56, v76, v77
    v_lshlrev_b32 v76, 16, v56
    v_and_b32 v77, 0xffff0000, v56
    v_cvt_pk_bf16_f32 v57, v78, v79
    v_lshlrev_b32 v78, 16, v57
    v_and_b32 v79, 0xffff0000, v57
    v_lshlrev_b32 v58, 16, v46
    v_and_b32 v59, 0xffff0000, v46
    v_pk_add_f32 v[76:77], v[76:77], v[58:59]
    v_lshlrev_b32 v58, 16, v47
    v_and_b32 v59, 0xffff0000, v47
    v_pk_add_f32 v[78:79], v[78:79], v[58:59]
    v_cvt_pk_bf16_f32 v26, v76, v77
    v_cvt_pk_bf16_f32 v27, v78, v79
    buffer_store_dwordx2 v[26:27], v18, s[40:43], s55 offen offset:1536
    v_dot2_f32_bf16 v8, v26, v7, v8
    v_dot2_f32_bf16 v9, v26, v26, v9
    v_dot2_f32_bf16 v8, v27, v7, v8
    v_dot2_f32_bf16 v9, v27, v27, v9
    v_mov_b32 v10, v16
    s_lshr_b32 s51, s50, 1
    s_lshl_b32 s52, s48, 1
    s_add_u32 s51, s51, s52
    s_lshl_b32 s51, s51, 9
    s_lshl_b32 s52, s49, 16
    s_add_u32 s51, s51, s52
    s_and_b32 s52, s50, 1
    s_lshl_b32 s52, s52, 15
    s_add_u32 s51, s51, s52
    buffer_store_dwordx2 v[8:9], v10, s[56:59], s51 offen
L_wo2_kernel_end:
    s_endpgm
.globl ffn1b_kernel
.p2align 8
.type ffn1b_kernel,@function
ffn1b_kernel:
    s_cmp_ge_u32 s2, 224
    s_cbranch_scc1 L_ffn1b_kernel_end
    s_load_dwordx16 s[4:19], s[0:1], 0
    s_load_dwordx4 s[20:23], s[0:1], 64
    s_load_dwordx2 s[24:25], s[0:1], 80
    s_and_b32 s51, s2, 7
    s_mul_i32 s51, s51, 28
    s_lshr_b32 s54, s2, 3
    s_add_u32 s54, s54, s51
    s_mov_b32 s51, 0x04924925
    s_mul_hi_u32 s48, s54, s51
    s_mul_i32 s51, s48, 56
    s_sub_u32 s54, s54, s51
    s_lshr_b32 s49, s54, 3
    s_and_b32 s54, s54, 7
    s_lshl_b32 s48, s48, 3
    s_add_u32 s48, s48, s54
    v_lshrrev_b32 v2, 6, v0
    v_and_b32 v1, 63, v0
    v_lshrrev_b32 v5, 5, v1
    v_readfirstlane_b32 s50, v2
    v_lshlrev_b32 v3, 4, v1
    s_waitcnt lgkmcnt(0)
    s_add_u32 s28, s24, 0x01400000
    s_addc_u32 s29, s25, 0
    s_and_b32 s29, s29, 0xffff
    s_mov_b32 s30, 0x00200000
    s_mov_b32 s31, 0x00020000
    s_add_u32 s32, s24, 0x01900000
    s_addc_u32 s33, s25, 0
    s_and_b32 s33, s33, 0xffff
    s_mov_b32 s34, 0x001c0000
    s_mov_b32 s35, 0x00020000
    s_add_u32 s44, s24, 0x02300000
    s_addc_u32 s45, s25, 0
    s_and_b32 s45, s45, 0xffff
    s_mov_b32 s46, 0x00080000
    s_mov_b32 s47, 0x00020000
    s_add_u32 s64, s24, 0x02410000
    s_addc_u32 s65, s25, 0
    s_and_b32 s65, s65, 0xffff
    s_mov_b32 s66, 0x00001c00
    s_mov_b32 s67, 0x00020000
    s_lshl_b32 s51, s48, 16
    s_lshl_b32 s54, s50, 13
    s_add_u32 s51, s51, s54
    s_add_u32 m0, s54, 0
    s_add_u32 s59, s51, 0
    buffer_load_dwordx4 v3, s[28:31], s59 offen offset:0 lds
    buffer_load_dwordx4 v3, s[28:31], s59 offen offset:1024 lds
    buffer_load_dwordx4 v3, s[28:31], s59 offen offset:2048 lds
    buffer_load_dwordx4 v3, s[28:31], s59 offen offset:3072 lds
    s_add_u32 m0, s54, 4096
    s_add_u32 s59, s51, 4096
    buffer_load_dwordx4 v3, s[28:31], s59 offen offset:0 lds
    buffer_load_dwordx4 v3, s[28:31], s59 offen offset:1024 lds
    buffer_load_dwordx4 v3, s[28:31], s59 offen offset:2048 lds
    buffer_load_dwordx4 v3, s[28:31], s59 offen offset:3072 lds
    s_lshl_b32 s58, s49, 3
    s_add_u32 s58, s58, s50
    s_lshl_b32 s52, s58, 15
    s_lshl_b32 s57, s58, 5
    s_add_u32 s61, s52, 0
    buffer_load_dwordx4 a[0:3], v3, s[32:35], s61 offen offset:0
    buffer_load_dwordx4 a[4:7], v3, s[32:35], s61 offen offset:1024
    buffer_load_dwordx4 a[8:11], v3, s[32:35], s61 offen offset:2048
    buffer_load_dwordx4 a[12:15], v3, s[32:35], s61 offen offset:3072
    s_add_u32 s61, s52, 4096
    buffer_load_dwordx4 a[16:19], v3, s[32:35], s61 offen offset:0
    buffer_load_dwordx4 a[20:23], v3, s[32:35], s61 offen offset:1024
    buffer_load_dwordx4 a[24:27], v3, s[32:35], s61 offen offset:2048
    buffer_load_dwordx4 a[28:31], v3, s[32:35], s61 offen offset:3072
    v_lshrrev_b32 v24, 3, v1
    v_and_b32 v25, 7, v1
    v_lshlrev_b32 v25, 16, v25
    v_lshl_add_u32 v24, v24, 4, v25
    s_lshl_b32 s60, s48, 10
    s_lshl_b32 s59, s50, 7
    s_add_u32 s60, s60, s59
    buffer_load_dwordx4 v[64:67], v24, s[44:47], s60 offen
    s_add_u32 s60, s60, 32768
    buffer_load_dwordx4 v[68:71], v24, s[44:47], s60 offen
    v_mov_b32 v32, 0
    v_mov_b32 v33, 0
    v_mov_b32 v34, 0
    v_mov_b32 v35, 0
    v_mov_b32 v36, 0
    v_mov_b32 v37, 0
    v_mov_b32 v38, 0
    v_mov_b32 v39, 0
    v_mov_b32 v40, 0
    v_mov_b32 v41, 0
    v_mov_b32 v42, 0
    v_mov_b32 v43, 0
    v_mov_b32 v44, 0
    v_mov_b32 v45, 0
    v_mov_b32 v46, 0
    v_mov_b32 v47, 0
    v_mov_b32 v48, 0
    v_mov_b32 v49, 0
    v_mov_b32 v50, 0
    v_mov_b32 v51, 0
    v_mov_b32 v52, 0
    v_mov_b32 v53, 0
    v_mov_b32 v54, 0
    v_mov_b32 v55, 0
    v_mov_b32 v56, 0
    v_mov_b32 v57, 0
    v_mov_b32 v58, 0
    v_mov_b32 v59, 0
    v_mov_b32 v60, 0
    v_mov_b32 v61, 0
    v_mov_b32 v62, 0
    v_mov_b32 v63, 0
    v_and_b32 v4, 31, v1
    v_lshlrev_b32 v7, 4, v4
    v_lshl_add_u32 v7, v5, 3, v7
    v_lshlrev_b32 v6, 4, v5
    s_lshl_b32 s51, s57, 2
    buffer_load_dwordx4 v[8:11], v6, s[64:67], s51 offen offset:0
    buffer_load_dwordx4 v[12:15], v6, s[64:67], s51 offen offset:32
    buffer_load_dwordx4 v[16:19], v6, s[64:67], s51 offen offset:64
    buffer_load_dwordx4 v[20:23], v6, s[64:67], s51 offen offset:96
    s_mov_b32 s40, s14
    s_and_b32 s41, s15, 0xffff
    s_mov_b32 s42, 0x00000e00
    s_mov_b32 s43, 0x00020000
    s_add_u32 s36, s24, 0x00a00000
    s_addc_u32 s37, s25, 0
    s_and_b32 s37, s37, 0xffff
    s_mov_b32 s38, 0x00700000
    s_mov_b32 s39, 0x00020000
    s_lshl_b32 s55, s57, 1
    v_lshlrev_b32 v6, 3, v5
    buffer_load_dwordx2 v[88:89], v6, s[40:43], s55 offen offset:0
    buffer_load_dwordx2 v[90:91], v6, s[40:43], s55 offen offset:16
    buffer_load_dwordx2 v[92:93], v6, s[40:43], s55 offen offset:32
    buffer_load_dwordx2 v[94:95], v6, s[40:43], s55 offen offset:48
    s_mul_i32 s56, s48, 229376
    s_lshl_b32 s51, s57, 6
    s_add_u32 s56, s56, s51
    s_cmp_ge_u32 s50, 4
    s_cbranch_scc1 L_ffn1b_kernel_prio_1
    s_setprio 2
L_ffn1b_kernel_prio_1:
    s_waitcnt vmcnt(18)
    s_barrier
    ds_read_b128 v[96:99], v3 offset:0
    ds_read_b128 v[100:103], v3 offset:32768
    ds_read_b128 v[104:107], v3 offset:1024
    ds_read_b128 v[108:111], v3 offset:33792
    ds_read_b128 v[112:115], v3 offset:2048
    ds_read_b128 v[116:119], v3 offset:34816
    s_add_u32 s61, s52, 8192
    buffer_load_dwordx4 a[32:35], v3, s[32:35], s61 offen offset:0
    s_waitcnt vmcnt(18) lgkmcnt(4)
    v_mfma_f32_32x32x16_bf16 v[32:47], a[0:3], v[96:99], v[32:47]
    v_mfma_f32_32x32x16_bf16 v[48:63], a[0:3], v[100:103], v[48:63]
    ds_read_b128 v[120:123], v3 offset:3072
    ds_read_b128 v[124:127], v3 offset:35840
    buffer_load_dwordx4 a[36:39], v3, s[32:35], s61 offen offset:1024
    s_waitcnt vmcnt(18) lgkmcnt(4)
    v_mfma_f32_32x32x16_bf16 v[32:47], a[4:7], v[104:107], v[32:47]
    v_mfma_f32_32x32x16_bf16 v[48:63], a[4:7], v[108:111], v[48:63]
    ds_read_b128 v[96:99], v3 offset:4096
    ds_read_b128 v[100:103], v3 offset:36864
    buffer_load_dwordx4 a[40:43], v3, s[32:35], s61 offen offset:2048
    s_waitcnt vmcnt(18) lgkmcnt(4)
    v_mfma_f32_32x32x16_bf16 v[32:47], a[8:11], v[112:115], v[32:47]
    v_mfma_f32_32x32x16_bf16 v[48:63], a[8:11], v[116:119], v[48:63]
    ds_read_b128 v[104:107], v3 offset:5120
    ds_read_b128 v[108:111], v3 offset:37888
    buffer_load_dwordx4 a[44:47], v3, s[32:35], s61 offen offset:3072
    s_waitcnt vmcnt(18) lgkmcnt(4)
    v_mfma_f32_32x32x16_bf16 v[32:47], a[12:15], v[120:123], v[32:47]
    v_mfma_f32_32x32x16_bf16 v[48:63], a[12:15], v[124:127], v[48:63]
    ds_read_b128 v[112:115], v3 offset:6144
    ds_read_b128 v[116:119], v3 offset:38912
    s_add_u32 s61, s52, 12288
    buffer_load_dwordx4 a[48:51], v3, s[32:35], s61 offen offset:0
    s_waitcnt vmcnt(18) lgkmcnt(4)
    v_mfma_f32_32x32x16_bf16 v[32:47], a[16:19], v[96:99], v[32:47]
    v_mfma_f32_32x32x16_bf16 v[48:63], a[16:19], v[100:103], v[48:63]
    ds_read_b128 v[120:123], v3 offset:7168
    ds_read_b128 v[124:127], v3 offset:39936
    buffer_load_dwordx4 a[52:55], v3, s[32:35], s61 offen offset:1024
    s_waitcnt vmcnt(18) lgkmcnt(4)
    v_mfma_f32_32x32x16_bf16 v[32:47], a[20:23], v[104:107], v[32:47]
    v_mfma_f32_32x32x16_bf16 v[48:63], a[20:23], v[108:111], v[48:63]
    ds_read_b128 v[96:99], v3 offset:8192
    ds_read_b128 v[100:103], v3 offset:40960
    buffer_load_dwordx4 a[56:59], v3, s[32:35], s61 offen offset:2048
    s_waitcnt vmcnt(15)
    v_pk_add_f32 v[64:65], v[64:65], v[66:67]
    v_pk_add_f32 v[68:69], v[68:69], v[70:71]
    v_pk_add_f32 v[24:25], v[64:65], v[68:69]
    s_nop 1
    v_add_f32_dpp v24, v24, v24 quad_perm:[1,0,3,2] row_mask:0xf bank_mask:0xf
    v_add_f32_dpp v25, v25, v25 quad_perm:[1,0,3,2] row_mask:0xf bank_mask:0xf
    s_nop 1
    v_add_f32_dpp v24, v24, v24 quad_perm:[2,3,0,1] row_mask:0xf bank_mask:0xf
    v_add_f32_dpp v25, v25, v25 quad_perm:[2,3,0,1] row_mask:0xf bank_mask:0xf
    s_nop 1
    v_add_f32_dpp v24, v24, v24 row_half_mirror row_mask:0xf bank_mask:0xf
    v_add_f32_dpp v25, v25, v25 row_half_mirror row_mask:0xf bank_mask:0xf
    v_mul_f32 v29, 0x3b000000, v24
    v_mul_f32 v28, 0x3b000000, v25
    v_fma_f32 v28, -v29, v29, v28
    v_max_f32 v28, 0, v28
    v_cvt_pk_bf16_f32 v30, v29, v28
    v_lshlrev_b32 v29, 16, v30
    v_and_b32 v28, 0xffff0000, v30
    v_add_f32 v28, 0x3727c5ac, v28
    v_cvt_pk_bf16_f32 v30, v28, v28
    v_and_b32 v28, 0xffff0000, v30
    v_sqrt_f32 v28, v28
    s_nop 0
    v_cvt_pk_bf16_f32 v30, v28, v28
    v_and_b32 v28, 0xffff0000, v30
    v_rcp_f32 v28, v28
    s_nop 0
    v_mul_f32 v29, v29, v28
    v_sub_f32 v29, 0, v29
    v_lshrrev_b32 v30, 3, v1
    v_lshlrev_b32 v30, 3, v30
    s_lshl_b32 s59, s50, 6
    s_add_u32 s59, s59, 65536
    v_add_u32 v30, s59, v30
    ds_write_b64 v30, v[28:29]
    s_waitcnt lgkmcnt(0)
    s_waitcnt vmcnt(18) lgkmcnt(4)
    v_mfma_f32_32x32x16_bf16 v[32:47], a[24:27], v[112:115], v[32:47]
    v_mfma_f32_32x32x16_bf16 v[48:63], a[24:27], v[116:119], v[48:63]
    ds_read_b128 v[104:107], v3 offset:9216
    ds_read_b128 v[108:111], v3 offset:41984
    buffer_load_dwordx4 a[60:63], v3, s[32:35], s61 offen offset:3072
    s_waitcnt vmcnt(18) lgkmcnt(4)
    v_mfma_f32_32x32x16_bf16 v[32:47], a[28:31], v[120:123], v[32:47]
    v_mfma_f32_32x32x16_bf16 v[48:63], a[28:31], v[124:127], v[48:63]
    ds_read_b128 v[112:115], v3 offset:10240
    ds_read_b128 v[116:119], v3 offset:43008
    s_add_u32 s61, s52, 16384
    buffer_load_dwordx4 a[64:67], v3, s[32:35], s61 offen offset:0
    s_barrier
    s_waitcnt vmcnt(8) lgkmcnt(4)
    v_mfma_f32_32x32x16_bf16 v[32:47], a[32:35], v[96:99], v[32:47]
    v_mfma_f32_32x32x16_bf16 v[48:63], a[32:35], v[100:103], v[48:63]
    ds_read_b128 v[120:123], v3 offset:11264
    ds_read_b128 v[124:127], v3 offset:44032
    buffer_load_dwordx4 a[68:71], v3, s[32:35], s61 offen offset:1024
    s_waitcnt vmcnt(8) lgkmcnt(4)
    v_mfma_f32_32x32x16_bf16 v[32:47], a[36:39], v[104:107], v[32:47]
    v_mfma_f32_32x32x16_bf16 v[48:63], a[36:39], v[108:111], v[48:63]
    ds_read_b128 v[96:99], v3 offset:12288
    ds_read_b128 v[100:103], v3 offset:45056
    buffer_load_dwordx4 a[72:75], v3, s[32:35], s61 offen offset:2048
    s_waitcnt vmcnt(8) lgkmcnt(4)
    v_mfma_f32_32x32x16_bf16 v[32:47], a[40:43], v[112:115], v[32:47]
    v_mfma_f32_32x32x16_bf16 v[48:63], a[40:43], v[116:119], v[48:63]
    ds_read_b128 v[104:107], v3 offset:13312
    ds_read_b128 v[108:111], v3 offset:46080
    buffer_load_dwordx4 a[76:79], v3, s[32:35], s61 offen offset:3072
    s_waitcnt vmcnt(8) lgkmcnt(4)
    v_mfma_f32_32x32x16_bf16 v[32:47], a[44:47], v[120:123], v[32:47]
    v_mfma_f32_32x32x16_bf16 v[48:63], a[44:47], v[124:127], v[48:63]
    ds_read_b128 v[112:115], v3 offset:14336
    ds_read_b128 v[116:119], v3 offset:47104
    s_add_u32 s61, s52, 20480
    buffer_load_dwordx4 a[80:83], v3, s[32:35], s61 offen offset:0
    s_waitcnt vmcnt(8) lgkmcnt(4)
    v_mfma_f32_32x32x16_bf16 v[32:47], a[48:51], v[96:99], v[32:47]
    v_mfma_f32_32x32x16_bf16 v[48:63], a[48:51], v[100:103], v[48:63]
    ds_read_b128 v[120:123], v3 offset:15360
    ds_read_b128 v[124:127], v3 offset:48128
    buffer_load_dwordx4 a[84:87], v3, s[32:35], s61 offen offset:1024
    s_waitcnt vmcnt(8) lgkmcnt(4)
    v_mfma_f32_32x32x16_bf16 v[32:47], a[52:55], v[104:107], v[32:47]
    v_mfma_f32_32x32x16_bf16 v[48:63], a[52:55], v[108:111], v[48:63]
    ds_read_b128 v[96:99], v3 offset:16384
    ds_read_b128 v[100:103], v3 offset:49152
    buffer_load_dwordx4 a[88:91], v3, s[32:35], s61 offen offset:2048
    s_waitcnt vmcnt(8) lgkmcnt(4)
    v_mfma_f32_32x32x16_bf16 v[32:47], a[56:59], v[112:115], v[32:47]
    v_mfma_f32_32x32x16_bf16 v[48:63], a[56:59], v[116:119], v[48:63]
    ds_read_b128 v[104:107], v3 offset:17408
    ds_read_b128 v[108:111], v3 offset:50176
    buffer_load_dwordx4 a[92:95], v3, s[32:35], s61 offen offset:3072
    s_waitcnt vmcnt(8) lgkmcnt(4)
    v_mfma_f32_32x32x16_bf16 v[32:47], a[60:63], v[120:123], v[32:47]
    v_mfma_f32_32x32x16_bf16 v[48:63], a[60:63], v[124:127], v[48:63]
    ds_read_b128 v[112:115], v3 offset:18432
    ds_read_b128 v[116:119], v3 offset:51200
    s_add_u32 s61, s52, 24576
    buffer_load_dwordx4 a[96:99], v3, s[32:35], s61 offen offset:0
    s_waitcnt vmcnt(8) lgkmcnt(4)
    v_mfma_f32_32x32x16_bf16 v[32:47], a[64:67], v[96:99], v[32:47]
    v_mfma_f32_32x32x16_bf16 v[48:63], a[64:67], v[100:103], v[48:63]
    ds_read_b128 v[120:123], v3 offset:19456
    ds_read_b128 v[124:127], v3 offset:52224
    buffer_load_dwordx4 a[100:103], v3, s[32:35], s61 offen offset:1024
    s_waitcnt vmcnt(8) lgkmcnt(4)
    v_mfma_f32_32x32x16_bf16 v[32:47], a[68:71], v[104:107], v[32:47]
    v_mfma_f32_32x32x16_bf16 v[48:63], a[68:71], v[108:111], v[48:63]
    ds_read_b128 v[96:99], v3 offset:20480
    ds_read_b128 v[100:103], v3 offset:53248
    buffer_load_dwordx4 a[104:107], v3, s[32:35], s61 offen offset:2048
    s_waitcnt vmcnt(8) lgkmcnt(4)
    v_mfma_f32_32x32x16_bf16 v[32:47], a[72:75], v[112:115], v[32:47]
    v_mfma_f32_32x32x16_bf16 v[48:63], a[72:75], v[116:119], v[48:63]
    ds_read_b128 v[104:107], v3 offset:21504
    ds_read_b128 v[108:111], v3 offset:54272
    buffer_load_dwordx4 a[108:111], v3, s[32:35], s61 offen offset:3072
    s_waitcnt vmcnt(8) lgkmcnt(4)
    v_mfma_f32_32x32x16_bf16 v[32:47], a[76:79], v[120:123], v[32:47]
    v_mfma_f32_32x32x16_bf16 v[48:63], a[76:79], v[124:127], v[48:63]
    ds_read_b128 v[112:115], v3 offset:22528
    ds_read_b128 v[116:119], v3 offset:55296
    s_add_u32 s61, s52, 28672
    buffer_load_dwordx4 a[112:115], v3, s[32:35], s61 offen offset:0
    s_waitcnt vmcnt(8) lgkmcnt(4)
    v_mfma_f32_32x32x16_bf16 v[32:47], a[80:83], v[96:99], v[32:47]
    v_mfma_f32_32x32x16_bf16 v[48:63], a[80:83], v[100:103], v[48:63]
    ds_read_b128 v[120:123], v3 offset:23552
    ds_read_b128 v[124:127], v3 offset:56320
    buffer_load_dwordx4 a[116:119], v3, s[32:35], s61 offen offset:1024
    s_waitcnt vmcnt(8) lgkmcnt(4)
    v_mfma_f32_32x32x16_bf16 v[32:47], a[84:87], v[104:107], v[32:47]
    v_mfma_f32_32x32x16_bf16 v[48:63], a[84:87], v[108:111], v[48:63]
    ds_read_b128 v[96:99], v3 offset:24576
    ds_read_b128 v[100:103], v3 offset:57344
    buffer_load_dwordx4 a[120:123], v3, s[32:35], s61 offen offset:2048
    s_waitcnt vmcnt(8) lgkmcnt(4)
    v_mfma_f32_32x32x16_bf16 v[32:47], a[88:91], v[112:115], v[32:47]
    v_mfma_f32_32x32x16_bf16 v[48:63], a[88:91], v[116:119], v[48:63]
    ds_read_b128 v[104:107], v3 offset:25600
    ds_read_b128 v[108:111], v3 offset:58368
    buffer_load_dwordx4 a[124:127], v3, s[32:35], s61 offen offset:3072
    s_waitcnt vmcnt(8) lgkmcnt(4)
    v_mfma_f32_32x32x16_bf16 v[32:47], a[92:95], v[120:123], v[32:47]
    v_mfma_f32_32x32x16_bf16 v[48:63], a[92:95], v[124:127], v[48:63]
    ds_read_b128 v[112:115], v3 offset:26624
    ds_read_b128 v[116:119], v3 offset:59392
    s_waitcnt vmcnt(7) lgkmcnt(4)
    v_mfma_f32_32x32x16_bf16 v[32:47], a[96:99], v[96:99], v[32:47]
    v_mfma_f32_32x32x16_bf16 v[48:63], a[96:99], v[100:103], v[48:63]
    ds_read_b128 v[120:123], v3 offset:27648
    ds_read_b128 v[124:127], v3 offset:60416
    s_waitcnt vmcnt(6) lgkmcnt(4)
    v_mfma_f32_32x32x16_bf16 v[32:47], a[100:103], v[104:107], v[32:47]
    v_mfma_f32_32x32x16_bf16 v[48:63], a[100:103], v[108:111], v[48:63]
    ds_read_b128 v[96:99], v3 offset:28672
    ds_read_b128 v[100:103], v3 offset:61440
    s_waitcnt vmcnt(5) lgkmcnt(4)
    v_mfma_f32_32x32x16_bf16 v[32:47], a[104:107], v[112:115], v[32:47]
    v_mfma_f32_32x32x16_bf16 v[48:63], a[104:107], v[116:119], v[48:63]
    ds_read_b128 v[104:107], v3 offset:29696
    ds_read_b128 v[108:111], v3 offset:62464
    s_waitcnt vmcnt(4) lgkmcnt(4)
    v_mfma_f32_32x32x16_bf16 v[32:47], a[108:111], v[120:123], v[32:47]
    v_mfma_f32_32x32x16_bf16 v[48:63], a[108:111], v[124:127], v[48:63]
    ds_read_b128 v[112:115], v3 offset:30720
    ds_read_b128 v[116:119], v3 offset:63488
    s_waitcnt vmcnt(3) lgkmcnt(4)
    v_mfma_f32_32x32x16_bf16 v[32:47], a[112:115], v[96:99], v[32:47]
    v_mfma_f32_32x32x16_bf16 v[48:63], a[112:115], v[100:103], v[48:63]
    ds_read_b128 v[120:123], v3 offset:31744
    ds_read_b128 v[124:127], v3 offset:64512
    s_waitcnt vmcnt(2) lgkmcnt(4)
    v_mfma_f32_32x32x16_bf16 v[32:47], a[116:119], v[104:107], v[32:47]
    v_mfma_f32_32x32x16_bf16 v[48:63], a[116:119], v[108:111], v[48:63]
    s_waitcnt vmcnt(1) lgkmcnt(2)
    v_mfma_f32_32x32x16_bf16 v[32:47], a[120:123], v[112:115], v[32:47]
    v_mfma_f32_32x32x16_bf16 v[48:63], a[120:123], v[116:119], v[48:63]
    s_waitcnt vmcnt(0) lgkmcnt(0)
    v_mfma_f32_32x32x16_bf16 v[32:47], a[124:127], v[120:123], v[32:47]
    v_mfma_f32_32x32x16_bf16 v[48:63], a[124:127], v[124:127], v[48:63]
    v_lshlrev_b32 v30, 3, v4
    v_add_u32 v30, 65536, v30
    ds_read_b64 v[28:29], v30
    ds_read_b64 v[30:31], v30 offset:256
    s_waitcnt lgkmcnt(0)
    v_mov_b32 v64, v28
    v_mov_b32 v65, v28
    v_mov_b32 v66, v29
    v_mov_b32 v67, v29
    v_mov_b32 v68, v30
    v_mov_b32 v69, v30
    v_mov_b32 v70, v31
    v_mov_b32 v71, v31
    s_waitcnt vmcnt(24)
    v_mov_b32 v120, 0xbdd2d3e8
    v_mov_b32 v121, 0xbdd2d3e8
    v_mov_b32 v122, 0xc0135761
    v_mov_b32 v123, 0xc0135761
    v_mov_b32 v124, 1.0
    v_mov_b32 v125, 1.0
    v_lshlrev_b32 v96, 16, v88
    v_and_b32 v97, 0xffff0000, v88
    v_lshlrev_b32 v98, 16, v89
    v_and_b32 v99, 0xffff0000, v89
    v_lshlrev_b32 v100, 16, v90
    v_and_b32 v101, 0xffff0000, v90
    v_lshlrev_b32 v102, 16, v91
    v_and_b32 v103, 0xffff0000, v91
    v_lshlrev_b32 v104, 16, v92
    v_and_b32 v105, 0xffff0000, v92
    v_lshlrev_b32 v106, 16, v93
    v_and_b32 v107, 0xffff0000, v93
    v_lshlrev_b32 v108, 16, v94
    v_and_b32 v109, 0xffff0000, v94
    v_lshlrev_b32 v110, 16, v95
    v_and_b32 v111, 0xffff0000, v95
    v_pk_mul_f32 v[32:33], v[32:33], v[64:65]
    v_pk_mul_f32 v[34:35], v[34:35], v[64:65]
    v_pk_fma_f32 v[32:33], v[8:9], v[66:67], v[32:33]
    v_pk_fma_f32 v[34:35], v[10:11], v[66:67], v[34:35]
    v_pk_add_f32 v[32:33], v[32:33], v[96:97]
    v_pk_add_f32 v[34:35], v[34:35], v[98:99]
    v_cvt_pk_bf16_f32 v72, v32, v33
    v_lshlrev_b32 v32, 16, v72
    v_and_b32 v33, 0xffff0000, v72
    v_cvt_pk_bf16_f32 v73, v34, v35
    v_lshlrev_b32 v34, 16, v73
    v_and_b32 v35, 0xffff0000, v73
    v_pk_mul_f32 v[76:77], v[32:33], v[32:33]
    v_pk_mul_f32 v[78:79], v[34:35], v[34:35]
    v_pk_fma_f32 v[76:77], v[76:77], v[120:121], v[122:123]
    v_pk_fma_f32 v[78:79], v[78:79], v[120:121], v[122:123]
    v_pk_mul_f32 v[76:77], v[76:77], v[32:33]
    v_pk_mul_f32 v[78:79], v[78:79], v[34:35]
    v_exp_f32 v76, v76
    v_exp_f32 v77, v77
    v_exp_f32 v78, v78
    v_exp_f32 v79, v79
    s_nop 0
    v_pk_add_f32 v[76:77], v[76:77], v[124:125]
    v_pk_add_f32 v[78:79], v[78:79], v[124:125]
    v_rcp_f32 v76, v76
    v_rcp_f32 v77, v77
    v_rcp_f32 v78, v78
    v_rcp_f32 v79, v79
    s_nop 0
    v_pk_mul_f32 v[32:33], v[32:33], v[76:77]
    v_pk_mul_f32 v[34:35], v[34:35], v[78:79]
    v_cvt_pk_bf16_f32 v80, v32, v33
    v_cvt_pk_bf16_f32 v81, v34, v35
    s_add_u32 s51, s56, 0
    buffer_store_dwordx2 v[80:81], v7, s[36:39], s51 offen
    v_pk_mul_f32 v[36:37], v[36:37], v[64:65]
    v_pk_mul_f32 v[38:39], v[38:39], v[64:65]
    v_pk_fma_f32 v[36:37], v[12:13], v[66:67], v[36:37]
    v_pk_fma_f32 v[38:39], v[14:15], v[66:67], v[38:39]
    v_pk_add_f32 v[36:37], v[36:37], v[100:101]
    v_pk_add_f32 v[38:39], v[38:39], v[102:103]
    v_cvt_pk_bf16_f32 v72, v36, v37
    v_lshlrev_b32 v36, 16, v72
    v_and_b32 v37, 0xffff0000, v72
    v_cvt_pk_bf16_f32 v73, v38, v39
    v_lshlrev_b32 v38, 16, v73
    v_and_b32 v39, 0xffff0000, v73
    v_pk_mul_f32 v[76:77], v[36:37], v[36:37]
    v_pk_mul_f32 v[78:79], v[38:39], v[38:39]
    v_pk_fma_f32 v[76:77], v[76:77], v[120:121], v[122:123]
    v_pk_fma_f32 v[78:79], v[78:79], v[120:121], v[122:123]
    v_pk_mul_f32 v[76:77], v[76:77], v[36:37]
    v_pk_mul_f32 v[78:79], v[78:79], v[38:39]
    v_exp_f32 v76, v76
    v_exp_f32 v77, v77
    v_exp_f32 v78, v78
    v_exp_f32 v79, v79
    s_nop 0
    v_pk_add_f32 v[76:77], v[76:77], v[124:125]
    v_pk_add_f32 v[78:79], v[78:79], v[124:125]
    v_rcp_f32 v76, v76
    v_rcp_f32 v77, v77
    v_rcp_f32 v78, v78
    v_rcp_f32 v79, v79
    s_nop 0
    v_pk_mul_f32 v[36:37], v[36:37], v[76:77]
    v_pk_mul_f32 v[38:39], v[38:39], v[78:79]
    v_cvt_pk_bf16_f32 v82, v36, v37
    v_cvt_pk_bf16_f32 v83, v38, v39
    s_add_u32 s51, s56, 512
    buffer_store_dwordx2 v[82:83], v7, s[36:39], s51 offen
    v_pk_mul_f32 v[40:41], v[40:41], v[64:65]
    v_pk_mul_f32 v[42:43], v[42:43], v[64:65]
    v_pk_fma_f32 v[40:41], v[16:17], v[66:67], v[40:41]
    v_pk_fma_f32 v[42:43], v[18:19], v[66:67], v[42:43]
    v_pk_add_f32 v[40:41], v[40:41], v[104:105]
    v_pk_add_f32 v[42:43], v[42:43], v[106:107]
    v_cvt_pk_bf16_f32 v72, v40, v41
    v_lshlrev_b32 v40, 16, v72
    v_and_b32 v41, 0xffff0000, v72
    v_cvt_pk_bf16_f32 v73, v42, v43
    v_lshlrev_b32 v42, 16, v73
    v_and_b32 v43, 0xffff0000, v73
    v_pk_mul_f32 v[76:77], v[40:41], v[40:41]
    v_pk_mul_f32 v[78:79], v[42:43], v[42:43]
    v_pk_fma_f32 v[76:77], v[76:77], v[120:121], v[122:123]
    v_pk_fma_f32 v[78:79], v[78:79], v[120:121], v[122:123]
    v_pk_mul_f32 v[76:77], v[76:77], v[40:41]
    v_pk_mul_f32 v[78:79], v[78:79], v[42:43]
    v_exp_f32 v76, v76
    v_exp_f32 v77, v77
    v_exp_f32 v78, v78
    v_exp_f32 v79, v79
    s_nop 0
    v_pk_add_f32 v[76:77], v[76:77], v[124:125]
    v_pk_add_f32 v[78:79], v[78:79], v[124:125]
    v_rcp_f32 v76, v76
    v_rcp_f32 v77, v77
    v_rcp_f32 v78, v78
    v_rcp_f32 v79, v79
    s_nop 0
    v_pk_mul_f32 v[40:41], v[40:41], v[76:77]
    v_pk_mul_f32 v[42:43], v[42:43], v[78:79]
    v_cvt_pk_bf16_f32 v80, v40, v41
    v_cvt_pk_bf16_f32 v81, v42, v43
    s_add_u32 s51, s56, 1024
    buffer_store_dwordx2 v[80:81], v7, s[36:39], s51 offen
    v_pk_mul_f32 v[44:45], v[44:45], v[64:65]
    v_pk_mul_f32 v[46:47], v[46:47], v[64:65]
    v_pk_fma_f32 v[44:45], v[20:21], v[66:67], v[44:45]
    v_pk_fma_f32 v[46:47], v[22:23], v[66:67], v[46:47]
    v_pk_add_f32 v[44:45], v[44:45], v[108:109]
    v_pk_add_f32 v[46:47], v[46:47], v[110:111]
    v_cvt_pk_bf16_f32 v72, v44, v45
    v_lshlrev_b32 v44, 16, v72
    v_and_b32 v45, 0xffff0000, v72
    v_cvt_pk_bf16_f32 v73, v46, v47
    v_lshlrev_b32 v46, 16, v73
    v_and_b32 v47, 0xffff0000, v73
    v_pk_mul_f32 v[76:77], v[44:45], v[44:45]
    v_pk_mul_f32 v[78:79], v[46:47], v[46:47]
    v_pk_fma_f32 v[76:77], v[76:77], v[120:121], v[122:123]
    v_pk_fma_f32 v[78:79], v[78:79], v[120:121], v[122:123]
    v_pk_mul_f32 v[76:77], v[76:77], v[44:45]
    v_pk_mul_f32 v[78:79], v[78:79], v[46:47]
    v_exp_f32 v76, v76
    v_exp_f32 v77, v77
    v_exp_f32 v78, v78
    v_exp_f32 v79, v79
    s_nop 0
    v_pk_add_f32 v[76:77], v[76:77], v[124:125]
    v_pk_add_f32 v[78:79], v[78:79], v[124:125]
    v_rcp_f32 v76, v76
    v_rcp_f32 v77, v77
    v_rcp_f32 v78, v78
    v_rcp_f32 v79, v79
    s_nop 0
    v_pk_mul_f32 v[44:45], v[44:45], v[76:77]
    v_pk_mul_f32 v[46:47], v[46:47], v[78:79]
    v_cvt_pk_bf16_f32 v82, v44, v45
    v_cvt_pk_bf16_f32 v83, v46, v47
    s_add_u32 s51, s56, 1536
    buffer_store_dwordx2 v[82:83], v7, s[36:39], s51 offen
    v_pk_mul_f32 v[48:49], v[48:49], v[68:69]
    v_pk_mul_f32 v[50:51], v[50:51], v[68:69]
    v_pk_fma_f32 v[48:49], v[8:9], v[70:71], v[48:49]
    v_pk_fma_f32 v[50:51], v[10:11], v[70:71], v[50:51]
    v_pk_add_f32 v[48:49], v[48:49], v[96:97]
    v_pk_add_f32 v[50:51], v[50:51], v[98:99]
    v_cvt_pk_bf16_f32 v72, v48, v49
    v_lshlrev_b32 v48, 16, v72
    v_and_b32 v49, 0xffff0000, v72
    v_cvt_pk_bf16_f32 v73, v50, v51
    v_lshlrev_b32 v50, 16, v73
    v_and_b32 v51, 0xffff0000, v73
    v_pk_mul_f32 v[76:77], v[48:49], v[48:49]
    v_pk_mul_f32 v[78:79], v[50:51], v[50:51]
    v_pk_fma_f32 v[76:77], v[76:77], v[120:121], v[122:123]
    v_pk_fma_f32 v[78:79], v[78:79], v[120:121], v[122:123]
    v_pk_mul_f32 v[76:77], v[76:77], v[48:49]
    v_pk_mul_f32 v[78:79], v[78:79], v[50:51]
    v_exp_f32 v76, v76
    v_exp_f32 v77, v77
    v_exp_f32 v78, v78
    v_exp_f32 v79, v79
    s_nop 0
    v_pk_add_f32 v[76:77], v[76:77], v[124:125]
    v_pk_add_f32 v[78:79], v[78:79], v[124:125]
    v_rcp_f32 v76, v76
    v_rcp_f32 v77, v77
    v_rcp_f32 v78, v78
    v_rcp_f32 v79, v79
    s_nop 0
    v_pk_mul_f32 v[48:49], v[48:49], v[76:77]
    v_pk_mul_f32 v[50:51], v[50:51], v[78:79]
    v_cvt_pk_bf16_f32 v80, v48, v49
    v_cvt_pk_bf16_f32 v81, v50, v51
    s_add_u32 s51, s56, 114688
    buffer_store_dwordx2 v[80:81], v7, s[36:39], s51 offen
    v_pk_mul_f32 v[52:53], v[52:53], v[68:69]
    v_pk_mul_f32 v[54:55], v[54:55], v[68:69]
    v_pk_fma_f32 v[52:53], v[12:13], v[70:71], v[52:53]
    v_pk_fma_f32 v[54:55], v[14:15], v[70:71], v[54:55]
    v_pk_add_f32 v[52:53], v[52:53], v[100:101]
    v_pk_add_f32 v[54:55], v[54:55], v[102:103]
    v_cvt_pk_bf16_f32 v72, v52, v53
    v_lshlrev_b32 v52, 16, v72
    v_and_b32 v53, 0xffff0000, v72
    v_cvt_pk_bf16_f32 v73, v54, v55
    v_lshlrev_b32 v54, 16, v73
    v_and_b32 v55, 0xffff0000, v73
    v_pk_mul_f32 v[76:77], v[52:53], v[52:53]
    v_pk_mul_f32 v[78:79], v[54:55], v[54:55]
    v_pk_fma_f32 v[76:77], v[76:77], v[120:121], v[122:123]
    v_pk_fma_f32 v[78:79], v[78:79], v[120:121], v[122:123]
    v_pk_mul_f32 v[76:77], v[76:77], v[52:53]
    v_pk_mul_f32 v[78:79], v[78:79], v[54:55]
    v_exp_f32 v76, v76
    v_exp_f32 v77, v77
    v_exp_f32 v78, v78
    v_exp_f32 v79, v79
    s_nop 0
    v_pk_add_f32 v[76:77], v[76:77], v[124:125]
    v_pk_add_f32 v[78:79], v[78:79], v[124:125]
    v_rcp_f32 v76, v76
    v_rcp_f32 v77, v77
    v_rcp_f32 v78, v78
    v_rcp_f32 v79, v79
    s_nop 0
    v_pk_mul_f32 v[52:53], v[52:53], v[76:77]
    v_pk_mul_f32 v[54:55], v[54:55], v[78:79]
    v_cvt_pk_bf16_f32 v82, v52, v53
    v_cvt_pk_bf16_f32 v83, v54, v55
    s_add_u32 s51, s56, 115200
    buffer_store_dwordx2 v[82:83], v7, s[36:39], s51 offen
    v_pk_mul_f32 v[56:57], v[56:57], v[68:69]
    v_pk_mul_f32 v[58:59], v[58:59], v[68:69]
    v_pk_fma_f32 v[56:57], v[16:17], v[70:71], v[56:57]
    v_pk_fma_f32 v[58:59], v[18:19], v[70:71], v[58:59]
    v_pk_add_f32 v[56:57], v[56:57], v[104:105]
    v_pk_add_f32 v[58:59], v[58:59], v[106:107]
    v_cvt_pk_bf16_f32 v72, v56, v57
    v_lshlrev_b32 v56, 16, v72
    v_and_b32 v57, 0xffff0000, v72
    v_cvt_pk_bf16_f32 v73, v58, v59
    v_lshlrev_b32 v58, 16, v73
    v_and_b32 v59, 0xffff0000, v73
    v_pk_mul_f32 v[76:77], v[56:57], v[56:57]
    v_pk_mul_f32 v[78:79], v[58:59], v[58:59]
    v_pk_fma_f32 v[76:77], v[76:77], v[120:121], v[122:123]
    v_pk_fma_f32 v[78:79], v[78:79], v[120:121], v[122:123]
    v_pk_mul_f32 v[76:77], v[76:77], v[56:57]
    v_pk_mul_f32 v[78:79], v[78:79], v[58:59]
    v_exp_f32 v76, v76
    v_exp_f32 v77, v77
    v_exp_f32 v78, v78
    v_exp_f32 v79, v79
    s_nop 0
    v_pk_add_f32 v[76:77], v[76:77], v[124:125]
    v_pk_add_f32 v[78:79], v[78:79], v[124:125]
    v_rcp_f32 v76, v76
    v_rcp_f32 v77, v77
    v_rcp_f32 v78, v78
    v_rcp_f32 v79, v79
    s_nop 0
    v_pk_mul_f32 v[56:57], v[56:57], v[76:77]
    v_pk_mul_f32 v[58:59], v[58:59], v[78:79]
    v_cvt_pk_bf16_f32 v80, v56, v57
    v_cvt_pk_bf16_f32 v81, v58, v59
    s_add_u32 s51, s56, 115712
    buffer_store_dwordx2 v[80:81], v7, s[36:39], s51 offen
    v_pk_mul_f32 v[60:61], v[60:61], v[68:69]
    v_pk_mul_f32 v[62:63], v[62:63], v[68:69]
    v_pk_fma_f32 v[60:61], v[20:21], v[70:71], v[60:61]
    v_pk_fma_f32 v[62:63], v[22:23], v[70:71], v[62:63]
    v_pk_add_f32 v[60:61], v[60:61], v[108:109]
    v_pk_add_f32 v[62:63], v[62:63], v[110:111]
    v_cvt_pk_bf16_f32 v72, v60, v61
    v_lshlrev_b32 v60, 16, v72
    v_and_b32 v61, 0xffff0000, v72
    v_cvt_pk_bf16_f32 v73, v62, v63
    v_lshlrev_b32 v62, 16, v73
    v_and_b32 v63, 0xffff0000, v73
    v_pk_mul_f32 v[76:77], v[60:61], v[60:61]
    v_pk_mul_f32 v[78:79], v[62:63], v[62:63]
    v_pk_fma_f32 v[76:77], v[76:77], v[120:121], v[122:123]
    v_pk_fma_f32 v[78:79], v[78:79], v[120:121], v[122:123]
    v_pk_mul_f32 v[76:77], v[76:77], v[60:61]
    v_pk_mul_f32 v[78:79], v[78:79], v[62:63]
    v_exp_f32 v76, v76
    v_exp_f32 v77, v77
    v_exp_f32 v78, v78
    v_exp_f32 v79, v79
    s_nop 0
    v_pk_add_f32 v[76:77], v[76:77], v[124:125]
    v_pk_add_f32 v[78:79], v[78:79], v[124:125]
    v_rcp_f32 v76, v76
    v_rcp_f32 v77, v77
    v_rcp_f32 v78, v78
    v_rcp_f32 v79, v79
    s_nop 0
    v_pk_mul_f32 v[60:61], v[60:61], v[76:77]
    v_pk_mul_f32 v[62:63], v[62:63], v[78:79]
    v_cvt_pk_bf16_f32 v82, v60, v61
    v_cvt_pk_bf16_f32 v83, v62, v63
    s_add_u32 s51, s56, 116224
    buffer_store_dwordx2 v[82:83], v7, s[36:39], s51 offen
L_ffn1b_kernel_end:
    s_endpgm
.globl ffn2b_kernel
.p2align 8
.type ffn2b_kernel,@function
ffn2b_kernel:
    s_cmp_ge_u32 s2, 256
    s_cbranch_scc1 L_ffn2b_kernel_end
    s_load_dwordx16 s[4:19], s[0:1], 0
    s_load_dwordx4 s[20:23], s[0:1], 64
    s_load_dwordx2 s[24:25], s[0:1], 80
    s_and_b32 s51, s2, 7
    s_lshl_b32 s48, s51, 2
    s_lshr_b32 s51, s2, 6
    s_add_u32 s48, s48, s51
    s_lshr_b32 s49, s2, 3
    s_and_b32 s49, s49, 7
    v_lshrrev_b32 v2, 6, v0
    v_and_b32 v1, 63, v0
    v_lshlrev_b32 v3, 4, v1
    v_readfirstlane_b32 s50, v2
    s_waitcnt lgkmcnt(0)
    s_add_u32 s28, s24, 0x00a00000
    s_addc_u32 s29, s25, 0
    s_and_b32 s29, s29, 0xffff
    s_mov_b32 s30, 0x00700000
    s_mov_b32 s31, 0x00020000
    s_add_u32 s32, s24, 0x01b00000
    s_addc_u32 s33, s25, 0
    s_and_b32 s33, s33, 0xffff
    s_mov_b32 s34, 0x001c0000
    s_mov_b32 s35, 0x00020000
    s_add_u32 s36, s24, 0x01400000
    s_addc_u32 s37, s25, 0
    s_and_b32 s37, s37, 0xffff
    s_mov_b32 s38, 0x00200000
    s_mov_b32 s39, 0x00020000
    s_mov_b32 s40, s20
    s_and_b32 s41, s21, 0xffff
    s_mov_b32 s42, 0x00200000
    s_mov_b32 s43, 0x00020000
    s_mov_b32 s44, s18
    s_and_b32 s45, s19, 0xffff
    s_mov_b32 s46, 0x00000400
    s_mov_b32 s47, 0x00020000
    s_mul_i32 s51, s50, 28672
    s_mul_i32 s53, s48, 229376
    s_add_u32 s53, s53, s51
    s_mul_i32 s54, s49, 229376
    s_add_u32 s54, s54, s51
    v_lshrrev_b32 v15, 5, v1
    v_and_b32 v14, 31, v1
    v_lshlrev_b32 v16, 4, v14
    v_lshl_add_u32 v16, v15, 3, v16
    s_lshr_b32 s51, s50, 1
    s_lshl_b32 s52, s48, 1
    s_add_u32 s51, s51, s52
    s_lshl_b32 s55, s51, 15
    s_lshl_b32 s52, s49, 12
    s_add_u32 s55, s55, s52
    s_and_b32 s52, s50, 1
    s_lshl_b32 s52, s52, 11
    s_add_u32 s55, s55, s52
    s_add_u32 s51, s53, 0
    buffer_load_dwordx4 a[0:3], v3, s[28:31], s51 offen
    s_add_u32 s51, s53, 114688
    buffer_load_dwordx4 a[4:7], v3, s[28:31], s51 offen
    s_add_u32 s51, s54, 0
    buffer_load_dwordx4 a[8:11], v3, s[32:35], s51 offen
    s_add_u32 s51, s54, 114688
    buffer_load_dwordx4 a[12:15], v3, s[32:35], s51 offen
    s_add_u32 s51, s53, 1024
    buffer_load_dwordx4 a[16:19], v3, s[28:31], s51 offen
    s_add_u32 s51, s53, 115712
    buffer_load_dwordx4 a[20:23], v3, s[28:31], s51 offen
    s_add_u32 s51, s54, 1024
    buffer_load_dwordx4 a[24:27], v3, s[32:35], s51 offen
    s_add_u32 s51, s54, 115712
    buffer_load_dwordx4 a[28:31], v3, s[32:35], s51 offen
    s_add_u32 s51, s53, 2048
    buffer_load_dwordx4 a[32:35], v3, s[28:31], s51 offen
    s_add_u32 s51, s53, 116736
    buffer_load_dwordx4 a[36:39], v3, s[28:31], s51 offen
    s_add_u32 s51, s54, 2048
    buffer_load_dwordx4 a[40:43], v3, s[32:35], s51 offen
    s_add_u32 s51, s54, 116736
    buffer_load_dwordx4 a[44:47], v3, s[32:35], s51 offen
    s_add_u32 s51, s53, 3072
    buffer_load_dwordx4 a[48:51], v3, s[28:31], s51 offen
    s_add_u32 s51, s53, 117760
    buffer_load_dwordx4 a[52:55], v3, s[28:31], s51 offen
    s_add_u32 s51, s54, 3072
    buffer_load_dwordx4 a[56:59], v3, s[32:35], s51 offen
    s_add_u32 s51, s54, 117760
    buffer_load_dwordx4 a[60:63], v3, s[32:35], s51 offen
    s_add_u32 s51, s53, 4096
    buffer_load_dwordx4 a[64:67], v3, s[28:31], s51 offen
    s_add_u32 s51, s53, 118784
    buffer_load_dwordx4 a[68:71], v3, s[28:31], s51 offen
    s_add_u32 s51, s54, 4096
    buffer_load_dwordx4 a[72:75], v3, s[32:35], s51 offen
    s_add_u32 s51, s54, 118784
    buffer_load_dwordx4 a[76:79], v3, s[32:35], s51 offen
    s_add_u32 s51, s53, 5120
    buffer_load_dwordx4 a[80:83], v3, s[28:31], s51 offen
    s_add_u32 s51, s53, 119808
    buffer_load_dwordx4 a[84:87], v3, s[28:31], s51 offen
    s_add_u32 s51, s54, 5120
    buffer_load_dwordx4 a[88:91], v3, s[32:35], s51 offen
    s_add_u32 s51, s54, 119808
    buffer_load_dwordx4 a[92:95], v3, s[32:35], s51 offen
    buffer_load_dwordx2 v[40:41], v16, s[36:39], s55 offen offset:0
    buffer_load_dwordx2 v[42:43], v16, s[36:39], s55 offen offset:512
    buffer_load_dwordx2 v[44:45], v16, s[36:39], s55 offen offset:1024
    buffer_load_dwordx2 v[46:47], v16, s[36:39], s55 offen offset:1536
    s_lshl_b32 s51, s49, 7
    s_and_b32 s52, s50, 1
    s_lshl_b32 s52, s52, 6
    s_add_u32 s51, s51, s52
    v_lshlrev_b32 v17, 3, v15
    buffer_load_dwordx2 v[48:49], v17, s[44:47], s51 offen offset:0
    buffer_load_dwordx2 v[50:51], v17, s[44:47], s51 offen offset:16
    buffer_load_dwordx2 v[52:53], v17, s[44:47], s51 offen offset:32
    buffer_load_dwordx2 v[54:55], v17, s[44:47], s51 offen offset:48
    v_mov_b32 v64, 0
    v_mov_b32 v65, 0
    v_mov_b32 v66, 0
    v_mov_b32 v67, 0
    v_mov_b32 v68, 0
    v_mov_b32 v69, 0
    v_mov_b32 v70, 0
    v_mov_b32 v71, 0
    v_mov_b32 v72, 0
    v_mov_b32 v73, 0
    v_mov_b32 v74, 0
    v_mov_b32 v75, 0
    v_mov_b32 v76, 0
    v_mov_b32 v77, 0
    v_mov_b32 v78, 0
    v_mov_b32 v79, 0
    v_mov_b32 v80, 0
    v_mov_b32 v81, 0
    v_mov_b32 v82, 0
    v_mov_b32 v83, 0
    v_mov_b32 v84, 0
    v_mov_b32 v85, 0
    v_mov_b32 v86, 0
    v_mov_b32 v87, 0
    v_mov_b32 v88, 0
    v_mov_b32 v89, 0
    v_mov_b32 v90, 0
    v_mov_b32 v91, 0
    v_mov_b32 v92, 0
    v_mov_b32 v93, 0
    v_mov_b32 v94, 0
    v_mov_b32 v95, 0
    v_mov_b32 v96, 0
    v_mov_b32 v97, 0
    v_mov_b32 v98, 0
    v_mov_b32 v99, 0
    v_mov_b32 v100, 0
    v_mov_b32 v101, 0
    v_mov_b32 v102, 0
    v_mov_b32 v103, 0
    v_mov_b32 v104, 0
    v_mov_b32 v105, 0
    v_mov_b32 v106, 0
    v_mov_b32 v107, 0
    v_mov_b32 v108, 0
    v_mov_b32 v109, 0
    v_mov_b32 v110, 0
    v_mov_b32 v111, 0
    v_mov_b32 v112, 0
    v_mov_b32 v113, 0
    v_mov_b32 v114, 0
    v_mov_b32 v115, 0
    v_mov_b32 v116, 0
    v_mov_b32 v117, 0
    v_mov_b32 v118, 0
    v_mov_b32 v119, 0
    v_mov_b32 v120, 0
    v_mov_b32 v121, 0
    v_mov_b32 v122, 0
    v_mov_b32 v123, 0
    v_mov_b32 v124, 0
    v_mov_b32 v125, 0
    v_mov_b32 v126, 0
    v_mov_b32 v127, 0
    s_waitcnt vmcnt(28)
    v_mfma_f32_32x32x16_bf16 v[64:79], a[8:11], a[0:3], v[64:79]
    v_mfma_f32_32x32x16_bf16 v[80:95], a[12:15], a[0:3], v[80:95]
    v_mfma_f32_32x32x16_bf16 v[96:111], a[8:11], a[4:7], v[96:111]
    v_mfma_f32_32x32x16_bf16 v[112:127], a[12:15], a[4:7], v[112:127]
    s_add_u32 s51, s53, 6144
    buffer_load_dwordx4 a[96:99], v3, s[28:31], s51 offen
    s_add_u32 s51, s53, 120832
    buffer_load_dwordx4 a[100:103], v3, s[28:31], s51 offen
    s_add_u32 s51, s54, 6144
    buffer_load_dwordx4 a[104:107], v3, s[32:35], s51 offen
    s_add_u32 s51, s54, 120832
    buffer_load_dwordx4 a[108:111], v3, s[32:35], s51 offen
    s_waitcnt vmcnt(28)
    v_mfma_f32_32x32x16_bf16 v[64:79], a[24:27], a[16:19], v[64:79]
    v_mfma_f32_32x32x16_bf16 v[80:95], a[28:31], a[16:19], v[80:95]
    v_mfma_f32_32x32x16_bf16 v[96:111], a[24:27], a[20:23], v[96:111]
    v_mfma_f32_32x32x16_bf16 v[112:127], a[28:31], a[20:23], v[112:127]
    s_add_u32 s51, s53, 7168
    buffer_load_dwordx4 a[112:115], v3, s[28:31], s51 offen
    s_add_u32 s51, s53, 121856
    buffer_load_dwordx4 a[116:119], v3, s[28:31], s51 offen
    s_add_u32 s51, s54, 7168
    buffer_load_dwordx4 a[120:123], v3, s[32:35], s51 offen
    s_add_u32 s51, s54, 121856
    buffer_load_dwordx4 a[124:127], v3, s[32:35], s51 offen
    s_waitcnt vmcnt(28)
    v_mfma_f32_32x32x16_bf16 v[64:79], a[40:43], a[32:35], v[64:79]
    v_mfma_f32_32x32x16_bf16 v[80:95], a[44:47], a[32:35], v[80:95]
    v_mfma_f32_32x32x16_bf16 v[96:111], a[40:43], a[36:39], v[96:111]
    v_mfma_f32_32x32x16_bf16 v[112:127], a[44:47], a[36:39], v[112:127]
    s_add_u32 s51, s53, 8192
    buffer_load_dwordx4 a[128:131], v3, s[28:31], s51 offen
    s_add_u32 s51, s53, 122880
    buffer_load_dwordx4 a[132:135], v3, s[28:31], s51 offen
    s_add_u32 s51, s54, 8192
    buffer_load_dwordx4 a[136:139], v3, s[32:35], s51 offen
    s_add_u32 s51, s54, 122880
    buffer_load_dwordx4 a[140:143], v3, s[32:35], s51 offen
    s_waitcnt vmcnt(28)
    v_mfma_f32_32x32x16_bf16 v[64:79], a[56:59], a[48:51], v[64:79]
    v_mfma_f32_32x32x16_bf16 v[80:95], a[60:63], a[48:51], v[80:95]
    v_mfma_f32_32x32x16_bf16 v[96:111], a[56:59], a[52:55], v[96:111]
    v_mfma_f32_32x32x16_bf16 v[112:127], a[60:63], a[52:55], v[112:127]
    s_add_u32 s51, s53, 9216
    buffer_load_dwordx4 a[144:147], v3, s[28:31], s51 offen
    s_add_u32 s51, s53, 123904
    buffer_load_dwordx4 a[148:151], v3, s[28:31], s51 offen
    s_add_u32 s51, s54, 9216
    buffer_load_dwordx4 a[152:155], v3, s[32:35], s51 offen
    s_add_u32 s51, s54, 123904
    buffer_load_dwordx4 a[156:159], v3, s[32:35], s51 offen
    s_waitcnt vmcnt(28)
    v_mfma_f32_32x32x16_bf16 v[64:79], a[72:75], a[64:67], v[64:79]
    v_mfma_f32_32x32x16_bf16 v[80:95], a[76:79], a[64:67], v[80:95]
    v_mfma_f32_32x32x16_bf16 v[96:111], a[72:75], a[68:71], v[96:111]
    v_mfma_f32_32x32x16_bf16 v[112:127], a[76:79], a[68:71], v[112:127]
    s_add_u32 s51, s53, 10240
    buffer_load_dwordx4 a[160:163], v3, s[28:31], s51 offen
    s_add_u32 s51, s53, 124928
    buffer_load_dwordx4 a[164:167], v3, s[28:31], s51 offen
    s_add_u32 s51, s54, 10240
    buffer_load_dwordx4 a[168:171], v3, s[32:35], s51 offen
    s_add_u32 s51, s54, 124928
    buffer_load_dwordx4 a[172:175], v3, s[32:35], s51 offen
    s_waitcnt vmcnt(28)
    v_mfma_f32_32x32x16_bf16 v[64:79], a[88:91], a[80:83], v[64:79]
    v_mfma_f32_32x32x16_bf16 v[80:95], a[92:95], a[80:83], v[80:95]
    v_mfma_f32_32x32x16_bf16 v[96:111], a[88:91], a[84:87], v[96:111]
    v_mfma_f32_32x32x16_bf16 v[112:127], a[92:95], a[84:87], v[112:127]
    s_add_u32 s51, s53, 11264
    buffer_load_dwordx4 a[176:179], v3, s[28:31], s51 offen
    s_add_u32 s51, s53, 125952
    buffer_load_dwordx4 a[180:183], v3, s[28:31], s51 offen
    s_add_u32 s51, s54, 11264
    buffer_load_dwordx4 a[184:187], v3, s[32:35], s51 offen
    s_add_u32 s51, s54, 125952
    buffer_load_dwordx4 a[188:191], v3, s[32:35], s51 offen
    s_waitcnt vmcnt(20)
    v_mfma_f32_32x32x16_bf16 v[64:79], a[104:107], a[96:99], v[64:79]
    v_mfma_f32_32x32x16_bf16 v[80:95], a[108:111], a[96:99], v[80:95]
    v_mfma_f32_32x32x16_bf16 v[96:111], a[104:107], a[100:103], v[96:111]
    v_mfma_f32_32x32x16_bf16 v[112:127], a[108:111], a[100:103], v[112:127]
    s_add_u32 s51, s53, 12288
    buffer_load_dwordx4 a[192:195], v3, s[28:31], s51 offen
    s_add_u32 s51, s53, 126976
    buffer_load_dwordx4 a[196:199], v3, s[28:31], s51 offen
    s_add_u32 s51, s54, 12288
    buffer_load_dwordx4 a[200:203], v3, s[32:35], s51 offen
    s_add_u32 s51, s54, 126976
    buffer_load_dwordx4 a[204:207], v3, s[32:35], s51 offen
    s_waitcnt vmcnt(20)
    v_mfma_f32_32x32x16_bf16 v[64:79], a[120:123], a[112:115], v[64:79]
    v_mfma_f32_32x32x16_bf16 v[80:95], a[124:127], a[112:115], v[80:95]
    v_mfma_f32_32x32x16_bf16 v[96:111], a[120:123], a[116:119], v[96:111]
    v_mfma_f32_32x32x16_bf16 v[112:127], a[124:127], a[116:119], v[112:127]
    s_add_u32 s51, s53, 13312
    buffer_load_dwordx4 a[208:211], v3, s[28:31], s51 offen
    s_add_u32 s51, s53, 128000
    buffer_load_dwordx4 a[212:215], v3, s[28:31], s51 offen
    s_add_u32 s51, s54, 13312
    buffer_load_dwordx4 a[216:219], v3, s[32:35], s51 offen
    s_add_u32 s51, s54, 128000
    buffer_load_dwordx4 a[220:223], v3, s[32:35], s51 offen
    s_waitcnt vmcnt(20)
    v_mfma_f32_32x32x16_bf16 v[64:79], a[136:139], a[128:131], v[64:79]
    v_mfma_f32_32x32x16_bf16 v[80:95], a[140:143], a[128:131], v[80:95]
    v_mfma_f32_32x32x16_bf16 v[96:111], a[136:139], a[132:135], v[96:111]
    v_mfma_f32_32x32x16_bf16 v[112:127], a[140:143], a[132:135], v[112:127]
    s_add_u32 s51, s53, 14336
    buffer_load_dwordx4 a[0:3], v3, s[28:31], s51 offen
    s_add_u32 s51, s53, 129024
    buffer_load_dwordx4 a[4:7], v3, s[28:31], s51 offen
    s_add_u32 s51, s54, 14336
    buffer_load_dwordx4 a[8:11], v3, s[32:35], s51 offen
    s_add_u32 s51, s54, 129024
    buffer_load_dwordx4 a[12:15], v3, s[32:35], s51 offen
    s_waitcnt vmcnt(20)
    v_mfma_f32_32x32x16_bf16 v[64:79], a[152:155], a[144:147], v[64:79]
    v_mfma_f32_32x32x16_bf16 v[80:95], a[156:159], a[144:147], v[80:95]
    v_mfma_f32_32x32x16_bf16 v[96:111], a[152:155], a[148:151], v[96:111]
    v_mfma_f32_32x32x16_bf16 v[112:127], a[156:159], a[148:151], v[112:127]
    s_add_u32 s51, s53, 15360
    buffer_load_dwordx4 a[16:19], v3, s[28:31], s51 offen
    s_add_u32 s51, s53, 130048
    buffer_load_dwordx4 a[20:23], v3, s[28:31], s51 offen
    s_add_u32 s51, s54, 15360
    buffer_load_dwordx4 a[24:27], v3, s[32:35], s51 offen
    s_add_u32 s51, s54, 130048
    buffer_load_dwordx4 a[28:31], v3, s[32:35], s51 offen
    s_waitcnt vmcnt(20)
    v_mfma_f32_32x32x16_bf16 v[64:79], a[168:171], a[160:163], v[64:79]
    v_mfma_f32_32x32x16_bf16 v[80:95], a[172:175], a[160:163], v[80:95]
    v_mfma_f32_32x32x16_bf16 v[96:111], a[168:171], a[164:167], v[96:111]
    v_mfma_f32_32x32x16_bf16 v[112:127], a[172:175], a[164:167], v[112:127]
    s_add_u32 s51, s53, 16384
    buffer_load_dwordx4 a[32:35], v3, s[28:31], s51 offen
    s_add_u32 s51, s53, 131072
    buffer_load_dwordx4 a[36:39], v3, s[28:31], s51 offen
    s_add_u32 s51, s54, 16384
    buffer_load_dwordx4 a[40:43], v3, s[32:35], s51 offen
    s_add_u32 s51, s54, 131072
    buffer_load_dwordx4 a[44:47], v3, s[32:35], s51 offen
    s_waitcnt vmcnt(20)
    v_mfma_f32_32x32x16_bf16 v[64:79], a[184:187], a[176:179], v[64:79]
    v_mfma_f32_32x32x16_bf16 v[80:95], a[188:191], a[176:179], v[80:95]
    v_mfma_f32_32x32x16_bf16 v[96:111], a[184:187], a[180:183], v[96:111]
    v_mfma_f32_32x32x16_bf16 v[112:127], a[188:191], a[180:183], v[112:127]
    s_add_u32 s51, s53, 17408
    buffer_load_dwordx4 a[48:51], v3, s[28:31], s51 offen
    s_add_u32 s51, s53, 132096
    buffer_load_dwordx4 a[52:55], v3, s[28:31], s51 offen
    s_add_u32 s51, s54, 17408
    buffer_load_dwordx4 a[56:59], v3, s[32:35], s51 offen
    s_add_u32 s51, s54, 132096
    buffer_load_dwordx4 a[60:63], v3, s[32:35], s51 offen
    s_waitcnt vmcnt(20)
    v_mfma_f32_32x32x16_bf16 v[64:79], a[200:203], a[192:195], v[64:79]
    v_mfma_f32_32x32x16_bf16 v[80:95], a[204:207], a[192:195], v[80:95]
    v_mfma_f32_32x32x16_bf16 v[96:111], a[200:203], a[196:199], v[96:111]
    v_mfma_f32_32x32x16_bf16 v[112:127], a[204:207], a[196:199], v[112:127]
    s_add_u32 s51, s53, 18432
    buffer_load_dwordx4 a[64:67], v3, s[28:31], s51 offen
    s_add_u32 s51, s53, 133120
    buffer_load_dwordx4 a[68:71], v3, s[28:31], s51 offen
    s_add_u32 s51, s54, 18432
    buffer_load_dwordx4 a[72:75], v3, s[32:35], s51 offen
    s_add_u32 s51, s54, 133120
    buffer_load_dwordx4 a[76:79], v3, s[32:35], s51 offen
    s_waitcnt vmcnt(20)
    v_mfma_f32_32x32x16_bf16 v[64:79], a[216:219], a[208:211], v[64:79]
    v_mfma_f32_32x32x16_bf16 v[80:95], a[220:223], a[208:211], v[80:95]
    v_mfma_f32_32x32x16_bf16 v[96:111], a[216:219], a[212:215], v[96:111]
    v_mfma_f32_32x32x16_bf16 v[112:127], a[220:223], a[212:215], v[112:127]
    s_add_u32 s51, s53, 19456
    buffer_load_dwordx4 a[80:83], v3, s[28:31], s51 offen
    s_add_u32 s51, s53, 134144
    buffer_load_dwordx4 a[84:87], v3, s[28:31], s51 offen
    s_add_u32 s51, s54, 19456
    buffer_load_dwordx4 a[88:91], v3, s[32:35], s51 offen
    s_add_u32 s51, s54, 134144
    buffer_load_dwordx4 a[92:95], v3, s[32:35], s51 offen
    s_waitcnt vmcnt(20)
    v_mfma_f32_32x32x16_bf16 v[64:79], a[8:11], a[0:3], v[64:79]
    v_mfma_f32_32x32x16_bf16 v[80:95], a[12:15], a[0:3], v[80:95]
    v_mfma_f32_32x32x16_bf16 v[96:111], a[8:11], a[4:7], v[96:111]
    v_mfma_f32_32x32x16_bf16 v[112:127], a[12:15], a[4:7], v[112:127]
    s_add_u32 s51, s53, 20480
    buffer_load_dwordx4 a[96:99], v3, s[28:31], s51 offen
    s_add_u32 s51, s53, 135168
    buffer_load_dwordx4 a[100:103], v3, s[28:31], s51 offen
    s_add_u32 s51, s54, 20480
    buffer_load_dwordx4 a[104:107], v3, s[32:35], s51 offen
    s_add_u32 s51, s54, 135168
    buffer_load_dwordx4 a[108:111], v3, s[32:35], s51 offen
    s_waitcnt vmcnt(20)
    v_mfma_f32_32x32x16_bf16 v[64:79], a[24:27], a[16:19], v[64:79]
    v_mfma_f32_32x32x16_bf16 v[80:95], a[28:31], a[16:19], v[80:95]
    v_mfma_f32_32x32x16_bf16 v[96:111], a[24:27], a[20:23], v[96:111]
    v_mfma_f32_32x32x16_bf16 v[112:127], a[28:31], a[20:23], v[112:127]
    s_add_u32 s51, s53, 21504
    buffer_load_dwordx4 a[112:115], v3, s[28:31], s51 offen
    s_add_u32 s51, s53, 136192
    buffer_load_dwordx4 a[116:119], v3, s[28:31], s51 offen
    s_add_u32 s51, s54, 21504
    buffer_load_dwordx4 a[120:123], v3, s[32:35], s51 offen
    s_add_u32 s51, s54, 136192
    buffer_load_dwordx4 a[124:127], v3, s[32:35], s51 offen
    s_waitcnt vmcnt(20)
    v_mfma_f32_32x32x16_bf16 v[64:79], a[40:43], a[32:35], v[64:79]
    v_mfma_f32_32x32x16_bf16 v[80:95], a[44:47], a[32:35], v[80:95]
    v_mfma_f32_32x32x16_bf16 v[96:111], a[40:43], a[36:39], v[96:111]
    v_mfma_f32_32x32x16_bf16 v[112:127], a[44:47], a[36:39], v[112:127]
    s_add_u32 s51, s53, 22528
    buffer_load_dwordx4 a[128:131], v3, s[28:31], s51 offen
    s_add_u32 s51, s53, 137216
    buffer_load_dwordx4 a[132:135], v3, s[28:31], s51 offen
    s_add_u32 s51, s54, 22528
    buffer_load_dwordx4 a[136:139], v3, s[32:35], s51 offen
    s_add_u32 s51, s54, 137216
    buffer_load_dwordx4 a[140:143], v3, s[32:35], s51 offen
    s_waitcnt vmcnt(20)
    v_mfma_f32_32x32x16_bf16 v[64:79], a[56:59], a[48:51], v[64:79]
    v_mfma_f32_32x32x16_bf16 v[80:95], a[60:63], a[48:51], v[80:95]
    v_mfma_f32_32x32x16_bf16 v[96:111], a[56:59], a[52:55], v[96:111]
    v_mfma_f32_32x32x16_bf16 v[112:127], a[60:63], a[52:55], v[112:127]
    s_add_u32 s51, s53, 23552
    buffer_load_dwordx4 a[144:147], v3, s[28:31], s51 offen
    s_add_u32 s51, s53, 138240
    buffer_load_dwordx4 a[148:151], v3, s[28:31], s51 offen
    s_add_u32 s51, s54, 23552
    buffer_load_dwordx4 a[152:155], v3, s[32:35], s51 offen
    s_add_u32 s51, s54, 138240
    buffer_load_dwordx4 a[156:159], v3, s[32:35], s51 offen
    s_waitcnt vmcnt(20)
    v_mfma_f32_32x32x16_bf16 v[64:79], a[72:75], a[64:67], v[64:79]
    v_mfma_f32_32x32x16_bf16 v[80:95], a[76:79], a[64:67], v[80:95]
    v_mfma_f32_32x32x16_bf16 v[96:111], a[72:75], a[68:71], v[96:111]
    v_mfma_f32_32x32x16_bf16 v[112:127], a[76:79], a[68:71], v[112:127]
    s_add_u32 s51, s53, 24576
    buffer_load_dwordx4 a[160:163], v3, s[28:31], s51 offen
    s_add_u32 s51, s53, 139264
    buffer_load_dwordx4 a[164:167], v3, s[28:31], s51 offen
    s_add_u32 s51, s54, 24576
    buffer_load_dwordx4 a[168:171], v3, s[32:35], s51 offen
    s_add_u32 s51, s54, 139264
    buffer_load_dwordx4 a[172:175], v3, s[32:35], s51 offen
    s_waitcnt vmcnt(20)
    v_mfma_f32_32x32x16_bf16 v[64:79], a[88:91], a[80:83], v[64:79]
    v_mfma_f32_32x32x16_bf16 v[80:95], a[92:95], a[80:83], v[80:95]
    v_mfma_f32_32x32x16_bf16 v[96:111], a[88:91], a[84:87], v[96:111]
    v_mfma_f32_32x32x16_bf16 v[112:127], a[92:95], a[84:87], v[112:127]
    s_add_u32 s51, s53, 25600
    buffer_load_dwordx4 a[176:179], v3, s[28:31], s51 offen
    s_add_u32 s51, s53, 140288
    buffer_load_dwordx4 a[180:183], v3, s[28:31], s51 offen
    s_add_u32 s51, s54, 25600
    buffer_load_dwordx4 a[184:187], v3, s[32:35], s51 offen
    s_add_u32 s51, s54, 140288
    buffer_load_dwordx4 a[188:191], v3, s[32:35], s51 offen
    s_waitcnt vmcnt(20)
    v_mfma_f32_32x32x16_bf16 v[64:79], a[104:107], a[96:99], v[64:79]
    v_mfma_f32_32x32x16_bf16 v[80:95], a[108:111], a[96:99], v[80:95]
    v_mfma_f32_32x32x16_bf16 v[96:111], a[104:107], a[100:103], v[96:111]
    v_mfma_f32_32x32x16_bf16 v[112:127], a[108:111], a[100:103], v[112:127]
    s_add_u32 s51, s53, 26624
    buffer_load_dwordx4 a[192:195], v3, s[28:31], s51 offen
    s_add_u32 s51, s53, 141312
    buffer_load_dwordx4 a[196:199], v3, s[28:31], s51 offen
    s_add_u32 s51, s54, 26624
    buffer_load_dwordx4 a[200:203], v3, s[32:35], s51 offen
    s_add_u32 s51, s54, 141312
    buffer_load_dwordx4 a[204:207], v3, s[32:35], s51 offen
    s_waitcnt vmcnt(20)
    v_mfma_f32_32x32x16_bf16 v[64:79], a[120:123], a[112:115], v[64:79]
    v_mfma_f32_32x32x16_bf16 v[80:95], a[124:127], a[112:115], v[80:95]
    v_mfma_f32_32x32x16_bf16 v[96:111], a[120:123], a[116:119], v[96:111]
    v_mfma_f32_32x32x16_bf16 v[112:127], a[124:127], a[116:119], v[112:127]
    s_add_u32 s51, s53, 27648
    buffer_load_dwordx4 a[208:211], v3, s[28:31], s51 offen
    s_add_u32 s51, s53, 142336
    buffer_load_dwordx4 a[212:215], v3, s[28:31], s51 offen
    s_add_u32 s51, s54, 27648
    buffer_load_dwordx4 a[216:219], v3, s[32:35], s51 offen
    s_add_u32 s51, s54, 142336
    buffer_load_dwordx4 a[220:223], v3, s[32:35], s51 offen
    s_waitcnt vmcnt(20)
    v_mfma_f32_32x32x16_bf16 v[64:79], a[136:139], a[128:131], v[64:79]
    v_mfma_f32_32x32x16_bf16 v[80:95], a[140:143], a[128:131], v[80:95]
    v_mfma_f32_32x32x16_bf16 v[96:111], a[136:139], a[132:135], v[96:111]
    v_mfma_f32_32x32x16_bf16 v[112:127], a[140:143], a[132:135], v[112:127]
    s_waitcnt vmcnt(16)
    v_mfma_f32_32x32x16_bf16 v[64:79], a[152:155], a[144:147], v[64:79]
    v_mfma_f32_32x32x16_bf16 v[80:95], a[156:159], a[144:147], v[80:95]
    v_mfma_f32_32x32x16_bf16 v[96:111], a[152:155], a[148:151], v[96:111]
    v_mfma_f32_32x32x16_bf16 v[112:127], a[156:159], a[148:151], v[112:127]
    s_waitcnt vmcnt(12)
    v_mfma_f32_32x32x16_bf16 v[64:79], a[168:171], a[160:163], v[64:79]
    v_mfma_f32_32x32x16_bf16 v[80:95], a[172:175], a[160:163], v[80:95]
    v_mfma_f32_32x32x16_bf16 v[96:111], a[168:171], a[164:167], v[96:111]
    v_mfma_f32_32x32x16_bf16 v[112:127], a[172:175], a[164:167], v[112:127]
    s_waitcnt vmcnt(8)
    v_mfma_f32_32x32x16_bf16 v[64:79], a[184:187], a[176:179], v[64:79]
    v_mfma_f32_32x32x16_bf16 v[80:95], a[188:191], a[176:179], v[80:95]
    v_mfma_f32_32x32x16_bf16 v[96:111], a[184:187], a[180:183], v[96:111]
    v_mfma_f32_32x32x16_bf16 v[112:127], a[188:191], a[180:183], v[112:127]
    s_waitcnt vmcnt(4)
    v_mfma_f32_32x32x16_bf16 v[64:79], a[200:203], a[192:195], v[64:79]
    v_mfma_f32_32x32x16_bf16 v[80:95], a[204:207], a[192:195], v[80:95]
    v_mfma_f32_32x32x16_bf16 v[96:111], a[200:203], a[196:199], v[96:111]
    v_mfma_f32_32x32x16_bf16 v[112:127], a[204:207], a[196:199], v[112:127]
    s_waitcnt vmcnt(0)
    v_mfma_f32_32x32x16_bf16 v[64:79], a[216:219], a[208:211], v[64:79]
    v_mfma_f32_32x32x16_bf16 v[80:95], a[220:223], a[208:211], v[80:95]
    v_mfma_f32_32x32x16_bf16 v[96:111], a[216:219], a[212:215], v[96:111]
    v_mfma_f32_32x32x16_bf16 v[112:127], a[220:223], a[212:215], v[112:127]
    s_lshl_b32 s52, s50, 12
    v_add_u32 v4, s52, v3
    s_lshl_b32 s52, s50, 14
    v_add_u32 v6, s52, v3
    s_nop 15
    ds_write_b128 v4, v[64:67] offset:0
    ds_write_b128 v4, v[68:71] offset:1024
    ds_write_b128 v4, v[72:75] offset:2048
    ds_write_b128 v4, v[76:79] offset:3072
    ds_write_b128 v4, v[80:83] offset:16384
    ds_write_b128 v4, v[84:87] offset:17408
    ds_write_b128 v4, v[88:91] offset:18432
    ds_write_b128 v4, v[92:95] offset:19456
    ds_write_b128 v4, v[96:99] offset:32768
    ds_write_b128 v4, v[100:103] offset:33792
    ds_write_b128 v4, v[104:107] offset:34816
    ds_write_b128 v4, v[108:111] offset:35840
    ds_write_b128 v4, v[112:115] offset:49152
    ds_write_b128 v4, v[116:119] offset:50176
    ds_write_b128 v4, v[120:123] offset:51200
    ds_write_b128 v4, v[124:127] offset:52224
    s_waitcnt lgkmcnt(0)
    s_barrier
    ds_read_b128 v[64:67], v6 offset:0
    ds_read_b128 v[68:71], v6 offset:1024
    ds_read_b128 v[72:75], v6 offset:2048
    ds_read_b128 v[76:79], v6 offset:3072
    ds_read_b128 v[80:83], v6 offset:4096
    ds_read_b128 v[84:87], v6 offset:5120
    ds_read_b128 v[88:91], v6 offset:6144
    ds_read_b128 v[92:95], v6 offset:7168
    ds_read_b128 v[96:99], v6 offset:8192
    ds_read_b128 v[100:103], v6 offset:9216
    ds_read_b128 v[104:107], v6 offset:10240
    ds_read_b128 v[108:111], v6 offset:11264
    ds_read_b128 v[112:115], v6 offset:12288
    ds_read_b128 v[116:119], v6 offset:13312
    ds_read_b128 v[120:123], v6 offset:14336
    ds_read_b128 v[124:127], v6 offset:15360
    s_lshr_b32 s51, s50, 1
    s_lshl_b32 s51, s51, 5
    s_lshl_b32 s52, s48, 6
    s_add_u32 s51, s51, s52
    v_add_u32 v18, s51, v14
    v_lshlrev_b32 v18, 10, v18
    v_lshl_add_u32 v18, v15, 3, v18
    s_lshl_b32 s55, s49, 7
    s_and_b32 s52, s50, 1
    s_lshl_b32 s52, s52, 6
    s_add_u32 s55, s55, s52
    s_waitcnt vmcnt(0) lgkmcnt(0)
    v_pk_add_f32 v[64:65], v[64:65], v[80:81]
    v_pk_add_f32 v[96:97], v[96:97], v[112:113]
    v_pk_add_f32 v[66:67], v[66:67], v[82:83]
    v_pk_add_f32 v[98:99], v[98:99], v[114:115]
    v_pk_add_f32 v[68:69], v[68:69], v[84:85]
    v_pk_add_f32 v[100:101], v[100:101], v[116:117]
    v_pk_add_f32 v[70:71], v[70:71], v[86:87]
    v_pk_add_f32 v[102:103], v[102:103], v[118:119]
    v_pk_add_f32 v[72:73], v[72:73], v[88:89]
    v_pk_add_f32 v[104:105], v[104:105], v[120:121]
    v_pk_add_f32 v[74:75], v[74:75], v[90:91]
    v_pk_add_f32 v[106:107], v[106:107], v[122:123]
    v_pk_add_f32 v[76:77], v[76:77], v[92:93]
    v_pk_add_f32 v[108:109], v[108:109], v[124:125]
    v_pk_add_f32 v[78:79], v[78:79], v[94:95]
    v_pk_add_f32 v[110:111], v[110:111], v[126:127]
    v_pk_add_f32 v[64:65], v[64:65], v[96:97]
    v_pk_add_f32 v[66:67], v[66:67], v[98:99]
    v_pk_add_f32 v[68:69], v[68:69], v[100:101]
    v_pk_add_f32 v[70:71], v[70:71], v[102:103]
    v_pk_add_f32 v[72:73], v[72:73], v[104:105]
    v_pk_add_f32 v[74:75], v[74:75], v[106:107]
    v_pk_add_f32 v[76:77], v[76:77], v[108:109]
    v_pk_add_f32 v[78:79], v[78:79], v[110:111]
    v_cvt_pk_bf16_f32 v56, v64, v65
    v_lshlrev_b32 v64, 16, v56
    v_and_b32 v65, 0xffff0000, v56
    v_cvt_pk_bf16_f32 v57, v66, v67
    v_lshlrev_b32 v66, 16, v57
    v_and_b32 v67, 0xffff0000, v57
    v_lshlrev_b32 v58, 16, v48
    v_and_b32 v59, 0xffff0000, v48
    v_pk_add_f32 v[64:65], v[64:65], v[58:59]
    v_lshlrev_b32 v58, 16, v49
    v_and_b32 v59, 0xffff0000, v49
    v_pk_add_f32 v[66:67], v[66:67], v[58:59]
    v_cvt_pk_bf16_f32 v56, v64, v65
    v_lshlrev_b32 v64, 16, v56
    v_and_b32 v65, 0xffff0000, v56
    v_cvt_pk_bf16_f32 v57, v66, v67
    v_lshlrev_b32 v66, 16, v57
    v_and_b32 v67, 0xffff0000, v57
    v_lshlrev_b32 v58, 16, v40
    v_and_b32 v59, 0xffff0000, v40
    v_pk_add_f32 v[64:65], v[64:65], v[58:59]
    v_lshlrev_b32 v58, 16, v41
    v_and_b32 v59, 0xffff0000, v41
    v_pk_add_f32 v[66:67], v[66:67], v[58:59]
    v_cvt_pk_bf16_f32 v20, v64, v65
    v_cvt_pk_bf16_f32 v21, v66, v67
    buffer_store_dwordx2 v[20:21], v18, s[40:43], s55 offen offset:0
    v_cvt_pk_bf16_f32 v56, v68, v69
    v_lshlrev_b32 v68, 16, v56
    v_and_b32 v69, 0xffff0000, v56
    v_cvt_pk_bf16_f32 v57, v70, v71
    v_lshlrev_b32 v70, 16, v57
    v_and_b32 v71, 0xffff0000, v57
    v_lshlrev_b32 v58, 16, v50
    v_and_b32 v59, 0xffff0000, v50
    v_pk_add_f32 v[68:69], v[68:69], v[58:59]
    v_lshlrev_b32 v58, 16, v51
    v_and_b32 v59, 0xffff0000, v51
    v_pk_add_f32 v[70:71], v[70:71], v[58:59]
    v_cvt_pk_bf16_f32 v56, v68, v69
    v_lshlrev_b32 v68, 16, v56
    v_and_b32 v69, 0xffff0000, v56
    v_cvt_pk_bf16_f32 v57, v70, v71
    v_lshlrev_b32 v70, 16, v57
    v_and_b32 v71, 0xffff0000, v57
    v_lshlrev_b32 v58, 16, v42
    v_and_b32 v59, 0xffff0000, v42
    v_pk_add_f32 v[68:69], v[68:69], v[58:59]
    v_lshlrev_b32 v58, 16, v43
    v_and_b32 v59, 0xffff0000, v43
    v_pk_add_f32 v[70:71], v[70:71], v[58:59]
    v_cvt_pk_bf16_f32 v22, v68, v69
    v_cvt_pk_bf16_f32 v23, v70, v71
    buffer_store_dwordx2 v[22:23], v18, s[40:43], s55 offen offset:16
    v_cvt_pk_bf16_f32 v56, v72, v73
    v_lshlrev_b32 v72, 16, v56
    v_and_b32 v73, 0xffff0000, v56
    v_cvt_pk_bf16_f32 v57, v74, v75
    v_lshlrev_b32 v74, 16, v57
    v_and_b32 v75, 0xffff0000, v57
    v_lshlrev_b32 v58, 16, v52
    v_and_b32 v59, 0xffff0000, v52
    v_pk_add_f32 v[72:73], v[72:73], v[58:59]
    v_lshlrev_b32 v58, 16, v53
    v_and_b32 v59, 0xffff0000, v53
    v_pk_add_f32 v[74:75], v[74:75], v[58:59]
    v_cvt_pk_bf16_f32 v56, v72, v73
    v_lshlrev_b32 v72, 16, v56
    v_and_b32 v73, 0xffff0000, v56
    v_cvt_pk_bf16_f32 v57, v74, v75
    v_lshlrev_b32 v74, 16, v57
    v_and_b32 v75, 0xffff0000, v57
    v_lshlrev_b32 v58, 16, v44
    v_and_b32 v59, 0xffff0000, v44
    v_pk_add_f32 v[72:73], v[72:73], v[58:59]
    v_lshlrev_b32 v58, 16, v45
    v_and_b32 v59, 0xffff0000, v45
    v_pk_add_f32 v[74:75], v[74:75], v[58:59]
    v_cvt_pk_bf16_f32 v24, v72, v73
    v_cvt_pk_bf16_f32 v25, v74, v75
    buffer_store_dwordx2 v[24:25], v18, s[40:43], s55 offen offset:32
    v_cvt_pk_bf16_f32 v56, v76, v77
    v_lshlrev_b32 v76, 16, v56
    v_and_b32 v77, 0xffff0000, v56
    v_cvt_pk_bf16_f32 v57, v78, v79
    v_lshlrev_b32 v78, 16, v57
    v_and_b32 v79, 0xffff0000, v57
    v_lshlrev_b32 v58, 16, v54
    v_and_b32 v59, 0xffff0000, v54
    v_pk_add_f32 v[76:77], v[76:77], v[58:59]
    v_lshlrev_b32 v58, 16, v55
    v_and_b32 v59, 0xffff0000, v55
    v_pk_add_f32 v[78:79], v[78:79], v[58:59]
    v_cvt_pk_bf16_f32 v56, v76, v77
    v_lshlrev_b32 v76, 16, v56
    v_and_b32 v77, 0xffff0000, v56
    v_cvt_pk_bf16_f32 v57, v78, v79
    v_lshlrev_b32 v78, 16, v57
    v_and_b32 v79, 0xffff0000, v57
    v_lshlrev_b32 v58, 16, v46
    v_and_b32 v59, 0xffff0000, v46
    v_pk_add_f32 v[76:77], v[76:77], v[58:59]
    v_lshlrev_b32 v58, 16, v47
    v_and_b32 v59, 0xffff0000, v47
    v_pk_add_f32 v[78:79], v[78:79], v[58:59]
    v_cvt_pk_bf16_f32 v26, v76, v77
    v_cvt_pk_bf16_f32 v27, v78, v79
    buffer_store_dwordx2 v[26:27], v18, s[40:43], s55 offen offset:48
L_ffn2b_kernel_end:
    s_endpgm
.section .rodata,"a"
.p2align 6
.amdhsa_kernel qkv1_kernel
  .amdhsa_next_free_vgpr 128
  .amdhsa_next_free_sgpr 96
  .amdhsa_accum_offset 128
  .amdhsa_group_segment_fixed_size 0
  .amdhsa_kernarg_size 88
  .amdhsa_user_sgpr_count 2
  .amdhsa_user_sgpr_kernarg_segment_ptr 1
  .amdhsa_system_sgpr_workgroup_id_x 1
.end_amdhsa_kernel
.p2align 6
.amdhsa_kernel attn_kernel
  .amdhsa_next_free_vgpr 128
  .amdhsa_next_free_sgpr 96
  .amdhsa_accum_offset 128
  .amdhsa_group_segment_fixed_size 0
  .amdhsa_kernarg_size 88
  .amdhsa_user_sgpr_count 2
  .amdhsa_user_sgpr_kernarg_segment_ptr 1
  .amdhsa_system_sgpr_workgroup_id_x 1
.end_amdhsa_kernel
.p2align 6
.amdhsa_kernel wo1_kernel
  .amdhsa_next_free_vgpr 256
  .amdhsa_next_free_sgpr 96
  .amdhsa_accum_offset 128
  .amdhsa_group_segment_fixed_size 0
  .amdhsa_kernarg_size 88
  .amdhsa_user_sgpr_count 2
  .amdhsa_user_sgpr_kernarg_segment_ptr 1
  .amdhsa_system_sgpr_workgroup_id_x 1
.end_amdhsa_kernel
.p2align 6
.amdhsa_kernel ffn1a_kernel
  .amdhsa_next_free_vgpr 256
  .amdhsa_next_free_sgpr 96
  .amdhsa_accum_offset 128
  .amdhsa_group_segment_fixed_size 0
  .amdhsa_kernarg_size 88
  .amdhsa_user_sgpr_count 2
  .amdhsa_user_sgpr_kernarg_segment_ptr 1
  .amdhsa_system_sgpr_workgroup_id_x 1
.end_amdhsa_kernel
.p2align 6
.amdhsa_kernel ffn2a_kernel
  .amdhsa_next_free_vgpr 352
  .amdhsa_next_free_sgpr 96
  .amdhsa_accum_offset 128
  .amdhsa_group_segment_fixed_size 0
  .amdhsa_kernarg_size 88
  .amdhsa_user_sgpr_count 2
  .amdhsa_user_sgpr_kernarg_segment_ptr 1
  .amdhsa_system_sgpr_workgroup_id_x 1
.end_amdhsa_kernel
.p2align 6
.amdhsa_kernel qkv2_kernel
  .amdhsa_next_free_vgpr 256
  .amdhsa_next_free_sgpr 96
  .amdhsa_accum_offset 128
  .amdhsa_group_segment_fixed_size 0
  .amdhsa_kernarg_size 88
  .amdhsa_user_sgpr_count 2
  .amdhsa_user_sgpr_kernarg_segment_ptr 1
  .amdhsa_system_sgpr_workgroup_id_x 1
.end_amdhsa_kernel
.p2align 6
.amdhsa_kernel wo2_kernel
  .amdhsa_next_free_vgpr 256
  .amdhsa_next_free_sgpr 96
  .amdhsa_accum_offset 128
  .amdhsa_group_segment_fixed_size 0
  .amdhsa_kernarg_size 88
  .amdhsa_user_sgpr_count 2
  .amdhsa_user_sgpr_kernarg_segment_ptr 1
  .amdhsa_system_sgpr_workgroup_id_x 1
.end_amdhsa_kernel
.p2align 6
.amdhsa_kernel ffn1b_kernel
  .amdhsa_next_free_vgpr 256
  .amdhsa_next_free_sgpr 96
  .amdhsa_accum_offset 128
  .amdhsa_group_segment_fixed_size 0
  .amdhsa_kernarg_size 88
  .amdhsa_user_sgpr_count 2
  .amdhsa_user_sgpr_kernarg_segment_ptr 1
  .amdhsa_system_sgpr_workgroup_id_x 1
.end_amdhsa_kernel
.p2align 6
.amdhsa_kernel ffn2b_kernel
  .amdhsa_next_free_vgpr 352
  .amdhsa_next_free_sgpr 96
  .amdhsa_accum_offset 128
  .amdhsa_group_segment_fixed_size 0
  .amdhsa_kernarg_size 88
  .amdhsa_user_sgpr_count 2
  .amdhsa_user_sgpr_kernarg_segment_ptr 1
  .amdhsa_system_sgpr_workgroup_id_x 1
.end_amdhsa_kernel
```
